```python
import torch

def _softmax(x, axis=-1):
    return torch.softmax(x, dim=axis)

def _gelu(x):
    return torch.nn.functional.gelu(x, approximate='tanh')

def _silu(x):
    return torch.nn.functional.silu(x)

def _sigmoid(x):
    return torch.sigmoid(x)

def _layernorm(x, axis=-1, eps=1e-05):
    m = x.mean(dim=axis, keepdim=True)
    v = x.var(dim=axis, keepdim=True, unbiased=False)
    return (x - m) / torch.sqrt(v + eps)

def _scatter_add(tgt, idx, src, axis=0):
    return tgt.clone().index_add_(axis, idx, src)

def _segment_sum(src, seg, n):
    out = torch.zeros((n,) + src.shape[1:], dtype=src.dtype)
    return out.index_add_(0, seg, src)

def _pad(x, pw):
    flat = tuple((v for pair in reversed(pw) for v in pair))
    return torch.nn.functional.pad(x, flat)
kernel_name = 'interleave_layers__memory_aug_recurrent_mem_tr__mixer_channel_mlp__prompt'

def setup_inputs():

    _w = lambda a: (lambda t: t.to(torch.bfloat16) if t.is_floating_point() else t)(torch.as_tensor(a))

    def _A_setup():
        B, S, Dm = (1, 2048, 1024)
        H, Dh = (32, 128)
        M, seg = (8, 32)
        seg = min(seg, S)
        S = S // seg * seg
        return {'x': _w((lambda *s: torch.randn(*s, dtype=torch.bfloat16) * 0.05)(B, S, Dm)), 'mem0': _w((lambda *s: torch.randn(*s, dtype=torch.bfloat16) * 0.8)(B, M, Dm)), 'Wq': _w((lambda *s: torch.randn(*s, dtype=torch.bfloat16) * 1.6)(Dm, H, Dh) * Dm ** (-0.5)), 'Wk': _w((lambda *s: torch.randn(*s, dtype=torch.bfloat16) * 1.6)(Dm, H, Dh) * Dm ** (-0.5)), 'Wv': _w((lambda *s: torch.randn(*s, dtype=torch.bfloat16) * 0.8)(Dm, H, Dh) * Dm ** (-0.5)), 'Wo': _w((lambda *s: torch.randn(*s, dtype=torch.bfloat16) * 0.8)(H, Dh, Dm) * (H * Dh) ** (-0.5)), 'seg_len': seg}
    _A_in = _A_setup()

    def _B_setup():
        B, S, D, F = (1, 2048, 1024, 3584)
        return {'x': _w((lambda *s: torch.randn(*s, dtype=torch.bfloat16) * 0.05)(B, S, D)), 'w1': _w((lambda *s: torch.randn(*s, dtype=torch.bfloat16) * 3.2)(D, F) * D ** (-0.5)), 'b1': _w((lambda *s: torch.randn(*s, dtype=torch.bfloat16) * 0.8)(F)), 'w2': _w((lambda *s: torch.randn(*s, dtype=torch.bfloat16) * 0.1)(F, D) * F ** (-0.5)), 'b2': _w((lambda *s: torch.randn(*s, dtype=torch.bfloat16) * 0.1)(D))}
    _B_in = _B_setup()
    return {'A_x': _A_in['x'], 'A_mem0': _A_in['mem0'], 'A_Wq': _A_in['Wq'], 'A_Wk': _A_in['Wk'], 'A_Wv': _A_in['Wv'], 'A_Wo': _A_in['Wo'], 'A_seg_len': _A_in['seg_len'], 'B_x': _B_in['x'], 'B_w1': _B_in['w1'], 'B_b1': _B_in['b1'], 'B_w2': _B_in['w2'], 'B_b2': _B_in['b2']}

def reference(A_x, A_mem0, A_Wq, A_Wk, A_Wv, A_Wo, A_seg_len, B_x, B_w1, B_b1, B_w2, B_b2):

    def _A_ref(x, mem0, Wq, Wk, Wv, Wo, seg_len):
        B, S, Dm = x.shape
        H, Dh = (Wq.shape[1], Wq.shape[2])
        M = mem0.shape[1]
        scale = Dh ** (-0.5)
        n_seg = S // seg_len
        L = M + seg_len
        idx = torch.arange(L)
        mask = (idx[:, None] < M) | (idx[:, None] >= idx[None, :])
        mem = mem0
        outs = []
        for s in range(n_seg):
            xs = x[:, s * seg_len:(s + 1) * seg_len, :].clone()
            h = torch.concatenate([mem, xs], axis=1)
            q = torch.einsum('btd,dhe->bhte', h, Wq)
            k = torch.einsum('btd,dhe->bhte', h, Wk)
            v = torch.einsum('btd,dhe->bhte', h, Wv)
            scores = torch.einsum('bhqe,bhke->bhqk', q, k) * scale
            scores = torch.where(mask[None, None], scores, -1000000000.0)
            p = _softmax(scores, axis=-1)
            o = torch.einsum('bhqk,bhke->bhqe', p, v)
            o = torch.einsum('bhte,hed->btd', o, Wo)
            mem = o[:, :M, :].clone()
            outs.append(o[:, M:, :])
        return torch.concatenate(outs, axis=1)

    def _B_ref(x, w1, b1, w2, b2):
        y = _layernorm(x, axis=-1)
        h = _gelu(torch.einsum('bsd,df->bsf', y, w1) + b1)
        return torch.einsum('bsf,fd->bsd', h, w2) + b2
    x = A_x
    x = x + _A_ref(_layernorm(x, axis=-1), A_mem0, A_Wq, A_Wk, A_Wv, A_Wo, A_seg_len)
    x = x + _B_ref(_layernorm(x, axis=-1), B_w1, B_b1, B_w2, B_b2)
    x = x + _A_ref(_layernorm(x, axis=-1), A_mem0, A_Wq, A_Wk, A_Wv, A_Wo, A_seg_len)
    x = x + _B_ref(_layernorm(x, axis=-1), B_w1, B_b1, B_w2, B_b2)
    return x
```

```asm
; @launch kernel=ln1a_kernel grid=(512,1,1) block=(256,1,1) lds=0
; @launch kernel=gqkv_kernel grid=(768,1,1) block=(512,1,1) lds=147456
; @launch kernel=zero_kernel grid=(1024,1,1) block=(256,1,1) lds=0
; @launch kernel=rec_kernel grid=(256,1,1) block=(256,1,1) lds=131072
; @launch kernel=att_kernel grid=(512,1,1) block=(256,1,1) lds=32768
; @launch kernel=goa_kernel grid=(256,1,1) block=(256,1,1) lds=73728
; @launch kernel=ln2_kernel grid=(512,1,1) block=(256,1,1) lds=0
; @launch kernel=g1_kernel grid=(224,1,1) block=(256,1,1) lds=147456
; @launch kernel=g2a_kernel grid=(256,1,1) block=(256,1,1) lds=73728
; @launch kernel=ln1b_kernel grid=(512,1,1) block=(256,1,1) lds=0
; @launch kernel=gqkv_kernel grid=(768,1,1) block=(512,1,1) lds=147456
; @launch kernel=zero_kernel grid=(1024,1,1) block=(256,1,1) lds=0
; @launch kernel=rec_kernel grid=(256,1,1) block=(256,1,1) lds=131072
; @launch kernel=att_kernel grid=(512,1,1) block=(256,1,1) lds=32768
; @launch kernel=gob_kernel grid=(256,1,1) block=(256,1,1) lds=73728
; @launch kernel=ln2_kernel grid=(512,1,1) block=(256,1,1) lds=0
; @launch kernel=g1_kernel grid=(224,1,1) block=(256,1,1) lds=147456
; @launch kernel=g2b_kernel grid=(256,1,1) block=(256,1,1) lds=73728
.amdgcn_target "amdgcn-amd-amdhsa--gfx950"
.text
.globl ln1a_kernel
.p2align 8
.type ln1a_kernel,@function
ln1a_kernel:
    s_cmp_ge_u32 s2, 512
    s_cbranch_scc1 ln1a_kernel_done1
    s_load_dwordx2 s[4:5], s[0:1], 112
    s_load_dwordx2 s[6:7], s[0:1], 0
    s_waitcnt lgkmcnt(0)
    s_mov_b32 s8, s6
    s_and_b32 s9, s7, 0xffff
    s_mov_b32 s10, 4194304
    s_mov_b32 s11, 0x00020000
    s_add_u32 s12, s4, 0
    s_addc_u32 s13, s5, 0
    s_and_b32 s13, s13, 0xffff
    s_mov_b32 s14, 4194304
    s_mov_b32 s15, 0x00020000
    v_and_b32 v1, 63, v0
    v_lshrrev_b32 v2, 6, v0
    s_lshl_b32 s3, s2, 2
    v_add_u32 v2, s3, v2
    v_lshlrev_b32 v3, 11, v2
    v_lshl_add_u32 v3, v1, 4, v3
    buffer_load_dwordx4 v[4:7], v3, s[8:11], 0 offen
    buffer_load_dwordx4 v[8:11], v3, s[8:11], 0 offen offset:1024
    v_xor_b32 v50, 1, v1
    v_lshlrev_b32 v50, 2, v50
    v_xor_b32 v51, 2, v1
    v_lshlrev_b32 v51, 2, v51
    v_xor_b32 v52, 4, v1
    v_lshlrev_b32 v52, 2, v52
    v_xor_b32 v53, 8, v1
    v_lshlrev_b32 v53, 2, v53
    v_xor_b32 v54, 16, v1
    v_lshlrev_b32 v54, 2, v54
    v_xor_b32 v55, 32, v1
    v_lshlrev_b32 v55, 2, v55
    s_waitcnt vmcnt(0)
    v_lshlrev_b32 v16, 16, v4
    v_and_b32 v17, 0xffff0000, v4
    v_lshlrev_b32 v18, 16, v5
    v_and_b32 v19, 0xffff0000, v5
    v_lshlrev_b32 v20, 16, v6
    v_and_b32 v21, 0xffff0000, v6
    v_lshlrev_b32 v22, 16, v7
    v_and_b32 v23, 0xffff0000, v7
    v_lshlrev_b32 v24, 16, v8
    v_and_b32 v25, 0xffff0000, v8
    v_lshlrev_b32 v26, 16, v9
    v_and_b32 v27, 0xffff0000, v9
    v_lshlrev_b32 v28, 16, v10
    v_and_b32 v29, 0xffff0000, v10
    v_lshlrev_b32 v30, 16, v11
    v_and_b32 v31, 0xffff0000, v11
    v_add_f32 v40, v16, v17
    v_add_f32 v40, v40, v18
    v_add_f32 v40, v40, v19
    v_add_f32 v40, v40, v20
    v_add_f32 v40, v40, v21
    v_add_f32 v40, v40, v22
    v_add_f32 v40, v40, v23
    v_add_f32 v40, v40, v24
    v_add_f32 v40, v40, v25
    v_add_f32 v40, v40, v26
    v_add_f32 v40, v40, v27
    v_add_f32 v40, v40, v28
    v_add_f32 v40, v40, v29
    v_add_f32 v40, v40, v30
    v_add_f32 v40, v40, v31
    ds_bpermute_b32 v48, v50, v40
    s_waitcnt lgkmcnt(0)
    v_add_f32 v40, v40, v48
    ds_bpermute_b32 v48, v51, v40
    s_waitcnt lgkmcnt(0)
    v_add_f32 v40, v40, v48
    ds_bpermute_b32 v48, v52, v40
    s_waitcnt lgkmcnt(0)
    v_add_f32 v40, v40, v48
    ds_bpermute_b32 v48, v53, v40
    s_waitcnt lgkmcnt(0)
    v_add_f32 v40, v40, v48
    ds_bpermute_b32 v48, v54, v40
    s_waitcnt lgkmcnt(0)
    v_add_f32 v40, v40, v48
    ds_bpermute_b32 v48, v55, v40
    s_waitcnt lgkmcnt(0)
    v_add_f32 v40, v40, v48
    v_mul_f32 v40, 0x3a800000, v40
    v_sub_f32 v41, v16, v40
    v_mul_f32 v42, v41, v41
    v_sub_f32 v41, v17, v40
    v_fmac_f32 v42, v41, v41
    v_sub_f32 v41, v18, v40
    v_fmac_f32 v42, v41, v41
    v_sub_f32 v41, v19, v40
    v_fmac_f32 v42, v41, v41
    v_sub_f32 v41, v20, v40
    v_fmac_f32 v42, v41, v41
    v_sub_f32 v41, v21, v40
    v_fmac_f32 v42, v41, v41
    v_sub_f32 v41, v22, v40
    v_fmac_f32 v42, v41, v41
    v_sub_f32 v41, v23, v40
    v_fmac_f32 v42, v41, v41
    v_sub_f32 v41, v24, v40
    v_fmac_f32 v42, v41, v41
    v_sub_f32 v41, v25, v40
    v_fmac_f32 v42, v41, v41
    v_sub_f32 v41, v26, v40
    v_fmac_f32 v42, v41, v41
    v_sub_f32 v41, v27, v40
    v_fmac_f32 v42, v41, v41
    v_sub_f32 v41, v28, v40
    v_fmac_f32 v42, v41, v41
    v_sub_f32 v41, v29, v40
    v_fmac_f32 v42, v41, v41
    v_sub_f32 v41, v30, v40
    v_fmac_f32 v42, v41, v41
    v_sub_f32 v41, v31, v40
    v_fmac_f32 v42, v41, v41
    ds_bpermute_b32 v48, v50, v42
    s_waitcnt lgkmcnt(0)
    v_add_f32 v42, v42, v48
    ds_bpermute_b32 v48, v51, v42
    s_waitcnt lgkmcnt(0)
    v_add_f32 v42, v42, v48
    ds_bpermute_b32 v48, v52, v42
    s_waitcnt lgkmcnt(0)
    v_add_f32 v42, v42, v48
    ds_bpermute_b32 v48, v53, v42
    s_waitcnt lgkmcnt(0)
    v_add_f32 v42, v42, v48
    ds_bpermute_b32 v48, v54, v42
    s_waitcnt lgkmcnt(0)
    v_add_f32 v42, v42, v48
    ds_bpermute_b32 v48, v55, v42
    s_waitcnt lgkmcnt(0)
    v_add_f32 v42, v42, v48
    v_mul_f32 v42, 0x3a800000, v42
    v_cvt_pk_bf16_f32 v40, v40, v40
    v_lshlrev_b32 v40, 16, v40
    v_cvt_pk_bf16_f32 v42, v42, v42
    v_lshlrev_b32 v42, 16, v42
    v_add_f32 v42, 0x3727c5ac, v42
    v_cvt_pk_bf16_f32 v42, v42, v42
    v_lshlrev_b32 v42, 16, v42
    v_sqrt_f32 v42, v42
    s_nop 0
    v_cvt_pk_bf16_f32 v42, v42, v42
    v_lshlrev_b32 v42, 16, v42
    v_rcp_f32 v43, v42
    s_nop 0
    v_fma_f32 v44, -v42, v43, 2.0
    v_mul_f32 v43, v43, v44
    v_sub_f32 v16, v16, v40
    v_sub_f32 v17, v17, v40
    v_cvt_pk_bf16_f32 v44, v16, v17
    v_lshlrev_b32 v16, 16, v44
    v_and_b32 v17, 0xffff0000, v44
    v_mul_f32 v16, v16, v43
    v_mul_f32 v17, v17, v43
    v_cvt_pk_bf16_f32 v4, v16, v17
    v_lshlrev_b32 v16, 16, v4
    v_and_b32 v17, 0xffff0000, v4
    v_sub_f32 v18, v18, v40
    v_sub_f32 v19, v19, v40
    v_cvt_pk_bf16_f32 v44, v18, v19
    v_lshlrev_b32 v18, 16, v44
    v_and_b32 v19, 0xffff0000, v44
    v_mul_f32 v18, v18, v43
    v_mul_f32 v19, v19, v43
    v_cvt_pk_bf16_f32 v5, v18, v19
    v_lshlrev_b32 v18, 16, v5
    v_and_b32 v19, 0xffff0000, v5
    v_sub_f32 v20, v20, v40
    v_sub_f32 v21, v21, v40
    v_cvt_pk_bf16_f32 v44, v20, v21
    v_lshlrev_b32 v20, 16, v44
    v_and_b32 v21, 0xffff0000, v44
    v_mul_f32 v20, v20, v43
    v_mul_f32 v21, v21, v43
    v_cvt_pk_bf16_f32 v6, v20, v21
    v_lshlrev_b32 v20, 16, v6
    v_and_b32 v21, 0xffff0000, v6
    v_sub_f32 v22, v22, v40
    v_sub_f32 v23, v23, v40
    v_cvt_pk_bf16_f32 v44, v22, v23
    v_lshlrev_b32 v22, 16, v44
    v_and_b32 v23, 0xffff0000, v44
    v_mul_f32 v22, v22, v43
    v_mul_f32 v23, v23, v43
    v_cvt_pk_bf16_f32 v7, v22, v23
    v_lshlrev_b32 v22, 16, v7
    v_and_b32 v23, 0xffff0000, v7
    v_sub_f32 v24, v24, v40
    v_sub_f32 v25, v25, v40
    v_cvt_pk_bf16_f32 v44, v24, v25
    v_lshlrev_b32 v24, 16, v44
    v_and_b32 v25, 0xffff0000, v44
    v_mul_f32 v24, v24, v43
    v_mul_f32 v25, v25, v43
    v_cvt_pk_bf16_f32 v8, v24, v25
    v_lshlrev_b32 v24, 16, v8
    v_and_b32 v25, 0xffff0000, v8
    v_sub_f32 v26, v26, v40
    v_sub_f32 v27, v27, v40
    v_cvt_pk_bf16_f32 v44, v26, v27
    v_lshlrev_b32 v26, 16, v44
    v_and_b32 v27, 0xffff0000, v44
    v_mul_f32 v26, v26, v43
    v_mul_f32 v27, v27, v43
    v_cvt_pk_bf16_f32 v9, v26, v27
    v_lshlrev_b32 v26, 16, v9
    v_and_b32 v27, 0xffff0000, v9
    v_sub_f32 v28, v28, v40
    v_sub_f32 v29, v29, v40
    v_cvt_pk_bf16_f32 v44, v28, v29
    v_lshlrev_b32 v28, 16, v44
    v_and_b32 v29, 0xffff0000, v44
    v_mul_f32 v28, v28, v43
    v_mul_f32 v29, v29, v43
    v_cvt_pk_bf16_f32 v10, v28, v29
    v_lshlrev_b32 v28, 16, v10
    v_and_b32 v29, 0xffff0000, v10
    v_sub_f32 v30, v30, v40
    v_sub_f32 v31, v31, v40
    v_cvt_pk_bf16_f32 v44, v30, v31
    v_lshlrev_b32 v30, 16, v44
    v_and_b32 v31, 0xffff0000, v44
    v_mul_f32 v30, v30, v43
    v_mul_f32 v31, v31, v43
    v_cvt_pk_bf16_f32 v11, v30, v31
    v_lshlrev_b32 v30, 16, v11
    v_and_b32 v31, 0xffff0000, v11
    buffer_store_dwordx4 v[4:7], v3, s[12:15], 0 offen
    buffer_store_dwordx4 v[8:11], v3, s[12:15], 0 offen offset:1024
ln1a_kernel_done1:
    s_endpgm
.globl gqkv_kernel
.p2align 8
.type gqkv_kernel,@function
gqkv_kernel:
    s_cmp_ge_u32 s2, 768
    s_cbranch_scc1 gqkv_kernel_done1
    s_load_dwordx2 s[4:5], s[0:1], 112
    s_load_dwordx2 s[40:41], s[0:1], 16
    s_load_dwordx2 s[42:43], s[0:1], 24
    s_load_dwordx2 s[44:45], s[0:1], 32
    s_mov_b32 s34, 44739243
    s_mul_hi_u32 s35, s2, s34
    s_mul_i32 s36, s35, 96
    s_sub_u32 s34, s2, s36
    v_and_b32 v1, 63, v0
    v_lshrrev_b32 v17, 6, v0
    s_nop 0
    v_readfirstlane_b32 s37, v17
    s_waitcnt lgkmcnt(0)
    s_mul_i32 s38, s35, 524288
    s_add_u32 s38, s38, 0
    s_add_u32 s8, s4, s38
    s_addc_u32 s9, s5, 0
    s_and_b32 s9, s9, 0xffff
    s_mov_b32 s10, 524288
    s_mov_b32 s11, 0x00020000
    s_mul_i32 s38, s34, 128
    s_add_u32 s38, s38, 0
    s_lshr_b32 s39, s38, 12
    s_and_b32 s38, s38, 4095
    s_cmp_eq_u32 s39, 1
    s_cselect_b32 s54, s42, s40
    s_cselect_b32 s55, s43, s41
    s_cmp_eq_u32 s39, 2
    s_cselect_b32 s54, s44, s54
    s_cselect_b32 s55, s45, s55
    s_lshl_b32 s38, s38, 1
    s_add_u32 s12, s54, s38
    s_addc_u32 s13, s55, 0
    s_and_b32 s13, s13, 0xffff
    s_sub_u32 s14, 8388608, s38
    s_mov_b32 s15, 0x00020000
    s_mul_i32 s38, s34, 128
    s_add_u32 s38, s38, 64
    s_lshr_b32 s39, s38, 12
    s_and_b32 s38, s38, 4095
    s_cmp_eq_u32 s39, 1
    s_cselect_b32 s54, s42, s40
    s_cselect_b32 s55, s43, s41
    s_cmp_eq_u32 s39, 2
    s_cselect_b32 s54, s44, s54
    s_cselect_b32 s55, s45, s55
    s_lshl_b32 s38, s38, 1
    s_add_u32 s16, s54, s38
    s_addc_u32 s17, s55, 0
    s_and_b32 s17, s17, 0xffff
    s_sub_u32 s18, 8388608, s38
    s_mov_b32 s19, 0x00020000
    s_add_u32 s28, s4, 4194304
    s_addc_u32 s29, s5, 0
    s_and_b32 s29, s29, 0xffff
    s_mov_b32 s30, 50331648
    s_mov_b32 s31, 0x00020000
    v_lshrrev_b32 v17, 3, v1
    v_and_b32 v18, 7, v1
    v_lshrrev_b32 v19, 4, v1
    v_xor_b32 v20, v18, v19
    v_xor_b32 v21, 4, v20
    s_mov_b32 s38, 2048
    v_mul_lo_u32 v22, s38, v17
    v_lshl_add_u32 v2, v20, 4, v22
    v_lshl_add_u32 v3, v21, 4, v22
    v_and_b32 v20, 1, v19
    v_lshlrev_b32 v20, 2, v20
    v_xor_b32 v20, v18, v20
    s_mov_b32 s38, 8192
    v_mul_lo_u32 v22, s38, v17
    v_lshl_add_u32 v4, v20, 4, v22
    s_and_b32 s38, s37, 3
    s_lshr_b32 s39, s37, 2
    v_and_b32 v17, 31, v1
    v_lshrrev_b32 v18, 5, v1
    v_lshrrev_b32 v19, 1, v17
    v_and_b32 v19, 7, v19
    s_mul_i32 s54, s38, 8192
    v_add_u32 v20, 0, v18
    v_xor_b32 v20, v20, v19
    v_lshlrev_b32 v20, 4, v20
    v_lshl_add_u32 v20, v17, 7, v20
    v_add_u32 v5, s54, v20
    v_add_u32 v20, 2, v18
    v_xor_b32 v20, v20, v19
    v_lshlrev_b32 v20, 4, v20
    v_lshl_add_u32 v20, v17, 7, v20
    v_add_u32 v6, s54, v20
    v_add_u32 v20, 4, v18
    v_xor_b32 v20, v20, v19
    v_lshlrev_b32 v20, 4, v20
    v_lshl_add_u32 v20, v17, 7, v20
    v_add_u32 v7, s54, v20
    v_add_u32 v20, 6, v18
    v_xor_b32 v20, v20, v19
    v_lshlrev_b32 v20, 4, v20
    v_lshl_add_u32 v20, v17, 7, v20
    v_add_u32 v8, s54, v20
    v_and_b32 v17, 15, v1
    v_lshrrev_b32 v19, 2, v17
    v_and_b32 v20, 3, v17
    v_bfe_u32 v21, v1, 4, 1
    v_lshlrev_b32 v22, 1, v21
    v_lshrrev_b32 v23, 1, v20
    v_add_u32 v22, v22, v23
    v_bfe_u32 v23, v19, 1, 1
    v_lshlrev_b32 v23, 2, v23
    v_xor_b32 v22, v22, v23
    v_lshlrev_b32 v22, 4, v22
    v_and_b32 v23, 1, v20
    v_lshl_add_u32 v22, v23, 3, v22
    v_lshl_add_u32 v23, v18, 3, v19
    v_lshl_add_u32 v22, v23, 7, v22
    v_add_u32 v9, 32768, v22
    v_xor_b32 v10, 64, v9
    s_mul_i32 s55, s39, 2
    v_accvgpr_write_b32 a0, 0
    v_accvgpr_write_b32 a1, 0
    v_accvgpr_write_b32 a2, 0
    v_accvgpr_write_b32 a3, 0
    v_accvgpr_write_b32 a4, 0
    v_accvgpr_write_b32 a5, 0
    v_accvgpr_write_b32 a6, 0
    v_accvgpr_write_b32 a7, 0
    v_accvgpr_write_b32 a8, 0
    v_accvgpr_write_b32 a9, 0
    v_accvgpr_write_b32 a10, 0
    v_accvgpr_write_b32 a11, 0
    v_accvgpr_write_b32 a12, 0
    v_accvgpr_write_b32 a13, 0
    v_accvgpr_write_b32 a14, 0
    v_accvgpr_write_b32 a15, 0
    v_accvgpr_write_b32 a16, 0
    v_accvgpr_write_b32 a17, 0
    v_accvgpr_write_b32 a18, 0
    v_accvgpr_write_b32 a19, 0
    v_accvgpr_write_b32 a20, 0
    v_accvgpr_write_b32 a21, 0
    v_accvgpr_write_b32 a22, 0
    v_accvgpr_write_b32 a23, 0
    v_accvgpr_write_b32 a24, 0
    v_accvgpr_write_b32 a25, 0
    v_accvgpr_write_b32 a26, 0
    v_accvgpr_write_b32 a27, 0
    v_accvgpr_write_b32 a28, 0
    v_accvgpr_write_b32 a29, 0
    v_accvgpr_write_b32 a30, 0
    v_accvgpr_write_b32 a31, 0
    v_accvgpr_write_b32 a32, 0
    v_accvgpr_write_b32 a33, 0
    v_accvgpr_write_b32 a34, 0
    v_accvgpr_write_b32 a35, 0
    v_accvgpr_write_b32 a36, 0
    v_accvgpr_write_b32 a37, 0
    v_accvgpr_write_b32 a38, 0
    v_accvgpr_write_b32 a39, 0
    v_accvgpr_write_b32 a40, 0
    v_accvgpr_write_b32 a41, 0
    v_accvgpr_write_b32 a42, 0
    v_accvgpr_write_b32 a43, 0
    v_accvgpr_write_b32 a44, 0
    v_accvgpr_write_b32 a45, 0
    v_accvgpr_write_b32 a46, 0
    v_accvgpr_write_b32 a47, 0
    v_accvgpr_write_b32 a48, 0
    v_accvgpr_write_b32 a49, 0
    v_accvgpr_write_b32 a50, 0
    v_accvgpr_write_b32 a51, 0
    v_accvgpr_write_b32 a52, 0
    v_accvgpr_write_b32 a53, 0
    v_accvgpr_write_b32 a54, 0
    v_accvgpr_write_b32 a55, 0
    v_accvgpr_write_b32 a56, 0
    v_accvgpr_write_b32 a57, 0
    v_accvgpr_write_b32 a58, 0
    v_accvgpr_write_b32 a59, 0
    v_accvgpr_write_b32 a60, 0
    v_accvgpr_write_b32 a61, 0
    v_accvgpr_write_b32 a62, 0
    v_accvgpr_write_b32 a63, 0
    s_mul_i32 s67, s37, 4
    s_mul_i32 s68, s37, 2
    s_mov_b32 s64, 0
    s_mov_b32 s65, 0
    s_mov_b32 s66, 0
    s_add_u32 s69, s67, 0
    s_mul_i32 s70, s69, 16384
    s_add_u32 s70, s70, s64
    s_lshl_b32 s69, s69, 10
    s_add_u32 m0, s69, s66
    buffer_load_dwordx4 v2, s[8:11], s70 offen lds
    s_add_u32 s69, s67, 1
    s_mul_i32 s70, s69, 16384
    s_add_u32 s70, s70, s64
    s_lshl_b32 s69, s69, 10
    s_add_u32 m0, s69, s66
    buffer_load_dwordx4 v3, s[8:11], s70 offen lds
    s_add_u32 s69, s67, 2
    s_mul_i32 s70, s69, 16384
    s_add_u32 s70, s70, s64
    s_lshl_b32 s69, s69, 10
    s_add_u32 m0, s69, s66
    buffer_load_dwordx4 v2, s[8:11], s70 offen lds
    s_add_u32 s69, s67, 3
    s_mul_i32 s70, s69, 16384
    s_add_u32 s70, s70, s64
    s_lshl_b32 s69, s69, 10
    s_add_u32 m0, s69, s66
    buffer_load_dwordx4 v3, s[8:11], s70 offen lds
    s_add_u32 s69, s68, 0
    s_and_b32 s71, s69, 7
    s_mul_i32 s70, s71, 65536
    s_add_u32 s70, s70, s65
    s_lshl_b32 s72, s69, 10
    s_add_u32 s72, s72, s66
    s_add_u32 m0, s72, 32768
    s_lshr_b32 s69, s69, 3
    s_cmp_lg_u32 s69, 0
    s_cbranch_scc1 gqkv_kernel_wb3
    buffer_load_dwordx4 v4, s[12:15], s70 offen lds
    s_branch gqkv_kernel_we2
gqkv_kernel_wb3:
    buffer_load_dwordx4 v4, s[16:19], s70 offen lds
gqkv_kernel_we2:
    s_add_u32 s69, s68, 1
    s_and_b32 s71, s69, 7
    s_mul_i32 s70, s71, 65536
    s_add_u32 s70, s70, s65
    s_lshl_b32 s72, s69, 10
    s_add_u32 s72, s72, s66
    s_add_u32 m0, s72, 32768
    s_lshr_b32 s69, s69, 3
    s_cmp_lg_u32 s69, 0
    s_cbranch_scc1 gqkv_kernel_wb6
    buffer_load_dwordx4 v4, s[12:15], s70 offen lds
    s_branch gqkv_kernel_we5
gqkv_kernel_wb6:
    buffer_load_dwordx4 v4, s[16:19], s70 offen lds
gqkv_kernel_we5:
    s_mov_b32 s64, 128
    s_mov_b32 s65, 524288
    s_mov_b32 s66, 49152
    s_add_u32 s69, s67, 0
    s_mul_i32 s70, s69, 16384
    s_add_u32 s70, s70, s64
    s_lshl_b32 s69, s69, 10
    s_add_u32 m0, s69, s66
    buffer_load_dwordx4 v2, s[8:11], s70 offen lds
    s_add_u32 s69, s67, 1
    s_mul_i32 s70, s69, 16384
    s_add_u32 s70, s70, s64
    s_lshl_b32 s69, s69, 10
    s_add_u32 m0, s69, s66
    buffer_load_dwordx4 v3, s[8:11], s70 offen lds
    s_add_u32 s69, s67, 2
    s_mul_i32 s70, s69, 16384
    s_add_u32 s70, s70, s64
    s_lshl_b32 s69, s69, 10
    s_add_u32 m0, s69, s66
    buffer_load_dwordx4 v2, s[8:11], s70 offen lds
    s_add_u32 s69, s67, 3
    s_mul_i32 s70, s69, 16384
    s_add_u32 s70, s70, s64
    s_lshl_b32 s69, s69, 10
    s_add_u32 m0, s69, s66
    buffer_load_dwordx4 v3, s[8:11], s70 offen lds
    s_add_u32 s69, s68, 0
    s_and_b32 s71, s69, 7
    s_mul_i32 s70, s71, 65536
    s_add_u32 s70, s70, s65
    s_lshl_b32 s72, s69, 10
    s_add_u32 s72, s72, s66
    s_add_u32 m0, s72, 32768
    s_lshr_b32 s69, s69, 3
    s_cmp_lg_u32 s69, 0
    s_cbranch_scc1 gqkv_kernel_wb9
    buffer_load_dwordx4 v4, s[12:15], s70 offen lds
    s_branch gqkv_kernel_we8
gqkv_kernel_wb9:
    buffer_load_dwordx4 v4, s[16:19], s70 offen lds
gqkv_kernel_we8:
    s_add_u32 s69, s68, 1
    s_and_b32 s71, s69, 7
    s_mul_i32 s70, s71, 65536
    s_add_u32 s70, s70, s65
    s_lshl_b32 s72, s69, 10
    s_add_u32 s72, s72, s66
    s_add_u32 m0, s72, 32768
    s_lshr_b32 s69, s69, 3
    s_cmp_lg_u32 s69, 0
    s_cbranch_scc1 gqkv_kernel_wb12
    buffer_load_dwordx4 v4, s[12:15], s70 offen lds
    s_branch gqkv_kernel_we11
gqkv_kernel_wb12:
    buffer_load_dwordx4 v4, s[16:19], s70 offen lds
gqkv_kernel_we11:
    s_mov_b32 s73, 0
    s_mov_b32 s74, 0
    s_mov_b32 s66, 98304
gqkv_kernel_loop14:
    s_waitcnt vmcnt(6)
    s_barrier
    s_add_u32 s64, s64, 128
    s_add_u32 s65, s65, 524288
    s_add_u32 s69, s67, 0
    s_mul_i32 s70, s69, 16384
    s_add_u32 s70, s70, s64
    s_lshl_b32 s69, s69, 10
    s_add_u32 m0, s69, s66
    buffer_load_dwordx4 v2, s[8:11], s70 offen lds
    s_add_u32 s69, s67, 1
    s_mul_i32 s70, s69, 16384
    s_add_u32 s70, s70, s64
    s_lshl_b32 s69, s69, 10
    s_add_u32 m0, s69, s66
    buffer_load_dwordx4 v3, s[8:11], s70 offen lds
    s_add_u32 s69, s67, 2
    s_mul_i32 s70, s69, 16384
    s_add_u32 s70, s70, s64
    s_lshl_b32 s69, s69, 10
    s_add_u32 m0, s69, s66
    buffer_load_dwordx4 v2, s[8:11], s70 offen lds
    s_add_u32 s69, s67, 3
    s_mul_i32 s70, s69, 16384
    s_add_u32 s70, s70, s64
    s_lshl_b32 s69, s69, 10
    s_add_u32 m0, s69, s66
    buffer_load_dwordx4 v3, s[8:11], s70 offen lds
    s_add_u32 s69, s68, 0
    s_and_b32 s71, s69, 7
    s_mul_i32 s70, s71, 65536
    s_add_u32 s70, s70, s65
    s_lshl_b32 s72, s69, 10
    s_add_u32 s72, s72, s66
    s_add_u32 m0, s72, 32768
    s_lshr_b32 s69, s69, 3
    s_cmp_lg_u32 s69, 0
    s_cbranch_scc1 gqkv_kernel_wb16
    buffer_load_dwordx4 v4, s[12:15], s70 offen lds
    s_branch gqkv_kernel_we15
gqkv_kernel_wb16:
    buffer_load_dwordx4 v4, s[16:19], s70 offen lds
gqkv_kernel_we15:
    s_add_u32 s69, s68, 1
    s_and_b32 s71, s69, 7
    s_mul_i32 s70, s71, 65536
    s_add_u32 s70, s70, s65
    s_lshl_b32 s72, s69, 10
    s_add_u32 s72, s72, s66
    s_add_u32 m0, s72, 32768
    s_lshr_b32 s69, s69, 3
    s_cmp_lg_u32 s69, 0
    s_cbranch_scc1 gqkv_kernel_wb19
    buffer_load_dwordx4 v4, s[12:15], s70 offen lds
    s_branch gqkv_kernel_we18
gqkv_kernel_wb19:
    buffer_load_dwordx4 v4, s[16:19], s70 offen lds
gqkv_kernel_we18:
    s_add_u32 s66, s66, 49152
    s_cmp_ge_u32 s66, 147456
    s_cselect_b32 s75, 147456, 0
    s_sub_u32 s66, s66, s75
    v_add_u32 v11, s74, v5
    v_add_u32 v12, s74, v6
    v_add_u32 v13, s74, v7
    v_add_u32 v14, s74, v8
    v_add_u32 v15, s74, v9
    v_add_u32 v16, s74, v10
    s_add_u32 s76, s55, 0
    s_and_b32 s77, s76, 1
    s_lshr_b32 s76, s76, 1
    s_mul_i32 s76, s76, 8192
    s_cmp_eq_u32 s77, 0
    s_cselect_b64 s[78:79], -1, 0
    v_cndmask_b32 v17, v16, v15, s[78:79]
    v_add_u32 v17, s76, v17
    s_add_u32 s76, s55, 1
    s_and_b32 s77, s76, 1
    s_lshr_b32 s76, s76, 1
    s_mul_i32 s76, s76, 8192
    s_cmp_eq_u32 s77, 0
    s_cselect_b64 s[78:79], -1, 0
    v_cndmask_b32 v18, v16, v15, s[78:79]
    v_add_u32 v18, s76, v18
    ds_read_b128 v[24:27], v11 offset:0
    ds_read_b128 v[28:31], v11 offset:4096
    ds_read_b64_tr_b16 v[40:41], v17 offset:0
    ds_read_b64_tr_b16 v[42:43], v17 offset:512
    ds_read_b64_tr_b16 v[44:45], v18 offset:0
    ds_read_b64_tr_b16 v[46:47], v18 offset:512
    ds_read_b128 v[32:35], v12 offset:0
    ds_read_b128 v[36:39], v12 offset:4096
    ds_read_b64_tr_b16 v[48:49], v17 offset:2048
    ds_read_b64_tr_b16 v[50:51], v17 offset:2560
    ds_read_b64_tr_b16 v[52:53], v18 offset:2048
    ds_read_b64_tr_b16 v[54:55], v18 offset:2560
    s_waitcnt lgkmcnt(6)
    v_mfma_f32_32x32x16_bf16 a[0:15], v[40:43], v[24:27], a[0:15]
    v_mfma_f32_32x32x16_bf16 a[16:31], v[44:47], v[24:27], a[16:31]
    v_mfma_f32_32x32x16_bf16 a[32:47], v[40:43], v[28:31], a[32:47]
    v_mfma_f32_32x32x16_bf16 a[48:63], v[44:47], v[28:31], a[48:63]
    ds_read_b128 v[24:27], v13 offset:0
    ds_read_b128 v[28:31], v13 offset:4096
    ds_read_b64_tr_b16 v[40:41], v17 offset:4096
    ds_read_b64_tr_b16 v[42:43], v17 offset:4608
    ds_read_b64_tr_b16 v[44:45], v18 offset:4096
    ds_read_b64_tr_b16 v[46:47], v18 offset:4608
    s_waitcnt lgkmcnt(6)
    v_mfma_f32_32x32x16_bf16 a[0:15], v[48:51], v[32:35], a[0:15]
    v_mfma_f32_32x32x16_bf16 a[16:31], v[52:55], v[32:35], a[16:31]
    v_mfma_f32_32x32x16_bf16 a[32:47], v[48:51], v[36:39], a[32:47]
    v_mfma_f32_32x32x16_bf16 a[48:63], v[52:55], v[36:39], a[48:63]
    ds_read_b128 v[32:35], v14 offset:0
    ds_read_b128 v[36:39], v14 offset:4096
    ds_read_b64_tr_b16 v[48:49], v17 offset:6144
    ds_read_b64_tr_b16 v[50:51], v17 offset:6656
    ds_read_b64_tr_b16 v[52:53], v18 offset:6144
    ds_read_b64_tr_b16 v[54:55], v18 offset:6656
    s_waitcnt lgkmcnt(6)
    v_mfma_f32_32x32x16_bf16 a[0:15], v[40:43], v[24:27], a[0:15]
    v_mfma_f32_32x32x16_bf16 a[16:31], v[44:47], v[24:27], a[16:31]
    v_mfma_f32_32x32x16_bf16 a[32:47], v[40:43], v[28:31], a[32:47]
    v_mfma_f32_32x32x16_bf16 a[48:63], v[44:47], v[28:31], a[48:63]
    s_waitcnt lgkmcnt(0)
    v_mfma_f32_32x32x16_bf16 a[0:15], v[48:51], v[32:35], a[0:15]
    v_mfma_f32_32x32x16_bf16 a[16:31], v[52:55], v[32:35], a[16:31]
    v_mfma_f32_32x32x16_bf16 a[32:47], v[48:51], v[36:39], a[32:47]
    v_mfma_f32_32x32x16_bf16 a[48:63], v[52:55], v[36:39], a[48:63]
    s_add_u32 s74, s74, 49152
    s_cmp_ge_u32 s74, 147456
    s_cselect_b32 s75, 147456, 0
    s_sub_u32 s74, s74, s75
    s_add_u32 s73, s73, 1
    s_cmp_lt_u32 s73, 16
    s_cbranch_scc1 gqkv_kernel_loop14
    s_nop 15
    s_nop 3
    v_and_b32 v17, 31, v1
    v_lshrrev_b32 v18, 5, v1
    s_mul_i32 s64, s35, 256
    s_mul_i32 s65, s38, 64
    s_add_u32 s64, s64, s65
    v_add_u32 v17, s64, v17
    s_mov_b32 s65, 24576
    v_mul_lo_u32 v17, s65, v17
    s_mul_i32 s64, s34, 128
    s_lshl_b32 s65, s55, 5
    s_add_u32 s64, s64, s65
    v_lshlrev_b32 v18, 2, v18
    v_add_u32 v18, s64, v18
    v_lshlrev_b32 v18, 1, v18
    v_add_u32 v17, v17, v18
    v_accvgpr_read_b32 v24, a0
    v_accvgpr_read_b32 v25, a1
    v_accvgpr_read_b32 v26, a2
    v_accvgpr_read_b32 v27, a3
    v_cvt_pk_bf16_f32 v28, v24, v25
    v_cvt_pk_bf16_f32 v29, v26, v27
    s_mov_b32 s66, 0
    buffer_store_dwordx2 v[28:29], v17, s[28:31], s66 offen offset:0
    s_nop 1
    v_accvgpr_read_b32 v24, a4
    v_accvgpr_read_b32 v25, a5
    v_accvgpr_read_b32 v26, a6
    v_accvgpr_read_b32 v27, a7
    v_cvt_pk_bf16_f32 v28, v24, v25
    v_cvt_pk_bf16_f32 v29, v26, v27
    s_mov_b32 s66, 0
    buffer_store_dwordx2 v[28:29], v17, s[28:31], s66 offen offset:16
    s_nop 1
    v_accvgpr_read_b32 v24, a8
    v_accvgpr_read_b32 v25, a9
    v_accvgpr_read_b32 v26, a10
    v_accvgpr_read_b32 v27, a11
    v_cvt_pk_bf16_f32 v28, v24, v25
    v_cvt_pk_bf16_f32 v29, v26, v27
    s_mov_b32 s66, 0
    buffer_store_dwordx2 v[28:29], v17, s[28:31], s66 offen offset:32
    s_nop 1
    v_accvgpr_read_b32 v24, a12
    v_accvgpr_read_b32 v25, a13
    v_accvgpr_read_b32 v26, a14
    v_accvgpr_read_b32 v27, a15
    v_cvt_pk_bf16_f32 v28, v24, v25
    v_cvt_pk_bf16_f32 v29, v26, v27
    s_mov_b32 s66, 0
    buffer_store_dwordx2 v[28:29], v17, s[28:31], s66 offen offset:48
    s_nop 1
    v_accvgpr_read_b32 v24, a16
    v_accvgpr_read_b32 v25, a17
    v_accvgpr_read_b32 v26, a18
    v_accvgpr_read_b32 v27, a19
    v_cvt_pk_bf16_f32 v28, v24, v25
    v_cvt_pk_bf16_f32 v29, v26, v27
    s_mov_b32 s66, 0
    buffer_store_dwordx2 v[28:29], v17, s[28:31], s66 offen offset:64
    s_nop 1
    v_accvgpr_read_b32 v24, a20
    v_accvgpr_read_b32 v25, a21
    v_accvgpr_read_b32 v26, a22
    v_accvgpr_read_b32 v27, a23
    v_cvt_pk_bf16_f32 v28, v24, v25
    v_cvt_pk_bf16_f32 v29, v26, v27
    s_mov_b32 s66, 0
    buffer_store_dwordx2 v[28:29], v17, s[28:31], s66 offen offset:80
    s_nop 1
    v_accvgpr_read_b32 v24, a24
    v_accvgpr_read_b32 v25, a25
    v_accvgpr_read_b32 v26, a26
    v_accvgpr_read_b32 v27, a27
    v_cvt_pk_bf16_f32 v28, v24, v25
    v_cvt_pk_bf16_f32 v29, v26, v27
    s_mov_b32 s66, 0
    buffer_store_dwordx2 v[28:29], v17, s[28:31], s66 offen offset:96
    s_nop 1
    v_accvgpr_read_b32 v24, a28
    v_accvgpr_read_b32 v25, a29
    v_accvgpr_read_b32 v26, a30
    v_accvgpr_read_b32 v27, a31
    v_cvt_pk_bf16_f32 v28, v24, v25
    v_cvt_pk_bf16_f32 v29, v26, v27
    s_mov_b32 s66, 0
    buffer_store_dwordx2 v[28:29], v17, s[28:31], s66 offen offset:112
    s_nop 1
    v_accvgpr_read_b32 v24, a32
    v_accvgpr_read_b32 v25, a33
    v_accvgpr_read_b32 v26, a34
    v_accvgpr_read_b32 v27, a35
    v_cvt_pk_bf16_f32 v28, v24, v25
    v_cvt_pk_bf16_f32 v29, v26, v27
    s_mov_b32 s66, 786432
    buffer_store_dwordx2 v[28:29], v17, s[28:31], s66 offen offset:0
    s_nop 1
    v_accvgpr_read_b32 v24, a36
    v_accvgpr_read_b32 v25, a37
    v_accvgpr_read_b32 v26, a38
    v_accvgpr_read_b32 v27, a39
    v_cvt_pk_bf16_f32 v28, v24, v25
    v_cvt_pk_bf16_f32 v29, v26, v27
    s_mov_b32 s66, 786432
    buffer_store_dwordx2 v[28:29], v17, s[28:31], s66 offen offset:16
    s_nop 1
    v_accvgpr_read_b32 v24, a40
    v_accvgpr_read_b32 v25, a41
    v_accvgpr_read_b32 v26, a42
    v_accvgpr_read_b32 v27, a43
    v_cvt_pk_bf16_f32 v28, v24, v25
    v_cvt_pk_bf16_f32 v29, v26, v27
    s_mov_b32 s66, 786432
    buffer_store_dwordx2 v[28:29], v17, s[28:31], s66 offen offset:32
    s_nop 1
    v_accvgpr_read_b32 v24, a44
    v_accvgpr_read_b32 v25, a45
    v_accvgpr_read_b32 v26, a46
    v_accvgpr_read_b32 v27, a47
    v_cvt_pk_bf16_f32 v28, v24, v25
    v_cvt_pk_bf16_f32 v29, v26, v27
    s_mov_b32 s66, 786432
    buffer_store_dwordx2 v[28:29], v17, s[28:31], s66 offen offset:48
    s_nop 1
    v_accvgpr_read_b32 v24, a48
    v_accvgpr_read_b32 v25, a49
    v_accvgpr_read_b32 v26, a50
    v_accvgpr_read_b32 v27, a51
    v_cvt_pk_bf16_f32 v28, v24, v25
    v_cvt_pk_bf16_f32 v29, v26, v27
    s_mov_b32 s66, 786432
    buffer_store_dwordx2 v[28:29], v17, s[28:31], s66 offen offset:64
    s_nop 1
    v_accvgpr_read_b32 v24, a52
    v_accvgpr_read_b32 v25, a53
    v_accvgpr_read_b32 v26, a54
    v_accvgpr_read_b32 v27, a55
    v_cvt_pk_bf16_f32 v28, v24, v25
    v_cvt_pk_bf16_f32 v29, v26, v27
    s_mov_b32 s66, 786432
    buffer_store_dwordx2 v[28:29], v17, s[28:31], s66 offen offset:80
    s_nop 1
    v_accvgpr_read_b32 v24, a56
    v_accvgpr_read_b32 v25, a57
    v_accvgpr_read_b32 v26, a58
    v_accvgpr_read_b32 v27, a59
    v_cvt_pk_bf16_f32 v28, v24, v25
    v_cvt_pk_bf16_f32 v29, v26, v27
    s_mov_b32 s66, 786432
    buffer_store_dwordx2 v[28:29], v17, s[28:31], s66 offen offset:96
    s_nop 1
    v_accvgpr_read_b32 v24, a60
    v_accvgpr_read_b32 v25, a61
    v_accvgpr_read_b32 v26, a62
    v_accvgpr_read_b32 v27, a63
    v_cvt_pk_bf16_f32 v28, v24, v25
    v_cvt_pk_bf16_f32 v29, v26, v27
    s_mov_b32 s66, 786432
    buffer_store_dwordx2 v[28:29], v17, s[28:31], s66 offen offset:112
    s_nop 1
gqkv_kernel_done1:
    s_endpgm
.globl zero_kernel
.p2align 8
.type zero_kernel,@function
zero_kernel:
    s_cmp_ge_u32 s2, 1024
    s_cbranch_scc1 zero_kernel_done1
    s_load_dwordx2 s[4:5], s[0:1], 112
    s_waitcnt lgkmcnt(0)
    s_add_u32 s8, s4, 113246208
    s_addc_u32 s9, s5, 0
    s_and_b32 s9, s9, 0xffff
    s_mov_b32 s10, 2097152
    s_mov_b32 s11, 0x00020000
    s_add_u32 s12, s4, 121634816
    s_addc_u32 s13, s5, 0
    s_and_b32 s13, s13, 0xffff
    s_mov_b32 s14, 2097152
    s_mov_b32 s15, 0x00020000
    s_lshl_b32 s3, s2, 8
    v_add_u32 v1, s3, v0
    v_lshlrev_b32 v1, 4, v1
    v_mov_b32 v4, 0
    v_mov_b32 v5, 0
    v_mov_b32 v6, 0
    v_mov_b32 v7, 0
    buffer_store_dwordx4 v[4:7], v1, s[8:11], 0 offen
    v_subrev_u32 v1, 2097152, v1
    buffer_store_dwordx4 v[4:7], v1, s[12:15], 0 offen
zero_kernel_done1:
    s_endpgm
.globl rec_kernel
.p2align 8
.type rec_kernel,@function
rec_kernel:
    s_cmp_ge_u32 s2, 256
    s_cbranch_scc1 rec_kernel_done1
    s_load_dwordx2 s[4:5], s[0:1], 112
    s_load_dwordx2 s[6:7], s[0:1], 8
    s_load_dwordx2 s[40:41], s[0:1], 16
    s_load_dwordx2 s[42:43], s[0:1], 24
    s_load_dwordx2 s[44:45], s[0:1], 32
    s_load_dwordx2 s[46:47], s[0:1], 40
    v_and_b32 v1, 63, v0
    v_lshrrev_b32 v2, 6, v0
    s_nop 0
    v_readfirstlane_b32 s36, v2
    v_and_b32 v2, 15, v1
    v_lshrrev_b32 v3, 4, v1
    s_waitcnt lgkmcnt(0)
    s_add_u32 s24, s4, 121634816
    s_addc_u32 s25, s5, 0
    s_and_b32 s25, s25, 0xffff
    s_mov_b32 s26, 524288
    s_mov_b32 s27, 0x00020000
    s_getreg_b32 s90, hwreg(HW_REG_XCC_ID)
    s_and_b32 s90, s90, 7
    v_mov_b32 v26, 1
    s_cmp_lg_u32 s36, 0
    s_cbranch_scc1 rec_kernel_tk2
    s_mov_b64 s[60:61], exec
    s_mov_b64 exec, 1
    s_lshl_b32 s91, s90, 7
    s_add_u32 s91, s91, 458752
    v_mov_b32 v27, s91
    v_mov_b32 v19, 1
    buffer_atomic_add v19, v27, s[24:27], 0 offen sc0 sc1
    s_waitcnt vmcnt(0)
    v_mov_b32 v27, 460800
    buffer_atomic_add v26, v27, s[24:27], 0 offen sc1
rec_kernel_ip3:
    buffer_load_dword v20, v27, s[24:27], 0 offen sc1
    s_waitcnt vmcnt(0)
    v_cmp_gt_u32 vcc, 256, v20
    s_cbranch_vccnz rec_kernel_ip3
    s_mov_b64 exec, 0xff
    v_lshlrev_b32 v27, 7, v1
    v_add_u32 v27, 458752, v27
    buffer_load_dword v20, v27, s[24:27], 0 offen sc1
    s_waitcnt vmcnt(0)
    v_cmp_ne_u32 vcc, 32, v20
    s_mov_b64 exec, 1
    v_mov_b32 v20, 0
    ds_write_b32 v20, v19
    v_mov_b32 v21, vcc_lo
    ds_write_b32 v20, v21 offset:4
    s_mov_b64 exec, s[60:61]
    s_waitcnt lgkmcnt(0)
rec_kernel_tk2:
    s_barrier
    v_mov_b32 v20, 0
    ds_read_b64 v[20:21], v20
    s_waitcnt lgkmcnt(0)
    v_readfirstlane_b32 s91, v20
    v_readfirstlane_b32 s92, v21
    s_barrier
    s_lshl_b32 s90, s90, 5
    s_add_u32 s90, s90, s91
    s_cmp_eq_u32 s92, 0
    s_cselect_b32 s93, 1, 0
    s_cmp_eq_u32 s93, 1
    s_cselect_b32 s90, s90, s2
    s_lshr_b32 s34, s90, 3
    s_and_b32 s35, s90, 7
    s_lshl_b32 s37, s34, 8
    s_lshl_b32 s38, s35, 5
    s_add_u32 s37, s37, s38
    s_add_u32 s8, s40, s37
    s_addc_u32 s9, s41, 0
    s_and_b32 s9, s9, 0xffff
    s_sub_u32 s10, 8388608, s37
    s_mov_b32 s11, 0x00020000
    s_add_u32 s12, s42, s37
    s_addc_u32 s13, s43, 0
    s_and_b32 s13, s13, 0xffff
    s_sub_u32 s14, 8388608, s37
    s_mov_b32 s15, 0x00020000
    s_add_u32 s16, s44, s37
    s_addc_u32 s17, s45, 0
    s_and_b32 s17, s17, 0xffff
    s_sub_u32 s18, 8388608, s37
    s_mov_b32 s19, 0x00020000
    s_lshl_b32 s38, s34, 18
    s_lshl_b32 s39, s35, 8
    s_add_u32 s38, s38, s39
    s_add_u32 s20, s46, s38
    s_addc_u32 s21, s47, 0
    s_and_b32 s21, s21, 0xffff
    s_sub_u32 s22, 8388608, s38
    s_mov_b32 s23, 0x00020000
    v_lshrrev_b32 v4, 1, v1
    v_lshlrev_b32 v4, 13, v4
    v_and_b32 v5, 1, v1
    v_lshl_add_u32 v4, v5, 4, v4
    s_lshl_b32 s38, s36, 3
    s_add_u32 s38, s38, 0
    s_lshl_b32 s39, s38, 18
    s_lshl_b32 s38, s38, 10
    s_add_u32 m0, s38, 0
    buffer_load_dwordx4 v4, s[8:11], s39 offen lds
    s_lshl_b32 s38, s36, 3
    s_add_u32 s38, s38, 1
    s_lshl_b32 s39, s38, 18
    s_lshl_b32 s38, s38, 10
    s_add_u32 m0, s38, 0
    buffer_load_dwordx4 v4, s[8:11], s39 offen lds
    s_lshl_b32 s38, s36, 3
    s_add_u32 s38, s38, 2
    s_lshl_b32 s39, s38, 18
    s_lshl_b32 s38, s38, 10
    s_add_u32 m0, s38, 0
    buffer_load_dwordx4 v4, s[8:11], s39 offen lds
    s_lshl_b32 s38, s36, 3
    s_add_u32 s38, s38, 3
    s_lshl_b32 s39, s38, 18
    s_lshl_b32 s38, s38, 10
    s_add_u32 m0, s38, 0
    buffer_load_dwordx4 v4, s[8:11], s39 offen lds
    s_lshl_b32 s38, s36, 3
    s_add_u32 s38, s38, 4
    s_lshl_b32 s39, s38, 18
    s_lshl_b32 s38, s38, 10
    s_add_u32 m0, s38, 0
    buffer_load_dwordx4 v4, s[8:11], s39 offen lds
    s_lshl_b32 s38, s36, 3
    s_add_u32 s38, s38, 5
    s_lshl_b32 s39, s38, 18
    s_lshl_b32 s38, s38, 10
    s_add_u32 m0, s38, 0
    buffer_load_dwordx4 v4, s[8:11], s39 offen lds
    s_lshl_b32 s38, s36, 3
    s_add_u32 s38, s38, 6
    s_lshl_b32 s39, s38, 18
    s_lshl_b32 s38, s38, 10
    s_add_u32 m0, s38, 0
    buffer_load_dwordx4 v4, s[8:11], s39 offen lds
    s_lshl_b32 s38, s36, 3
    s_add_u32 s38, s38, 7
    s_lshl_b32 s39, s38, 18
    s_lshl_b32 s38, s38, 10
    s_add_u32 m0, s38, 0
    buffer_load_dwordx4 v4, s[8:11], s39 offen lds
    s_lshl_b32 s38, s36, 3
    s_add_u32 s38, s38, 0
    s_lshl_b32 s39, s38, 18
    s_lshl_b32 s38, s38, 10
    s_add_u32 m0, s38, 32768
    buffer_load_dwordx4 v4, s[12:15], s39 offen lds
    s_lshl_b32 s38, s36, 3
    s_add_u32 s38, s38, 1
    s_lshl_b32 s39, s38, 18
    s_lshl_b32 s38, s38, 10
    s_add_u32 m0, s38, 32768
    buffer_load_dwordx4 v4, s[12:15], s39 offen lds
    s_lshl_b32 s38, s36, 3
    s_add_u32 s38, s38, 2
    s_lshl_b32 s39, s38, 18
    s_lshl_b32 s38, s38, 10
    s_add_u32 m0, s38, 32768
    buffer_load_dwordx4 v4, s[12:15], s39 offen lds
    s_lshl_b32 s38, s36, 3
    s_add_u32 s38, s38, 3
    s_lshl_b32 s39, s38, 18
    s_lshl_b32 s38, s38, 10
    s_add_u32 m0, s38, 32768
    buffer_load_dwordx4 v4, s[12:15], s39 offen lds
    s_lshl_b32 s38, s36, 3
    s_add_u32 s38, s38, 4
    s_lshl_b32 s39, s38, 18
    s_lshl_b32 s38, s38, 10
    s_add_u32 m0, s38, 32768
    buffer_load_dwordx4 v4, s[12:15], s39 offen lds
    s_lshl_b32 s38, s36, 3
    s_add_u32 s38, s38, 5
    s_lshl_b32 s39, s38, 18
    s_lshl_b32 s38, s38, 10
    s_add_u32 m0, s38, 32768
    buffer_load_dwordx4 v4, s[12:15], s39 offen lds
    s_lshl_b32 s38, s36, 3
    s_add_u32 s38, s38, 6
    s_lshl_b32 s39, s38, 18
    s_lshl_b32 s38, s38, 10
    s_add_u32 m0, s38, 32768
    buffer_load_dwordx4 v4, s[12:15], s39 offen lds
    s_lshl_b32 s38, s36, 3
    s_add_u32 s38, s38, 7
    s_lshl_b32 s39, s38, 18
    s_lshl_b32 s38, s38, 10
    s_add_u32 m0, s38, 32768
    buffer_load_dwordx4 v4, s[12:15], s39 offen lds
    s_lshl_b32 s38, s36, 3
    s_add_u32 s38, s38, 0
    s_lshl_b32 s39, s38, 18
    s_lshl_b32 s38, s38, 10
    s_add_u32 m0, s38, 65536
    buffer_load_dwordx4 v4, s[16:19], s39 offen lds
    s_lshl_b32 s38, s36, 3
    s_add_u32 s38, s38, 1
    s_lshl_b32 s39, s38, 18
    s_lshl_b32 s38, s38, 10
    s_add_u32 m0, s38, 65536
    buffer_load_dwordx4 v4, s[16:19], s39 offen lds
    s_lshl_b32 s38, s36, 3
    s_add_u32 s38, s38, 2
    s_lshl_b32 s39, s38, 18
    s_lshl_b32 s38, s38, 10
    s_add_u32 m0, s38, 65536
    buffer_load_dwordx4 v4, s[16:19], s39 offen lds
    s_lshl_b32 s38, s36, 3
    s_add_u32 s38, s38, 3
    s_lshl_b32 s39, s38, 18
    s_lshl_b32 s38, s38, 10
    s_add_u32 m0, s38, 65536
    buffer_load_dwordx4 v4, s[16:19], s39 offen lds
    s_lshl_b32 s38, s36, 3
    s_add_u32 s38, s38, 4
    s_lshl_b32 s39, s38, 18
    s_lshl_b32 s38, s38, 10
    s_add_u32 m0, s38, 65536
    buffer_load_dwordx4 v4, s[16:19], s39 offen lds
    s_lshl_b32 s38, s36, 3
    s_add_u32 s38, s38, 5
    s_lshl_b32 s39, s38, 18
    s_lshl_b32 s38, s38, 10
    s_add_u32 m0, s38, 65536
    buffer_load_dwordx4 v4, s[16:19], s39 offen lds
    s_lshl_b32 s38, s36, 3
    s_add_u32 s38, s38, 6
    s_lshl_b32 s39, s38, 18
    s_lshl_b32 s38, s38, 10
    s_add_u32 m0, s38, 65536
    buffer_load_dwordx4 v4, s[16:19], s39 offen lds
    s_lshl_b32 s38, s36, 3
    s_add_u32 s38, s38, 7
    s_lshl_b32 s39, s38, 18
    s_lshl_b32 s38, s38, 10
    s_add_u32 m0, s38, 65536
    buffer_load_dwordx4 v4, s[16:19], s39 offen lds
    v_lshrrev_b32 v4, 4, v1
    v_lshlrev_b32 v4, 11, v4
    v_lshl_add_u32 v4, v2, 4, v4
    s_lshl_b32 s38, s36, 3
    s_add_u32 s38, s38, 0
    s_lshl_b32 s39, s38, 13
    s_lshl_b32 s38, s38, 10
    s_add_u32 m0, s38, 98304
    buffer_load_dwordx4 v4, s[20:23], s39 offen lds
    s_lshl_b32 s38, s36, 3
    s_add_u32 s38, s38, 1
    s_lshl_b32 s39, s38, 13
    s_lshl_b32 s38, s38, 10
    s_add_u32 m0, s38, 98304
    buffer_load_dwordx4 v4, s[20:23], s39 offen lds
    s_lshl_b32 s38, s36, 3
    s_add_u32 s38, s38, 2
    s_lshl_b32 s39, s38, 13
    s_lshl_b32 s38, s38, 10
    s_add_u32 m0, s38, 98304
    buffer_load_dwordx4 v4, s[20:23], s39 offen lds
    s_lshl_b32 s38, s36, 3
    s_add_u32 s38, s38, 3
    s_lshl_b32 s39, s38, 13
    s_lshl_b32 s38, s38, 10
    s_add_u32 m0, s38, 98304
    buffer_load_dwordx4 v4, s[20:23], s39 offen lds
    s_lshl_b32 s38, s36, 3
    s_add_u32 s38, s38, 4
    s_lshl_b32 s39, s38, 13
    s_lshl_b32 s38, s38, 10
    s_add_u32 m0, s38, 98304
    buffer_load_dwordx4 v4, s[20:23], s39 offen lds
    s_lshl_b32 s38, s36, 3
    s_add_u32 s38, s38, 5
    s_lshl_b32 s39, s38, 13
    s_lshl_b32 s38, s38, 10
    s_add_u32 m0, s38, 98304
    buffer_load_dwordx4 v4, s[20:23], s39 offen lds
    s_lshl_b32 s38, s36, 3
    s_add_u32 s38, s38, 6
    s_lshl_b32 s39, s38, 13
    s_lshl_b32 s38, s38, 10
    s_add_u32 m0, s38, 98304
    buffer_load_dwordx4 v4, s[20:23], s39 offen lds
    s_lshl_b32 s38, s36, 3
    s_add_u32 s38, s38, 7
    s_lshl_b32 s39, s38, 13
    s_lshl_b32 s38, s38, 10
    s_add_u32 m0, s38, 98304
    buffer_load_dwordx4 v4, s[20:23], s39 offen lds
    s_waitcnt vmcnt(0)
    s_barrier
    v_lshrrev_b32 v4, 2, v2
    v_and_b32 v5, 3, v2
    v_lshl_add_u32 v4, v3, 2, v4
    v_lshlrev_b32 v4, 5, v4
    v_lshl_add_u32 v4, v5, 3, v4
    s_lshl_b32 s38, s36, 13
    v_add_u32 v4, s38, v4
    ds_read_b64_tr_b16 v[8:9], v4 offset:0
    ds_read_b64_tr_b16 v[10:11], v4 offset:512
    s_waitcnt lgkmcnt(0)
    v_accvgpr_write_b32 a0, v8
    v_accvgpr_write_b32 a1, v9
    v_accvgpr_write_b32 a2, v10
    v_accvgpr_write_b32 a3, v11
    ds_read_b64_tr_b16 v[8:9], v4 offset:1024
    ds_read_b64_tr_b16 v[10:11], v4 offset:1536
    s_waitcnt lgkmcnt(0)
    v_accvgpr_write_b32 a4, v8
    v_accvgpr_write_b32 a5, v9
    v_accvgpr_write_b32 a6, v10
    v_accvgpr_write_b32 a7, v11
    ds_read_b64_tr_b16 v[8:9], v4 offset:2048
    ds_read_b64_tr_b16 v[10:11], v4 offset:2560
    s_waitcnt lgkmcnt(0)
    v_accvgpr_write_b32 a8, v8
    v_accvgpr_write_b32 a9, v9
    v_accvgpr_write_b32 a10, v10
    v_accvgpr_write_b32 a11, v11
    ds_read_b64_tr_b16 v[8:9], v4 offset:3072
    ds_read_b64_tr_b16 v[10:11], v4 offset:3584
    s_waitcnt lgkmcnt(0)
    v_accvgpr_write_b32 a12, v8
    v_accvgpr_write_b32 a13, v9
    v_accvgpr_write_b32 a14, v10
    v_accvgpr_write_b32 a15, v11
    ds_read_b64_tr_b16 v[8:9], v4 offset:4096
    ds_read_b64_tr_b16 v[10:11], v4 offset:4608
    s_waitcnt lgkmcnt(0)
    v_accvgpr_write_b32 a16, v8
    v_accvgpr_write_b32 a17, v9
    v_accvgpr_write_b32 a18, v10
    v_accvgpr_write_b32 a19, v11
    ds_read_b64_tr_b16 v[8:9], v4 offset:5120
    ds_read_b64_tr_b16 v[10:11], v4 offset:5632
    s_waitcnt lgkmcnt(0)
    v_accvgpr_write_b32 a20, v8
    v_accvgpr_write_b32 a21, v9
    v_accvgpr_write_b32 a22, v10
    v_accvgpr_write_b32 a23, v11
    ds_read_b64_tr_b16 v[8:9], v4 offset:6144
    ds_read_b64_tr_b16 v[10:11], v4 offset:6656
    s_waitcnt lgkmcnt(0)
    v_accvgpr_write_b32 a24, v8
    v_accvgpr_write_b32 a25, v9
    v_accvgpr_write_b32 a26, v10
    v_accvgpr_write_b32 a27, v11
    ds_read_b64_tr_b16 v[8:9], v4 offset:7168
    ds_read_b64_tr_b16 v[10:11], v4 offset:7680
    s_waitcnt lgkmcnt(0)
    v_accvgpr_write_b32 a28, v8
    v_accvgpr_write_b32 a29, v9
    v_accvgpr_write_b32 a30, v10
    v_accvgpr_write_b32 a31, v11
    ds_read_b64_tr_b16 v[8:9], v4 offset:32768
    ds_read_b64_tr_b16 v[10:11], v4 offset:33280
    s_waitcnt lgkmcnt(0)
    v_accvgpr_write_b32 a32, v8
    v_accvgpr_write_b32 a33, v9
    v_accvgpr_write_b32 a34, v10
    v_accvgpr_write_b32 a35, v11
    ds_read_b64_tr_b16 v[8:9], v4 offset:33792
    ds_read_b64_tr_b16 v[10:11], v4 offset:34304
    s_waitcnt lgkmcnt(0)
    v_accvgpr_write_b32 a36, v8
    v_accvgpr_write_b32 a37, v9
    v_accvgpr_write_b32 a38, v10
    v_accvgpr_write_b32 a39, v11
    ds_read_b64_tr_b16 v[8:9], v4 offset:34816
    ds_read_b64_tr_b16 v[10:11], v4 offset:35328
    s_waitcnt lgkmcnt(0)
    v_accvgpr_write_b32 a40, v8
    v_accvgpr_write_b32 a41, v9
    v_accvgpr_write_b32 a42, v10
    v_accvgpr_write_b32 a43, v11
    ds_read_b64_tr_b16 v[8:9], v4 offset:35840
    ds_read_b64_tr_b16 v[10:11], v4 offset:36352
    s_waitcnt lgkmcnt(0)
    v_accvgpr_write_b32 a44, v8
    v_accvgpr_write_b32 a45, v9
    v_accvgpr_write_b32 a46, v10
    v_accvgpr_write_b32 a47, v11
    ds_read_b64_tr_b16 v[8:9], v4 offset:36864
    ds_read_b64_tr_b16 v[10:11], v4 offset:37376
    s_waitcnt lgkmcnt(0)
    v_accvgpr_write_b32 a48, v8
    v_accvgpr_write_b32 a49, v9
    v_accvgpr_write_b32 a50, v10
    v_accvgpr_write_b32 a51, v11
    ds_read_b64_tr_b16 v[8:9], v4 offset:37888
    ds_read_b64_tr_b16 v[10:11], v4 offset:38400
    s_waitcnt lgkmcnt(0)
    v_accvgpr_write_b32 a52, v8
    v_accvgpr_write_b32 a53, v9
    v_accvgpr_write_b32 a54, v10
    v_accvgpr_write_b32 a55, v11
    ds_read_b64_tr_b16 v[8:9], v4 offset:38912
    ds_read_b64_tr_b16 v[10:11], v4 offset:39424
    s_waitcnt lgkmcnt(0)
    v_accvgpr_write_b32 a56, v8
    v_accvgpr_write_b32 a57, v9
    v_accvgpr_write_b32 a58, v10
    v_accvgpr_write_b32 a59, v11
    ds_read_b64_tr_b16 v[8:9], v4 offset:39936
    ds_read_b64_tr_b16 v[10:11], v4 offset:40448
    s_waitcnt lgkmcnt(0)
    v_accvgpr_write_b32 a60, v8
    v_accvgpr_write_b32 a61, v9
    v_accvgpr_write_b32 a62, v10
    v_accvgpr_write_b32 a63, v11
    v_add_u32 v4, 65536, v4
    ds_read_b64_tr_b16 v[8:9], v4 offset:0
    ds_read_b64_tr_b16 v[10:11], v4 offset:512
    s_waitcnt lgkmcnt(0)
    v_accvgpr_write_b32 a64, v8
    v_accvgpr_write_b32 a65, v9
    v_accvgpr_write_b32 a66, v10
    v_accvgpr_write_b32 a67, v11
    ds_read_b64_tr_b16 v[8:9], v4 offset:1024
    ds_read_b64_tr_b16 v[10:11], v4 offset:1536
    s_waitcnt lgkmcnt(0)
    v_accvgpr_write_b32 a68, v8
    v_accvgpr_write_b32 a69, v9
    v_accvgpr_write_b32 a70, v10
    v_accvgpr_write_b32 a71, v11
    ds_read_b64_tr_b16 v[8:9], v4 offset:2048
    ds_read_b64_tr_b16 v[10:11], v4 offset:2560
    s_waitcnt lgkmcnt(0)
    v_accvgpr_write_b32 a72, v8
    v_accvgpr_write_b32 a73, v9
    v_accvgpr_write_b32 a74, v10
    v_accvgpr_write_b32 a75, v11
    ds_read_b64_tr_b16 v[8:9], v4 offset:3072
    ds_read_b64_tr_b16 v[10:11], v4 offset:3584
    s_waitcnt lgkmcnt(0)
    v_accvgpr_write_b32 a76, v8
    v_accvgpr_write_b32 a77, v9
    v_accvgpr_write_b32 a78, v10
    v_accvgpr_write_b32 a79, v11
    ds_read_b64_tr_b16 v[8:9], v4 offset:4096
    ds_read_b64_tr_b16 v[10:11], v4 offset:4608
    s_waitcnt lgkmcnt(0)
    v_accvgpr_write_b32 a80, v8
    v_accvgpr_write_b32 a81, v9
    v_accvgpr_write_b32 a82, v10
    v_accvgpr_write_b32 a83, v11
    ds_read_b64_tr_b16 v[8:9], v4 offset:5120
    ds_read_b64_tr_b16 v[10:11], v4 offset:5632
    s_waitcnt lgkmcnt(0)
    v_accvgpr_write_b32 a84, v8
    v_accvgpr_write_b32 a85, v9
    v_accvgpr_write_b32 a86, v10
    v_accvgpr_write_b32 a87, v11
    ds_read_b64_tr_b16 v[8:9], v4 offset:6144
    ds_read_b64_tr_b16 v[10:11], v4 offset:6656
    s_waitcnt lgkmcnt(0)
    v_accvgpr_write_b32 a88, v8
    v_accvgpr_write_b32 a89, v9
    v_accvgpr_write_b32 a90, v10
    v_accvgpr_write_b32 a91, v11
    ds_read_b64_tr_b16 v[8:9], v4 offset:7168
    ds_read_b64_tr_b16 v[10:11], v4 offset:7680
    s_waitcnt lgkmcnt(0)
    v_accvgpr_write_b32 a92, v8
    v_accvgpr_write_b32 a93, v9
    v_accvgpr_write_b32 a94, v10
    v_accvgpr_write_b32 a95, v11
    v_lshrrev_b32 v4, 2, v2
    v_lshl_add_u32 v4, v3, 2, v4
    v_lshlrev_b32 v4, 8, v4
    v_lshl_add_u32 v4, v5, 3, v4
    s_lshl_b32 s38, s36, 6
    s_add_u32 s38, s38, 98304
    v_add_u32 v4, s38, v4
    ds_read_b64_tr_b16 v[8:9], v4 offset:0
    ds_read_b64_tr_b16 v[10:11], v4 offset:4096
    s_waitcnt lgkmcnt(0)
    v_accvgpr_write_b32 a96, v8
    v_accvgpr_write_b32 a97, v9
    v_accvgpr_write_b32 a98, v10
    v_accvgpr_write_b32 a99, v11
    ds_read_b64_tr_b16 v[8:9], v4 offset:8192
    ds_read_b64_tr_b16 v[10:11], v4 offset:12288
    s_waitcnt lgkmcnt(0)
    v_accvgpr_write_b32 a100, v8
    v_accvgpr_write_b32 a101, v9
    v_accvgpr_write_b32 a102, v10
    v_accvgpr_write_b32 a103, v11
    ds_read_b64_tr_b16 v[8:9], v4 offset:16384
    ds_read_b64_tr_b16 v[10:11], v4 offset:20480
    s_waitcnt lgkmcnt(0)
    v_accvgpr_write_b32 a104, v8
    v_accvgpr_write_b32 a105, v9
    v_accvgpr_write_b32 a106, v10
    v_accvgpr_write_b32 a107, v11
    ds_read_b64_tr_b16 v[8:9], v4 offset:24576
    ds_read_b64_tr_b16 v[10:11], v4 offset:28672
    s_waitcnt lgkmcnt(0)
    v_accvgpr_write_b32 a108, v8
    v_accvgpr_write_b32 a109, v9
    v_accvgpr_write_b32 a110, v10
    v_accvgpr_write_b32 a111, v11
    ds_read_b64_tr_b16 v[8:9], v4 offset:32
    ds_read_b64_tr_b16 v[10:11], v4 offset:4128
    s_waitcnt lgkmcnt(0)
    v_accvgpr_write_b32 a112, v8
    v_accvgpr_write_b32 a113, v9
    v_accvgpr_write_b32 a114, v10
    v_accvgpr_write_b32 a115, v11
    ds_read_b64_tr_b16 v[8:9], v4 offset:8224
    ds_read_b64_tr_b16 v[10:11], v4 offset:12320
    s_waitcnt lgkmcnt(0)
    v_accvgpr_write_b32 a116, v8
    v_accvgpr_write_b32 a117, v9
    v_accvgpr_write_b32 a118, v10
    v_accvgpr_write_b32 a119, v11
    ds_read_b64_tr_b16 v[8:9], v4 offset:16416
    ds_read_b64_tr_b16 v[10:11], v4 offset:20512
    s_waitcnt lgkmcnt(0)
    v_accvgpr_write_b32 a120, v8
    v_accvgpr_write_b32 a121, v9
    v_accvgpr_write_b32 a122, v10
    v_accvgpr_write_b32 a123, v11
    ds_read_b64_tr_b16 v[8:9], v4 offset:24608
    ds_read_b64_tr_b16 v[10:11], v4 offset:28704
    s_waitcnt lgkmcnt(0)
    v_accvgpr_write_b32 a124, v8
    v_accvgpr_write_b32 a125, v9
    v_accvgpr_write_b32 a126, v10
    v_accvgpr_write_b32 a127, v11
    s_barrier
    s_add_u32 s8, s4, 4194304
    s_addc_u32 s9, s5, 0
    s_and_b32 s9, s9, 0xffff
    s_mov_b32 s10, 50331648
    s_mov_b32 s11, 0x00020000
    s_add_u32 s12, s4, 96468992
    s_addc_u32 s13, s5, 0
    s_and_b32 s13, s13, 0xffff
    s_mov_b32 s14, 8388608
    s_mov_b32 s15, 0x00020000
    s_add_u32 s16, s4, 104857600
    s_addc_u32 s17, s5, 0
    s_and_b32 s17, s17, 0xffff
    s_mov_b32 s18, 4194304
    s_mov_b32 s19, 0x00020000
    s_add_u32 s20, s4, 113246208
    s_addc_u32 s21, s5, 0
    s_and_b32 s21, s21, 0xffff
    s_mov_b32 s22, 2097152
    s_mov_b32 s23, 0x00020000
    s_mov_b32 s28, s6
    s_and_b32 s29, s7, 0xffff
    s_mov_b32 s30, 16384
    s_mov_b32 s31, 0x00020000
    v_and_b32 v5, 7, v2
    v_lshlrev_b32 v5, 11, v5
    v_lshl_add_u32 v5, v3, 3, v5
    s_lshl_b32 s38, s36, 9
    v_add_u32 v5, s38, v5
    s_mov_b32 s38, 24576
    v_mul_lo_u32 v6, s38, v3
    v_lshlrev_b32 v7, 1, v3
    v_xor_b32 v7, v7, v2
    v_lshl_add_u32 v6, v7, 4, v6
    s_lshl_b32 s39, s34, 8
    v_add_u32 v6, s39, v6
    v_add_u32 v6, 16384, v6
    v_mul_lo_u32 v192, s38, v3
    v_add_u32 v7, 0, v3
    v_xor_b32 v7, v7, v2
    v_lshl_add_u32 v192, v7, 4, v192
    v_add_u32 v192, s39, v192
    v_add_u32 v192, 8192, v192
    v_mul_lo_u32 v193, s38, v3
    v_add_u32 v7, 4, v3
    v_xor_b32 v7, v7, v2
    v_lshl_add_u32 v193, v7, 4, v193
    v_add_u32 v193, s39, v193
    v_add_u32 v193, 8192, v193
    v_mul_lo_u32 v194, s38, v3
    v_add_u32 v7, 8, v3
    v_xor_b32 v7, v7, v2
    v_lshl_add_u32 v194, v7, 4, v194
    v_add_u32 v194, s39, v194
    v_add_u32 v194, 8192, v194
    v_mul_lo_u32 v195, s38, v3
    v_add_u32 v7, 12, v3
    v_xor_b32 v7, v7, v2
    v_lshl_add_u32 v195, v7, 4, v195
    v_add_u32 v195, s39, v195
    v_add_u32 v195, 8192, v195
    v_add_u32 v7, 0, v3
    v_xor_b32 v7, v7, v2
    v_lshlrev_b32 v7, 4, v7
    v_lshl_add_u32 v196, v2, 8, v7
    v_add_u32 v196, 16384, v196
    v_add_u32 v7, 4, v3
    v_xor_b32 v7, v7, v2
    v_lshlrev_b32 v7, 4, v7
    v_lshl_add_u32 v197, v2, 8, v7
    v_add_u32 v197, 16384, v197
    v_add_u32 v7, 8, v3
    v_xor_b32 v7, v7, v2
    v_lshlrev_b32 v7, 4, v7
    v_lshl_add_u32 v198, v2, 8, v7
    v_add_u32 v198, 16384, v198
    v_add_u32 v7, 12, v3
    v_xor_b32 v7, v7, v2
    v_lshlrev_b32 v7, 4, v7
    v_lshl_add_u32 v199, v2, 8, v7
    v_add_u32 v199, 16384, v199
    v_lshrrev_b32 v7, 2, v2
    v_and_b32 v8, 3, v2
    s_movk_i32 s38, 1152
    v_mul_lo_u32 v14, s38, v3
    v_lshl_add_u32 v14, v7, 8, v14
    v_lshl_add_u32 v14, v8, 3, v14
    v_lshlrev_b32 v13, 5, v7
    v_lshlrev_b32 v9, 14, v3
    v_lshlrev_b32 v7, 1, v3
    v_xor_b32 v8, v7, v2
    v_lshl_add_u32 v12, v8, 4, v9
    v_add_u32 v12, s39, v12
    v_add_u32 v7, 8, v7
    v_xor_b32 v8, v7, v2
    v_lshl_add_u32 v11, v8, 4, v9
    v_add_u32 v11, s39, v11
    v_add_u32 v11, 65536, v11
    v_lshlrev_b32 v10, 4, v1
    v_and_b32 v7, 7, v2
    v_lshlrev_b32 v8, 1, v7
    v_add_u32 v9, 0, v3
    v_xor_b32 v9, v9, v8
    v_lshlrev_b32 v9, 4, v9
    v_lshl_add_u32 v28, v7, 8, v9
    v_add_u32 v28, 77824, v28
    v_add_u32 v9, 4, v3
    v_xor_b32 v9, v9, v8
    v_lshlrev_b32 v9, 4, v9
    v_lshl_add_u32 v29, v7, 8, v9
    v_add_u32 v29, 77824, v29
    v_add_u32 v9, 8, v3
    v_xor_b32 v9, v9, v8
    v_lshlrev_b32 v9, 4, v9
    v_lshl_add_u32 v30, v7, 8, v9
    v_add_u32 v30, 77824, v30
    v_add_u32 v9, 12, v3
    v_xor_b32 v9, v9, v8
    v_lshlrev_b32 v9, 4, v9
    v_lshl_add_u32 v31, v7, 8, v9
    v_add_u32 v31, 77824, v31
    v_and_b32 v7, 1, v3
    v_lshlrev_b32 v9, 4, v2
    v_lshl_add_u32 v9, v7, 3, v9
    v_add_u32 v9, 81920, v9
    v_and_b32 v7, 7, v2
    s_movk_i32 s38, 1088
    v_mul_lo_u32 v4, s38, v7
    v_lshl_add_u32 v4, v3, 4, v4
    s_mul_i32 s38, s36, 8704
    s_add_u32 s38, s38, 32768
    v_add_u32 v4, s38, v4
    s_movk_i32 s38, 2112
    v_mul_lo_u32 v15, s38, v3
    v_lshl_add_u32 v15, v2, 2, v15
    s_lshl_b32 s38, s36, 7
    s_add_u32 s38, s38, 86016
    v_add_u32 v15, s38, v15
    s_mul_i32 s38, s36, 1056
    s_add_u32 s38, s38, 86016
    v_lshl_add_u32 v7, v1, 2, s38
    s_lshl_b32 s38, s36, 13
    s_lshl_b32 s52, s35, 9
    s_add_u32 s38, s38, s52
    v_lshl_add_u32 v8, v1, 2, s38
    v_lshlrev_b32 v16, 8, v3
    v_lshl_add_u32 v16, v2, 2, v16
    s_mul_i32 s38, s36, 1536
    v_add_u32 v16, s38, v16
    v_add_u32 v16, 69632, v16
    v_xor_b32 v17, 16, v1
    v_lshlrev_b32 v17, 2, v17
    v_xor_b32 v18, 32, v1
    v_lshlrev_b32 v18, 2, v18
    v_lshrrev_b32 v19, 3, v1
    v_and_b32 v20, 7, v1
    v_lshlrev_b32 v21, 6, v19
    v_lshl_add_u32 v21, v20, 3, v21
    s_lshl_b32 s38, s36, 9
    v_add_u32 v21, s38, v21
    v_add_u32 v21, 69632, v21
    v_lshlrev_b32 v22, 14, v19
    v_lshl_add_u32 v22, v20, 2, v22
    s_lshl_b32 s38, s36, 13
    s_add_u32 s38, s38, s37
    v_add_u32 v22, s38, v22
    v_lshrrev_b32 v19, 2, v1
    v_and_b32 v20, 3, v1
    v_lshlrev_b32 v23, 7, v20
    v_lshl_add_u32 v23, v19, 2, v23
    v_add_u32 v23, 70656, v23
    v_lshlrev_b32 v24, 4, v19
    v_lshl_add_u32 v24, v20, 2, v24
    s_lshl_b32 s38, s37, 3
    v_add_u32 v24, s38, v24
    v_lshlrev_b32 v25, 7, v1
    v_add_u32 v25, 262144, v25
    v_mov_b32 v26, 1
    s_mov_b32 s53, 0
rec_kernel_loop4:
    s_mul_i32 s54, s53, 786432
    s_lshl_b32 s55, s36, 1
    s_add_u32 s55, s55, 0
    s_mul_i32 s56, s55, 98304
    s_add_u32 s56, s56, s54
    s_mul_i32 s57, s55, 1152
    s_add_u32 m0, s57, 0
    buffer_load_dwordx4 v6, s[8:11], s56 offen lds
    s_lshl_b32 s57, s55, 10
    s_add_u32 m0, s57, 16384
    s_bitcmp1_b32 s36, 0
    s_cbranch_scc1 rec_kernel_kv5
    buffer_load_dwordx4 v192, s[8:11], s56 offen lds
    s_branch rec_kernel_ke6
rec_kernel_kv5:
    buffer_load_dwordx4 v194, s[8:11], s56 offen lds
rec_kernel_ke6:
    s_lshl_b32 s55, s36, 1
    s_add_u32 s55, s55, 1
    s_mul_i32 s56, s55, 98304
    s_add_u32 s56, s56, s54
    s_mul_i32 s57, s55, 1152
    s_add_u32 m0, s57, 0
    buffer_load_dwordx4 v6, s[8:11], s56 offen lds
    s_lshl_b32 s57, s55, 10
    s_add_u32 m0, s57, 16384
    s_bitcmp1_b32 s36, 0
    s_cbranch_scc1 rec_kernel_kv7
    buffer_load_dwordx4 v193, s[8:11], s56 offen lds
    s_branch rec_kernel_ke8
rec_kernel_kv7:
    buffer_load_dwordx4 v195, s[8:11], s56 offen lds
rec_kernel_ke8:
    s_waitcnt vmcnt(0)
    s_barrier
    ds_read_b128 v[32:35], v196 offset:0
    ds_read_b128 v[36:39], v197 offset:0
    ds_read_b128 v[40:43], v198 offset:0
    ds_read_b128 v[44:47], v199 offset:0
    ds_read_b128 v[48:51], v196 offset:4096
    ds_read_b128 v[52:55], v197 offset:4096
    ds_read_b128 v[56:59], v198 offset:4096
    ds_read_b128 v[60:63], v199 offset:4096
    v_xor_b32 v27, 0, v13
    v_add_u32 v27, v27, v14
    ds_read_b64_tr_b16 v[64:65], v27 offset:0
    ds_read_b64_tr_b16 v[66:67], v27 offset:4608
    v_xor_b32 v27, 32, v13
    v_add_u32 v27, v27, v14
    ds_read_b64_tr_b16 v[68:69], v27 offset:0
    ds_read_b64_tr_b16 v[70:71], v27 offset:4608
    v_xor_b32 v27, 64, v13
    v_add_u32 v27, v27, v14
    ds_read_b64_tr_b16 v[72:73], v27 offset:0
    ds_read_b64_tr_b16 v[74:75], v27 offset:4608
    v_xor_b32 v27, 96, v13
    v_add_u32 v27, v27, v14
    ds_read_b64_tr_b16 v[76:77], v27 offset:0
    ds_read_b64_tr_b16 v[78:79], v27 offset:4608
    v_xor_b32 v27, 128, v13
    v_add_u32 v27, v27, v14
    ds_read_b64_tr_b16 v[80:81], v27 offset:0
    ds_read_b64_tr_b16 v[82:83], v27 offset:4608
    v_xor_b32 v27, 160, v13
    v_add_u32 v27, v27, v14
    ds_read_b64_tr_b16 v[84:85], v27 offset:0
    ds_read_b64_tr_b16 v[86:87], v27 offset:4608
    v_xor_b32 v27, 192, v13
    v_add_u32 v27, v27, v14
    ds_read_b64_tr_b16 v[88:89], v27 offset:0
    ds_read_b64_tr_b16 v[90:91], v27 offset:4608
    v_xor_b32 v27, 224, v13
    v_add_u32 v27, v27, v14
    ds_read_b64_tr_b16 v[92:93], v27 offset:0
    ds_read_b64_tr_b16 v[94:95], v27 offset:4608
    s_cmp_eq_u32 s53, 0
    s_cbranch_scc1 rec_kernel_first9
    s_sub_u32 s55, s53, 1
    s_lshl_b32 s56, s55, 11
    s_cmp_lg_u32 s36, 0
    s_cbranch_scc1 rec_kernel_p2s13
    s_mov_b64 s[60:61], exec
    s_mov_b64 exec, 0xffff
rec_kernel_poll211:
    buffer_load_dword v27, v25, s[24:27], s56 offen sc1
    s_waitcnt vmcnt(0)
    v_cmp_le_u32 vcc, 16, v27
    s_cmp_eq_u64 vcc, exec
    s_cbranch_scc1 rec_kernel_p2d12
    s_branch rec_kernel_poll211
rec_kernel_p2d12:
    s_mov_b64 exec, s[60:61]
rec_kernel_p2s13:
    s_barrier
    s_lshl_b32 s56, s55, 15
    s_lshl_b32 s58, s36, 10
    s_add_u32 s56, s56, s58
    s_mul_i32 s58, s36, 8704
    s_add_u32 s57, s56, 0
    s_add_u32 m0, s58, 32768
    buffer_load_dwordx4 v10, s[20:23], s57 offen sc1 lds
    s_add_u32 s57, s56, 4096
    s_add_u32 m0, s58, 33856
    buffer_load_dwordx4 v10, s[20:23], s57 offen sc1 lds
    s_add_u32 s57, s56, 8192
    s_add_u32 m0, s58, 34944
    buffer_load_dwordx4 v10, s[20:23], s57 offen sc1 lds
    s_add_u32 s57, s56, 12288
    s_add_u32 m0, s58, 36032
    buffer_load_dwordx4 v10, s[20:23], s57 offen sc1 lds
    s_add_u32 s57, s56, 16384
    s_add_u32 m0, s58, 37120
    buffer_load_dwordx4 v10, s[20:23], s57 offen sc1 lds
    s_add_u32 s57, s56, 20480
    s_add_u32 m0, s58, 38208
    buffer_load_dwordx4 v10, s[20:23], s57 offen sc1 lds
    s_add_u32 s57, s56, 24576
    s_add_u32 m0, s58, 39296
    buffer_load_dwordx4 v10, s[20:23], s57 offen sc1 lds
    s_add_u32 s57, s56, 28672
    s_add_u32 m0, s58, 40384
    buffer_load_dwordx4 v10, s[20:23], s57 offen sc1 lds
    s_waitcnt vmcnt(0)
    ds_read_b128 v[96:99], v4 offset:0
    ds_read_b128 v[100:103], v4 offset:64
    ds_read_b128 v[104:107], v4 offset:128
    ds_read_b128 v[108:111], v4 offset:192
    ds_read_b128 v[112:115], v4 offset:256
    ds_read_b128 v[116:119], v4 offset:320
    ds_read_b128 v[120:123], v4 offset:384
    ds_read_b128 v[124:127], v4 offset:448
    ds_read_b128 v[128:131], v4 offset:512
    ds_read_b128 v[132:135], v4 offset:576
    ds_read_b128 v[136:139], v4 offset:640
    ds_read_b128 v[140:143], v4 offset:704
    ds_read_b128 v[144:147], v4 offset:768
    ds_read_b128 v[148:151], v4 offset:832
    ds_read_b128 v[152:155], v4 offset:896
    ds_read_b128 v[156:159], v4 offset:960
    s_waitcnt lgkmcnt(14)
    v_cvt_pk_bf16_f32 v160, v96, v97
    v_cvt_pk_bf16_f32 v161, v98, v99
    v_cvt_pk_bf16_f32 v162, v100, v101
    v_cvt_pk_bf16_f32 v163, v102, v103
    s_waitcnt lgkmcnt(12)
    v_cvt_pk_bf16_f32 v164, v104, v105
    v_cvt_pk_bf16_f32 v165, v106, v107
    v_cvt_pk_bf16_f32 v166, v108, v109
    v_cvt_pk_bf16_f32 v167, v110, v111
    s_waitcnt lgkmcnt(10)
    v_cvt_pk_bf16_f32 v168, v112, v113
    v_cvt_pk_bf16_f32 v169, v114, v115
    v_cvt_pk_bf16_f32 v170, v116, v117
    v_cvt_pk_bf16_f32 v171, v118, v119
    s_waitcnt lgkmcnt(8)
    v_cvt_pk_bf16_f32 v172, v120, v121
    v_cvt_pk_bf16_f32 v173, v122, v123
    v_cvt_pk_bf16_f32 v174, v124, v125
    v_cvt_pk_bf16_f32 v175, v126, v127
    s_waitcnt lgkmcnt(6)
    v_cvt_pk_bf16_f32 v176, v128, v129
    v_cvt_pk_bf16_f32 v177, v130, v131
    v_cvt_pk_bf16_f32 v178, v132, v133
    v_cvt_pk_bf16_f32 v179, v134, v135
    s_waitcnt lgkmcnt(4)
    v_cvt_pk_bf16_f32 v180, v136, v137
    v_cvt_pk_bf16_f32 v181, v138, v139
    v_cvt_pk_bf16_f32 v182, v140, v141
    v_cvt_pk_bf16_f32 v183, v142, v143
    s_waitcnt lgkmcnt(2)
    v_cvt_pk_bf16_f32 v184, v144, v145
    v_cvt_pk_bf16_f32 v185, v146, v147
    v_cvt_pk_bf16_f32 v186, v148, v149
    v_cvt_pk_bf16_f32 v187, v150, v151
    s_waitcnt lgkmcnt(0)
    v_cvt_pk_bf16_f32 v188, v152, v153
    v_cvt_pk_bf16_f32 v189, v154, v155
    v_cvt_pk_bf16_f32 v190, v156, v157
    v_cvt_pk_bf16_f32 v191, v158, v159
    s_branch rec_kernel_haveM10
rec_kernel_first9:
    buffer_load_dwordx2 v[160:161], v5, s[28:31], 0 offen offset:0
    buffer_load_dwordx2 v[162:163], v5, s[28:31], 0 offen offset:32
    buffer_load_dwordx2 v[164:165], v5, s[28:31], 0 offen offset:64
    buffer_load_dwordx2 v[166:167], v5, s[28:31], 0 offen offset:96
    buffer_load_dwordx2 v[168:169], v5, s[28:31], 0 offen offset:128
    buffer_load_dwordx2 v[170:171], v5, s[28:31], 0 offen offset:160
    buffer_load_dwordx2 v[172:173], v5, s[28:31], 0 offen offset:192
    buffer_load_dwordx2 v[174:175], v5, s[28:31], 0 offen offset:224
    buffer_load_dwordx2 v[176:177], v5, s[28:31], 0 offen offset:256
    buffer_load_dwordx2 v[178:179], v5, s[28:31], 0 offen offset:288
    buffer_load_dwordx2 v[180:181], v5, s[28:31], 0 offen offset:320
    buffer_load_dwordx2 v[182:183], v5, s[28:31], 0 offen offset:352
    buffer_load_dwordx2 v[184:185], v5, s[28:31], 0 offen offset:384
    buffer_load_dwordx2 v[186:187], v5, s[28:31], 0 offen offset:416
    buffer_load_dwordx2 v[188:189], v5, s[28:31], 0 offen offset:448
    buffer_load_dwordx2 v[190:191], v5, s[28:31], 0 offen offset:480
    s_waitcnt vmcnt(0)
rec_kernel_haveM10:
    v_mfma_f32_16x16x32_bf16 v[96:99], v[160:163], a[0:3], 0
    v_mfma_f32_16x16x32_bf16 v[100:103], v[160:163], a[32:35], 0
    v_mfma_f32_16x16x32_bf16 v[104:107], v[160:163], a[64:67], 0
    v_mfma_f32_16x16x32_bf16 v[96:99], v[164:167], a[4:7], v[96:99]
    v_mfma_f32_16x16x32_bf16 v[100:103], v[164:167], a[36:39], v[100:103]
    v_mfma_f32_16x16x32_bf16 v[104:107], v[164:167], a[68:71], v[104:107]
    v_mfma_f32_16x16x32_bf16 v[96:99], v[168:171], a[8:11], v[96:99]
    v_mfma_f32_16x16x32_bf16 v[100:103], v[168:171], a[40:43], v[100:103]
    v_mfma_f32_16x16x32_bf16 v[104:107], v[168:171], a[72:75], v[104:107]
    v_mfma_f32_16x16x32_bf16 v[96:99], v[172:175], a[12:15], v[96:99]
    v_mfma_f32_16x16x32_bf16 v[100:103], v[172:175], a[44:47], v[100:103]
    v_mfma_f32_16x16x32_bf16 v[104:107], v[172:175], a[76:79], v[104:107]
    v_mfma_f32_16x16x32_bf16 v[96:99], v[176:179], a[16:19], v[96:99]
    v_mfma_f32_16x16x32_bf16 v[100:103], v[176:179], a[48:51], v[100:103]
    v_mfma_f32_16x16x32_bf16 v[104:107], v[176:179], a[80:83], v[104:107]
    v_mfma_f32_16x16x32_bf16 v[96:99], v[180:183], a[20:23], v[96:99]
    v_mfma_f32_16x16x32_bf16 v[100:103], v[180:183], a[52:55], v[100:103]
    v_mfma_f32_16x16x32_bf16 v[104:107], v[180:183], a[84:87], v[104:107]
    v_mfma_f32_16x16x32_bf16 v[96:99], v[184:187], a[24:27], v[96:99]
    v_mfma_f32_16x16x32_bf16 v[100:103], v[184:187], a[56:59], v[100:103]
    v_mfma_f32_16x16x32_bf16 v[104:107], v[184:187], a[88:91], v[104:107]
    v_mfma_f32_16x16x32_bf16 v[96:99], v[188:191], a[28:31], v[96:99]
    v_mfma_f32_16x16x32_bf16 v[100:103], v[188:191], a[60:63], v[100:103]
    v_mfma_f32_16x16x32_bf16 v[104:107], v[188:191], a[92:95], v[104:107]
    s_nop 7
    s_nop 1
    s_mov_b64 s[60:61], exec
    s_mov_b64 exec, 0xffffffff
    ds_write_b32 v16, v96 offset:0
    ds_write_b32 v16, v97 offset:64
    ds_write_b32 v16, v98 offset:128
    ds_write_b32 v16, v99 offset:192
    ds_write_b32 v16, v100 offset:512
    ds_write_b32 v16, v101 offset:576
    ds_write_b32 v16, v102 offset:640
    ds_write_b32 v16, v103 offset:704
    ds_write_b32 v16, v104 offset:1024
    ds_write_b32 v16, v105 offset:1088
    ds_write_b32 v16, v106 offset:1152
    ds_write_b32 v16, v107 offset:1216
    s_mov_b64 exec, s[60:61]
    s_waitcnt lgkmcnt(0)
    s_barrier
    s_cmp_eq_u32 s36, 3
    s_cbranch_scc1 rec_kernel_rd15
    s_cmp_eq_u32 s36, 2
    s_cbranch_scc1 rec_kernel_w214
    ds_read_b64 v[108:109], v21 offset:0
    ds_read_b64 v[110:111], v21 offset:1536
    ds_read_b64 v[112:113], v21 offset:3072
    ds_read_b64 v[114:115], v21 offset:4608
    s_waitcnt lgkmcnt(0)
    v_add_f32 v108, v108, v110
    v_add_f32 v109, v109, v111
    v_add_f32 v108, v108, v112
    v_add_f32 v109, v109, v113
    v_add_f32 v108, v108, v114
    v_add_f32 v109, v109, v115
    v_cvt_pk_bf16_f32 v108, v108, v109
    s_lshl_b32 s55, s53, 17
    s_cmp_eq_u32 s93, 1
    s_cbranch_scc1 rec_kernel_sl16
    buffer_store_dword v108, v22, s[12:15], s55 offen sc1
    s_branch rec_kernel_se17
rec_kernel_sl16:
    buffer_store_dword v108, v22, s[12:15], s55 offen
rec_kernel_se17:
    s_branch rec_kernel_rd15
rec_kernel_w214:
    ds_read_b32 v108, v23 offset:0
    ds_read_b32 v109, v23 offset:64
    ds_read_b32 v110, v23 offset:1536
    ds_read_b32 v111, v23 offset:1600
    ds_read_b32 v112, v23 offset:3072
    ds_read_b32 v113, v23 offset:3136
    ds_read_b32 v114, v23 offset:4608
    ds_read_b32 v115, v23 offset:4672
    s_waitcnt lgkmcnt(0)
    v_add_f32 v108, v108, v110
    v_add_f32 v109, v109, v111
    v_add_f32 v108, v108, v112
    v_add_f32 v109, v109, v113
    v_add_f32 v108, v108, v114
    v_add_f32 v109, v109, v115
    v_cvt_pk_bf16_f32 v108, v108, v109
    s_lshl_b32 s55, s53, 16
    s_cmp_eq_u32 s93, 1
    s_cbranch_scc1 rec_kernel_sl18
    buffer_store_dword v108, v24, s[16:19], s55 offen sc1
    s_branch rec_kernel_se19
rec_kernel_sl18:
    buffer_store_dword v108, v24, s[16:19], s55 offen
rec_kernel_se19:
rec_kernel_rd15:
    s_waitcnt vmcnt(0)
    s_barrier
    s_cmp_eq_u32 s53, 63
    s_cbranch_scc1 rec_kernel_done1
    s_lshl_b32 s55, s53, 5
    s_add_u32 s55, s55, s34
    s_lshl_b32 s55, s55, 7
    s_cmp_lg_u32 s36, 0
    s_cbranch_scc1 rec_kernel_nsig20
    s_mov_b64 s[60:61], exec
    s_mov_b64 exec, 1
    v_mov_b32 v27, s55
    s_cmp_eq_u32 s93, 1
    s_cbranch_scc1 rec_kernel_fp22
    buffer_atomic_add v26, v27, s[24:27], 0 offen sc1
rec_kernel_poll123:
    buffer_load_dword v19, v27, s[24:27], 0 offen sc1
    s_waitcnt vmcnt(0)
    v_cmp_le_u32 vcc, 8, v19
    s_cbranch_vccnz rec_kernel_p1d21
    s_branch rec_kernel_poll123
rec_kernel_fp22:
    buffer_atomic_add v26, v27, s[24:27], 0 offen
    s_mov_b32 s94, 0
rec_kernel_poll1f24:
    buffer_load_dword v19, v27, s[24:27], 0 offen sc1
    s_waitcnt vmcnt(0)
    v_cmp_le_u32 vcc, 8, v19
    s_cbranch_vccnz rec_kernel_p1d21
    s_add_u32 s94, s94, 1
    s_cmp_lt_u32 s94, 200000
    s_cbranch_scc1 rec_kernel_poll1f24
rec_kernel_p1d21:
    s_mov_b64 exec, s[60:61]
rec_kernel_nsig20:
    s_barrier
    s_cmp_eq_u32 s36, 3
    s_cbranch_scc1 rec_kernel_l325
    s_cmp_eq_u32 s36, 2
    s_cbranch_scc1 rec_kernel_l226
    s_lshl_b32 s55, s53, 17
    s_lshl_b32 s56, s36, 13
    s_add_u32 s55, s55, s56
    s_lshl_b32 s56, s36, 11
    s_add_u32 m0, s56, 77824
    s_cmp_eq_u32 s93, 1
    s_cbranch_scc1 rec_kernel_sl27
    buffer_load_dwordx4 v12, s[12:15], s55 offen sc1 lds
    s_branch rec_kernel_se28
rec_kernel_sl27:
    buffer_load_dwordx4 v12, s[12:15], s55 offen lds
rec_kernel_se28:
    s_add_u32 m0, s56, 78848
    s_cmp_eq_u32 s93, 1
    s_cbranch_scc1 rec_kernel_sl29
    buffer_load_dwordx4 v11, s[12:15], s55 offen sc1 lds
    s_branch rec_kernel_se30
rec_kernel_sl29:
    buffer_load_dwordx4 v11, s[12:15], s55 offen lds
rec_kernel_se30:
    s_branch rec_kernel_l325
rec_kernel_l226:
    s_lshl_b32 s55, s53, 16
    s_lshl_b32 s56, s34, 11
    s_add_u32 s55, s55, s56
    s_mov_b32 m0, 81920
    s_add_u32 s56, s55, 1024
    s_cmp_eq_u32 s93, 1
    s_cbranch_scc1 rec_kernel_sl31
    buffer_load_dwordx4 v10, s[16:19], s55 offen sc1 lds
    s_branch rec_kernel_se32
rec_kernel_sl31:
    buffer_load_dwordx4 v10, s[16:19], s55 offen lds
rec_kernel_se32:
    s_mov_b32 m0, 82944
    s_cmp_eq_u32 s93, 1
    s_cbranch_scc1 rec_kernel_sl33
    buffer_load_dwordx4 v10, s[16:19], s56 offen sc1 lds
    s_branch rec_kernel_se34
rec_kernel_sl33:
    buffer_load_dwordx4 v10, s[16:19], s56 offen lds
rec_kernel_se34:
rec_kernel_l325:
    s_waitcnt vmcnt(0)
    s_barrier
    ds_read_b128 v[96:99], v28
    ds_read_b128 v[100:103], v29
    ds_read_b128 v[104:107], v30
    ds_read_b128 v[108:111], v31
    ds_read_b128 v[112:115], v28 offset:2048
    ds_read_b128 v[116:119], v29 offset:2048
    ds_read_b128 v[120:123], v30 offset:2048
    ds_read_b128 v[124:127], v31 offset:2048
    ds_read_b64 v[128:129], v9 offset:0
    ds_read_b64 v[130:131], v9 offset:256
    ds_read_b64 v[132:133], v9 offset:512
    ds_read_b64 v[134:135], v9 offset:768
    ds_read_b64 v[136:137], v9 offset:1024
    ds_read_b64 v[138:139], v9 offset:1280
    ds_read_b64 v[140:141], v9 offset:1536
    ds_read_b64 v[142:143], v9 offset:1792
    s_waitcnt lgkmcnt(12)
    v_mfma_f32_16x16x32_bf16 v[144:147], v[32:35], v[96:99], 0
    v_mfma_f32_16x16x32_bf16 v[148:151], v[48:51], v[96:99], 0
    v_mfma_f32_16x16x32_bf16 v[144:147], v[36:39], v[100:103], v[144:147]
    v_mfma_f32_16x16x32_bf16 v[148:151], v[52:55], v[100:103], v[148:151]
    v_mfma_f32_16x16x32_bf16 v[144:147], v[40:43], v[104:107], v[144:147]
    v_mfma_f32_16x16x32_bf16 v[148:151], v[56:59], v[104:107], v[148:151]
    v_mfma_f32_16x16x32_bf16 v[144:147], v[44:47], v[108:111], v[144:147]
    v_mfma_f32_16x16x32_bf16 v[148:151], v[60:63], v[108:111], v[148:151]
    s_waitcnt lgkmcnt(8)
    v_mfma_f32_16x16x32_bf16 v[152:155], v[112:115], v[96:99], 0
    v_mfma_f32_16x16x32_bf16 v[152:155], v[116:119], v[100:103], v[152:155]
    v_mfma_f32_16x16x32_bf16 v[152:155], v[120:123], v[104:107], v[152:155]
    v_mfma_f32_16x16x32_bf16 v[152:155], v[124:127], v[108:111], v[152:155]
    s_nop 7
    s_nop 1
    s_mov_b32 s55, 0x3db504f3
    v_cvt_pk_bf16_f32 v27, v144, v145
    v_lshlrev_b32 v144, 16, v27
    v_and_b32 v145, 0xffff0000, v27
    v_mul_f32 v144, s55, v144
    v_mul_f32 v145, s55, v145
    v_cvt_pk_bf16_f32 v27, v144, v145
    v_lshlrev_b32 v144, 16, v27
    v_and_b32 v145, 0xffff0000, v27
    v_cvt_pk_bf16_f32 v27, v146, v147
    v_lshlrev_b32 v146, 16, v27
    v_and_b32 v147, 0xffff0000, v27
    v_mul_f32 v146, s55, v146
    v_mul_f32 v147, s55, v147
    v_cvt_pk_bf16_f32 v27, v146, v147
    v_lshlrev_b32 v146, 16, v27
    v_and_b32 v147, 0xffff0000, v27
    v_cvt_pk_bf16_f32 v27, v148, v149
    v_lshlrev_b32 v148, 16, v27
    v_and_b32 v149, 0xffff0000, v27
    v_mul_f32 v148, s55, v148
    v_mul_f32 v149, s55, v149
    v_cvt_pk_bf16_f32 v27, v148, v149
    v_lshlrev_b32 v148, 16, v27
    v_and_b32 v149, 0xffff0000, v27
    v_cvt_pk_bf16_f32 v27, v150, v151
    v_lshlrev_b32 v150, 16, v27
    v_and_b32 v151, 0xffff0000, v27
    v_mul_f32 v150, s55, v150
    v_mul_f32 v151, s55, v151
    v_cvt_pk_bf16_f32 v27, v150, v151
    v_lshlrev_b32 v150, 16, v27
    v_and_b32 v151, 0xffff0000, v27
    v_cvt_pk_bf16_f32 v27, v152, v153
    v_lshlrev_b32 v152, 16, v27
    v_and_b32 v153, 0xffff0000, v27
    v_mul_f32 v152, s55, v152
    v_mul_f32 v153, s55, v153
    v_cvt_pk_bf16_f32 v27, v152, v153
    v_lshlrev_b32 v152, 16, v27
    v_and_b32 v153, 0xffff0000, v27
    v_cvt_pk_bf16_f32 v27, v154, v155
    v_lshlrev_b32 v154, 16, v27
    v_and_b32 v155, 0xffff0000, v27
    v_mul_f32 v154, s55, v154
    v_mul_f32 v155, s55, v155
    v_cvt_pk_bf16_f32 v27, v154, v155
    v_lshlrev_b32 v154, 16, v27
    v_and_b32 v155, 0xffff0000, v27
    v_cmp_gt_u32 s[62:63], 2, v3
    v_mov_b32 v19, 0xf149f2ca
    s_nop 1
    v_cndmask_b32 v152, v19, v152, s[62:63]
    v_cndmask_b32 v153, v19, v153, s[62:63]
    v_cndmask_b32 v154, v19, v154, s[62:63]
    v_cndmask_b32 v155, v19, v155, s[62:63]
    v_max3_f32 v27, v144, v145, v146
    v_max3_f32 v27, v27, v147, v148
    v_max3_f32 v27, v27, v149, v150
    v_max3_f32 v27, v27, v151, v152
    v_max3_f32 v27, v27, v153, v154
    v_max_f32 v27, v27, v155
    v_mov_b32 v19, v27
    s_nop 1
    v_permlane16_swap_b32 v27, v19
    s_nop 1
    v_max_f32 v27, v27, v19
    v_mov_b32 v19, v27
    s_nop 1
    v_permlane32_swap_b32 v27, v19
    s_nop 1
    v_max_f32 v27, v27, v19
    s_mov_b32 s55, 0x3fb8aa3b
    v_mul_f32 v27, s55, v27
    v_fma_f32 v144, s55, v144, -v27
    v_exp_f32 v144, v144
    v_fma_f32 v145, s55, v145, -v27
    v_exp_f32 v145, v145
    v_fma_f32 v146, s55, v146, -v27
    v_exp_f32 v146, v146
    v_fma_f32 v147, s55, v147, -v27
    v_exp_f32 v147, v147
    v_fma_f32 v148, s55, v148, -v27
    v_exp_f32 v148, v148
    v_fma_f32 v149, s55, v149, -v27
    v_exp_f32 v149, v149
    v_fma_f32 v150, s55, v150, -v27
    v_exp_f32 v150, v150
    v_fma_f32 v151, s55, v151, -v27
    v_exp_f32 v151, v151
    v_fma_f32 v152, s55, v152, -v27
    v_exp_f32 v152, v152
    v_fma_f32 v153, s55, v153, -v27
    v_exp_f32 v153, v153
    v_fma_f32 v154, s55, v154, -v27
    v_exp_f32 v154, v154
    v_fma_f32 v155, s55, v155, -v27
    v_exp_f32 v155, v155
    s_nop 0
    v_add_f32 v27, v144, v145
    v_add_f32 v27, v27, v146
    v_add_f32 v27, v27, v147
    v_add_f32 v27, v27, v148
    v_add_f32 v27, v27, v149
    v_add_f32 v27, v27, v150
    v_add_f32 v27, v27, v151
    v_add_f32 v27, v27, v152
    v_add_f32 v27, v27, v153
    v_add_f32 v27, v27, v154
    v_add_f32 v27, v27, v155
    v_mov_b32 v19, v27
    s_nop 1
    v_permlane16_swap_b32 v27, v19
    s_nop 1
    v_add_f32 v27, v27, v19
    v_mov_b32 v19, v27
    s_nop 1
    v_permlane32_swap_b32 v27, v19
    s_nop 1
    v_add_f32 v27, v27, v19
    v_rcp_f32 v27, v27
    s_nop 0
    v_mul_f32 v144, v144, v27
    v_mul_f32 v145, v145, v27
    v_mul_f32 v146, v146, v27
    v_mul_f32 v147, v147, v27
    v_mul_f32 v148, v148, v27
    v_mul_f32 v149, v149, v27
    v_mul_f32 v150, v150, v27
    v_mul_f32 v151, v151, v27
    v_mul_f32 v152, v152, v27
    v_mul_f32 v153, v153, v27
    v_mul_f32 v154, v154, v27
    v_mul_f32 v155, v155, v27
    v_cvt_pk_bf16_f32 v156, v144, v145
    v_cvt_pk_bf16_f32 v157, v146, v147
    v_cvt_pk_bf16_f32 v158, v148, v149
    v_cvt_pk_bf16_f32 v159, v150, v151
    v_cvt_pk_bf16_f32 v160, v152, v153
    v_cvt_pk_bf16_f32 v161, v154, v155
    s_nop 1
    v_mfma_f32_16x16x32_bf16 v[96:99], v[64:67], v[156:159], 0
    v_mfma_f32_16x16x32_bf16 v[100:103], v[68:71], v[156:159], 0
    v_mfma_f32_16x16x32_bf16 v[104:107], v[72:75], v[156:159], 0
    v_mfma_f32_16x16x32_bf16 v[108:111], v[76:79], v[156:159], 0
    v_mfma_f32_16x16x32_bf16 v[112:115], v[80:83], v[156:159], 0
    v_mfma_f32_16x16x32_bf16 v[116:119], v[84:87], v[156:159], 0
    v_mfma_f32_16x16x32_bf16 v[120:123], v[88:91], v[156:159], 0
    v_mfma_f32_16x16x32_bf16 v[124:127], v[92:95], v[156:159], 0
    v_mfma_f32_16x16x16_bf16 v[96:99], v[128:129], v[160:161], v[96:99]
    v_mfma_f32_16x16x16_bf16 v[100:103], v[130:131], v[160:161], v[100:103]
    v_mfma_f32_16x16x16_bf16 v[104:107], v[132:133], v[160:161], v[104:107]
    v_mfma_f32_16x16x16_bf16 v[108:111], v[134:135], v[160:161], v[108:111]
    v_mfma_f32_16x16x16_bf16 v[112:115], v[136:137], v[160:161], v[112:115]
    v_mfma_f32_16x16x16_bf16 v[116:119], v[138:139], v[160:161], v[116:119]
    v_mfma_f32_16x16x16_bf16 v[120:123], v[140:141], v[160:161], v[120:123]
    v_mfma_f32_16x16x16_bf16 v[124:127], v[142:143], v[160:161], v[124:127]
    s_nop 7
    s_nop 1
    v_cvt_pk_bf16_f32 v128, v96, v97
    v_cvt_pk_bf16_f32 v129, v98, v99
    v_cvt_pk_bf16_f32 v130, v100, v101
    v_cvt_pk_bf16_f32 v131, v102, v103
    v_cvt_pk_bf16_f32 v132, v104, v105
    v_cvt_pk_bf16_f32 v133, v106, v107
    v_cvt_pk_bf16_f32 v134, v108, v109
    v_cvt_pk_bf16_f32 v135, v110, v111
    v_cvt_pk_bf16_f32 v136, v112, v113
    v_cvt_pk_bf16_f32 v137, v114, v115
    v_cvt_pk_bf16_f32 v138, v116, v117
    v_cvt_pk_bf16_f32 v139, v118, v119
    v_cvt_pk_bf16_f32 v140, v120, v121
    v_cvt_pk_bf16_f32 v141, v122, v123
    v_cvt_pk_bf16_f32 v142, v124, v125
    v_cvt_pk_bf16_f32 v143, v126, v127
    s_nop 1
    v_mfma_f32_16x16x32_bf16 v[148:151], v[128:131], a[96:99], 0
    v_mfma_f32_16x16x32_bf16 v[152:155], v[128:131], a[112:115], 0
    v_mfma_f32_16x16x32_bf16 v[148:151], v[132:135], a[100:103], v[148:151]
    v_mfma_f32_16x16x32_bf16 v[152:155], v[132:135], a[116:119], v[152:155]
    v_mfma_f32_16x16x32_bf16 v[148:151], v[136:139], a[104:107], v[148:151]
    v_mfma_f32_16x16x32_bf16 v[152:155], v[136:139], a[120:123], v[152:155]
    v_mfma_f32_16x16x32_bf16 v[148:151], v[140:143], a[108:111], v[148:151]
    v_mfma_f32_16x16x32_bf16 v[152:155], v[140:143], a[124:127], v[152:155]
    s_nop 7
    s_nop 1
    s_mov_b64 s[60:61], exec
    s_mov_b64 exec, 0xffffffff
    ds_write_b32 v15, v148 offset:0
    ds_write_b32 v15, v149 offset:528
    ds_write_b32 v15, v150 offset:1056
    ds_write_b32 v15, v151 offset:1584
    ds_write_b32 v15, v152 offset:64
    ds_write_b32 v15, v153 offset:592
    ds_write_b32 v15, v154 offset:1120
    ds_write_b32 v15, v155 offset:1648
    s_mov_b64 exec, s[60:61]
    s_waitcnt lgkmcnt(0)
    s_barrier
    ds_read_b32 v148, v7 offset:0
    ds_read_b32 v149, v7 offset:256
    ds_read_b32 v150, v7 offset:528
    ds_read_b32 v151, v7 offset:784
    s_lshl_b32 s55, s53, 15
    s_waitcnt lgkmcnt(3)
    s_add_u32 s56, s55, 0
    buffer_atomic_add_f32 v148, v8, s[20:23], s56 offen
    s_waitcnt lgkmcnt(2)
    s_add_u32 s56, s55, 256
    buffer_atomic_add_f32 v149, v8, s[20:23], s56 offen
    s_waitcnt lgkmcnt(1)
    s_add_u32 s56, s55, 4096
    buffer_atomic_add_f32 v150, v8, s[20:23], s56 offen
    s_waitcnt lgkmcnt(0)
    s_add_u32 s56, s55, 4352
    buffer_atomic_add_f32 v151, v8, s[20:23], s56 offen
    s_waitcnt vmcnt(0)
    s_barrier
    s_cmp_lg_u32 s36, 0
    s_cbranch_scc1 rec_kernel_nsig235
    s_lshl_b32 s55, s53, 11
    s_and_b32 s56, s90, 15
    s_lshl_b32 s56, s56, 7
    s_add_u32 s55, s55, s56
    s_add_u32 s55, s55, 262144
    s_mov_b64 s[60:61], exec
    s_mov_b64 exec, 1
    v_mov_b32 v27, s55
    buffer_atomic_add v26, v27, s[24:27], 0 offen
    s_mov_b64 exec, s[60:61]
rec_kernel_nsig235:
    s_add_u32 s53, s53, 1
    s_branch rec_kernel_loop4
rec_kernel_done1:
    s_endpgm
.globl att_kernel
.p2align 8
.type att_kernel,@function
att_kernel:
    s_cmp_ge_u32 s2, 512
    s_cbranch_scc1 att_kernel_done1
    s_load_dwordx2 s[4:5], s[0:1], 112
    v_and_b32 v1, 63, v0
    v_lshrrev_b32 v2, 6, v0
    s_nop 0
    v_readfirstlane_b32 s36, v2
    s_lshr_b32 s33, s2, 3
    s_and_b32 s34, s2, 7
    s_lshl_b32 s34, s34, 2
    s_add_u32 s34, s34, s36
    v_and_b32 v2, 31, v1
    v_lshrrev_b32 v3, 5, v1
    s_waitcnt lgkmcnt(0)
    s_add_u32 s8, s4, 4194304
    s_addc_u32 s9, s5, 0
    s_and_b32 s9, s9, 0xffff
    s_mov_b32 s10, 50331648
    s_mov_b32 s11, 0x00020000
    s_add_u32 s12, s4, 96468992
    s_addc_u32 s13, s5, 0
    s_and_b32 s13, s13, 0xffff
    s_mov_b32 s14, 8388608
    s_mov_b32 s15, 0x00020000
    s_add_u32 s16, s4, 104857600
    s_addc_u32 s17, s5, 0
    s_and_b32 s17, s17, 0xffff
    s_mov_b32 s18, 4194304
    s_mov_b32 s19, 0x00020000
    s_add_u32 s20, s4, 54525952
    s_addc_u32 s21, s5, 0
    s_and_b32 s21, s21, 0xffff
    s_mov_b32 s22, 16777216
    s_mov_b32 s23, 0x00020000
    s_mul_i32 s40, s33, 786432
    s_lshl_b32 s41, s34, 8
    s_add_u32 s40, s40, s41
    s_mov_b32 s42, 24576
    v_mul_lo_u32 v4, s42, v2
    v_lshl_add_u32 v4, v3, 4, v4
    s_add_u32 s43, s40, 8192
    buffer_load_dwordx4 v[16:19], v4, s[8:11], s40 offen offset:0
    buffer_load_dwordx4 v[20:23], v4, s[8:11], s40 offen offset:32
    buffer_load_dwordx4 v[24:27], v4, s[8:11], s40 offen offset:64
    buffer_load_dwordx4 v[28:31], v4, s[8:11], s40 offen offset:96
    buffer_load_dwordx4 v[32:35], v4, s[8:11], s40 offen offset:128
    buffer_load_dwordx4 v[36:39], v4, s[8:11], s40 offen offset:160
    buffer_load_dwordx4 v[40:43], v4, s[8:11], s40 offen offset:192
    buffer_load_dwordx4 v[44:47], v4, s[8:11], s40 offen offset:224
    buffer_load_dwordx4 v[48:51], v4, s[8:11], s43 offen offset:0
    buffer_load_dwordx4 v[52:55], v4, s[8:11], s43 offen offset:32
    buffer_load_dwordx4 v[56:59], v4, s[8:11], s43 offen offset:64
    buffer_load_dwordx4 v[60:63], v4, s[8:11], s43 offen offset:96
    buffer_load_dwordx4 v[64:67], v4, s[8:11], s43 offen offset:128
    buffer_load_dwordx4 v[68:71], v4, s[8:11], s43 offen offset:160
    buffer_load_dwordx4 v[72:75], v4, s[8:11], s43 offen offset:192
    buffer_load_dwordx4 v[76:79], v4, s[8:11], s43 offen offset:224
    v_and_b32 v5, 7, v2
    v_lshlrev_b32 v5, 14, v5
    v_lshl_add_u32 v5, v3, 4, v5
    s_lshl_b32 s44, s33, 17
    s_add_u32 s44, s44, s41
    s_add_u32 s44, s44, 8192
    buffer_load_dwordx4 v[80:83], v5, s[12:15], s44 offen offset:0
    buffer_load_dwordx4 v[84:87], v5, s[12:15], s44 offen offset:32
    buffer_load_dwordx4 v[88:91], v5, s[12:15], s44 offen offset:64
    buffer_load_dwordx4 v[92:95], v5, s[12:15], s44 offen offset:96
    buffer_load_dwordx4 v[96:99], v5, s[12:15], s44 offen offset:128
    buffer_load_dwordx4 v[100:103], v5, s[12:15], s44 offen offset:160
    buffer_load_dwordx4 v[104:107], v5, s[12:15], s44 offen offset:192
    buffer_load_dwordx4 v[108:111], v5, s[12:15], s44 offen offset:224
    v_lshrrev_b32 v6, 4, v1
    v_mul_lo_u32 v6, s42, v6
    v_and_b32 v7, 15, v1
    v_lshl_add_u32 v6, v7, 4, v6
    s_add_u32 s45, s40, 16384
    s_lshl_b32 s46, s36, 13
    s_add_u32 s47, s45, 0
    s_add_u32 m0, s46, 0
    buffer_load_dwordx4 v6, s[8:11], s47 offen lds
    s_add_u32 s47, s45, 98304
    s_add_u32 m0, s46, 1024
    buffer_load_dwordx4 v6, s[8:11], s47 offen lds
    s_add_u32 s47, s45, 196608
    s_add_u32 m0, s46, 2048
    buffer_load_dwordx4 v6, s[8:11], s47 offen lds
    s_add_u32 s47, s45, 294912
    s_add_u32 m0, s46, 3072
    buffer_load_dwordx4 v6, s[8:11], s47 offen lds
    s_add_u32 s47, s45, 393216
    s_add_u32 m0, s46, 4096
    buffer_load_dwordx4 v6, s[8:11], s47 offen lds
    s_add_u32 s47, s45, 491520
    s_add_u32 m0, s46, 5120
    buffer_load_dwordx4 v6, s[8:11], s47 offen lds
    s_add_u32 s47, s45, 589824
    s_add_u32 m0, s46, 6144
    buffer_load_dwordx4 v6, s[8:11], s47 offen lds
    s_add_u32 s47, s45, 688128
    s_add_u32 m0, s46, 7168
    buffer_load_dwordx4 v6, s[8:11], s47 offen lds
    v_lshlrev_b32 v8, 4, v2
    v_lshl_add_u32 v8, v3, 3, v8
    s_lshl_b32 s47, s33, 16
    s_lshl_b32 s48, s34, 11
    s_add_u32 s47, s47, s48
    buffer_load_dwordx2 v[112:113], v8, s[16:19], s47 offen offset:0
    buffer_load_dwordx2 v[114:115], v8, s[16:19], s47 offen offset:512
    buffer_load_dwordx2 v[116:117], v8, s[16:19], s47 offen offset:1024
    buffer_load_dwordx2 v[118:119], v8, s[16:19], s47 offen offset:1536
    v_mov_b32 v120, 0
    v_mov_b32 v121, 0
    v_mov_b32 v122, 0
    v_mov_b32 v123, 0
    v_mov_b32 v124, 0
    v_mov_b32 v125, 0
    v_mov_b32 v126, 0
    v_mov_b32 v127, 0
    v_mov_b32 v128, 0
    v_mov_b32 v129, 0
    v_mov_b32 v130, 0
    v_mov_b32 v131, 0
    v_mov_b32 v132, 0
    v_mov_b32 v133, 0
    v_mov_b32 v134, 0
    v_mov_b32 v135, 0
    v_mov_b32 v136, 0
    v_mov_b32 v137, 0
    v_mov_b32 v138, 0
    v_mov_b32 v139, 0
    v_mov_b32 v140, 0
    v_mov_b32 v141, 0
    v_mov_b32 v142, 0
    v_mov_b32 v143, 0
    v_mov_b32 v144, 0
    v_mov_b32 v145, 0
    v_mov_b32 v146, 0
    v_mov_b32 v147, 0
    v_mov_b32 v148, 0
    v_mov_b32 v149, 0
    v_mov_b32 v150, 0
    v_mov_b32 v151, 0
    s_waitcnt vmcnt(12)
    v_mfma_f32_32x32x16_bf16 v[120:135], v[48:51], v[16:19], v[120:135]
    v_mfma_f32_32x32x16_bf16 v[136:151], v[80:83], v[16:19], v[136:151]
    v_mfma_f32_32x32x16_bf16 v[120:135], v[52:55], v[20:23], v[120:135]
    v_mfma_f32_32x32x16_bf16 v[136:151], v[84:87], v[20:23], v[136:151]
    v_mfma_f32_32x32x16_bf16 v[120:135], v[56:59], v[24:27], v[120:135]
    v_mfma_f32_32x32x16_bf16 v[136:151], v[88:91], v[24:27], v[136:151]
    v_mfma_f32_32x32x16_bf16 v[120:135], v[60:63], v[28:31], v[120:135]
    v_mfma_f32_32x32x16_bf16 v[136:151], v[92:95], v[28:31], v[136:151]
    v_mfma_f32_32x32x16_bf16 v[120:135], v[64:67], v[32:35], v[120:135]
    v_mfma_f32_32x32x16_bf16 v[136:151], v[96:99], v[32:35], v[136:151]
    v_mfma_f32_32x32x16_bf16 v[120:135], v[68:71], v[36:39], v[120:135]
    v_mfma_f32_32x32x16_bf16 v[136:151], v[100:103], v[36:39], v[136:151]
    v_mfma_f32_32x32x16_bf16 v[120:135], v[72:75], v[40:43], v[120:135]
    v_mfma_f32_32x32x16_bf16 v[136:151], v[104:107], v[40:43], v[136:151]
    v_mfma_f32_32x32x16_bf16 v[120:135], v[76:79], v[44:47], v[120:135]
    v_mfma_f32_32x32x16_bf16 v[136:151], v[108:111], v[44:47], v[136:151]
    s_nop 15
    s_nop 3
    s_mov_b32 s55, 0x3db504f3
    v_cvt_pk_bf16_f32 v9, v120, v121
    v_lshlrev_b32 v120, 16, v9
    v_and_b32 v121, 0xffff0000, v9
    v_mul_f32 v120, s55, v120
    v_mul_f32 v121, s55, v121
    v_cvt_pk_bf16_f32 v9, v120, v121
    v_lshlrev_b32 v120, 16, v9
    v_and_b32 v121, 0xffff0000, v9
    v_cvt_pk_bf16_f32 v9, v122, v123
    v_lshlrev_b32 v122, 16, v9
    v_and_b32 v123, 0xffff0000, v9
    v_mul_f32 v122, s55, v122
    v_mul_f32 v123, s55, v123
    v_cvt_pk_bf16_f32 v9, v122, v123
    v_lshlrev_b32 v122, 16, v9
    v_and_b32 v123, 0xffff0000, v9
    v_cvt_pk_bf16_f32 v9, v124, v125
    v_lshlrev_b32 v124, 16, v9
    v_and_b32 v125, 0xffff0000, v9
    v_mul_f32 v124, s55, v124
    v_mul_f32 v125, s55, v125
    v_cvt_pk_bf16_f32 v9, v124, v125
    v_lshlrev_b32 v124, 16, v9
    v_and_b32 v125, 0xffff0000, v9
    v_cvt_pk_bf16_f32 v9, v126, v127
    v_lshlrev_b32 v126, 16, v9
    v_and_b32 v127, 0xffff0000, v9
    v_mul_f32 v126, s55, v126
    v_mul_f32 v127, s55, v127
    v_cvt_pk_bf16_f32 v9, v126, v127
    v_lshlrev_b32 v126, 16, v9
    v_and_b32 v127, 0xffff0000, v9
    v_cvt_pk_bf16_f32 v9, v128, v129
    v_lshlrev_b32 v128, 16, v9
    v_and_b32 v129, 0xffff0000, v9
    v_mul_f32 v128, s55, v128
    v_mul_f32 v129, s55, v129
    v_cvt_pk_bf16_f32 v9, v128, v129
    v_lshlrev_b32 v128, 16, v9
    v_and_b32 v129, 0xffff0000, v9
    v_cvt_pk_bf16_f32 v9, v130, v131
    v_lshlrev_b32 v130, 16, v9
    v_and_b32 v131, 0xffff0000, v9
    v_mul_f32 v130, s55, v130
    v_mul_f32 v131, s55, v131
    v_cvt_pk_bf16_f32 v9, v130, v131
    v_lshlrev_b32 v130, 16, v9
    v_and_b32 v131, 0xffff0000, v9
    v_cvt_pk_bf16_f32 v9, v132, v133
    v_lshlrev_b32 v132, 16, v9
    v_and_b32 v133, 0xffff0000, v9
    v_mul_f32 v132, s55, v132
    v_mul_f32 v133, s55, v133
    v_cvt_pk_bf16_f32 v9, v132, v133
    v_lshlrev_b32 v132, 16, v9
    v_and_b32 v133, 0xffff0000, v9
    v_cvt_pk_bf16_f32 v9, v134, v135
    v_lshlrev_b32 v134, 16, v9
    v_and_b32 v135, 0xffff0000, v9
    v_mul_f32 v134, s55, v134
    v_mul_f32 v135, s55, v135
    v_cvt_pk_bf16_f32 v9, v134, v135
    v_lshlrev_b32 v134, 16, v9
    v_and_b32 v135, 0xffff0000, v9
    v_cvt_pk_bf16_f32 v9, v136, v137
    v_lshlrev_b32 v136, 16, v9
    v_and_b32 v137, 0xffff0000, v9
    v_mul_f32 v136, s55, v136
    v_mul_f32 v137, s55, v137
    v_cvt_pk_bf16_f32 v9, v136, v137
    v_lshlrev_b32 v136, 16, v9
    v_and_b32 v137, 0xffff0000, v9
    v_cvt_pk_bf16_f32 v9, v138, v139
    v_lshlrev_b32 v138, 16, v9
    v_and_b32 v139, 0xffff0000, v9
    v_mul_f32 v138, s55, v138
    v_mul_f32 v139, s55, v139
    v_cvt_pk_bf16_f32 v9, v138, v139
    v_lshlrev_b32 v138, 16, v9
    v_and_b32 v139, 0xffff0000, v9
    v_mov_b32 v10, 0xf149f2ca
    v_lshlrev_b32 v11, 2, v3
    v_sub_u32 v11, v2, v11
    v_cmp_le_i32 vcc, 0, v11
    s_nop 1
    v_cndmask_b32 v120, v10, v120, vcc
    v_cmp_le_i32 vcc, 1, v11
    s_nop 1
    v_cndmask_b32 v121, v10, v121, vcc
    v_cmp_le_i32 vcc, 2, v11
    s_nop 1
    v_cndmask_b32 v122, v10, v122, vcc
    v_cmp_le_i32 vcc, 3, v11
    s_nop 1
    v_cndmask_b32 v123, v10, v123, vcc
    v_cmp_le_i32 vcc, 8, v11
    s_nop 1
    v_cndmask_b32 v124, v10, v124, vcc
    v_cmp_le_i32 vcc, 9, v11
    s_nop 1
    v_cndmask_b32 v125, v10, v125, vcc
    v_cmp_le_i32 vcc, 10, v11
    s_nop 1
    v_cndmask_b32 v126, v10, v126, vcc
    v_cmp_le_i32 vcc, 11, v11
    s_nop 1
    v_cndmask_b32 v127, v10, v127, vcc
    v_cmp_le_i32 vcc, 16, v11
    s_nop 1
    v_cndmask_b32 v128, v10, v128, vcc
    v_cmp_le_i32 vcc, 17, v11
    s_nop 1
    v_cndmask_b32 v129, v10, v129, vcc
    v_cmp_le_i32 vcc, 18, v11
    s_nop 1
    v_cndmask_b32 v130, v10, v130, vcc
    v_cmp_le_i32 vcc, 19, v11
    s_nop 1
    v_cndmask_b32 v131, v10, v131, vcc
    v_cmp_le_i32 vcc, 24, v11
    s_nop 1
    v_cndmask_b32 v132, v10, v132, vcc
    v_cmp_le_i32 vcc, 25, v11
    s_nop 1
    v_cndmask_b32 v133, v10, v133, vcc
    v_cmp_le_i32 vcc, 26, v11
    s_nop 1
    v_cndmask_b32 v134, v10, v134, vcc
    v_cmp_le_i32 vcc, 27, v11
    s_nop 1
    v_cndmask_b32 v135, v10, v135, vcc
    v_max_f32 v9, v120, v121
    v_max_f32 v9, v9, v122
    v_max_f32 v9, v9, v123
    v_max_f32 v9, v9, v124
    v_max_f32 v9, v9, v125
    v_max_f32 v9, v9, v126
    v_max_f32 v9, v9, v127
    v_max_f32 v9, v9, v128
    v_max_f32 v9, v9, v129
    v_max_f32 v9, v9, v130
    v_max_f32 v9, v9, v131
    v_max_f32 v9, v9, v132
    v_max_f32 v9, v9, v133
    v_max_f32 v9, v9, v134
    v_max_f32 v9, v9, v135
    v_max_f32 v9, v9, v136
    v_max_f32 v9, v9, v137
    v_max_f32 v9, v9, v138
    v_max_f32 v9, v9, v139
    v_xor_b32 v12, 32, v1
    v_lshlrev_b32 v12, 2, v12
    ds_bpermute_b32 v10, v12, v9
    s_waitcnt lgkmcnt(0)
    v_max_f32 v9, v9, v10
    s_mov_b32 s55, 0x3fb8aa3b
    v_sub_f32 v120, v120, v9
    v_mul_f32 v120, s55, v120
    v_exp_f32 v120, v120
    v_sub_f32 v121, v121, v9
    v_mul_f32 v121, s55, v121
    v_exp_f32 v121, v121
    v_sub_f32 v122, v122, v9
    v_mul_f32 v122, s55, v122
    v_exp_f32 v122, v122
    v_sub_f32 v123, v123, v9
    v_mul_f32 v123, s55, v123
    v_exp_f32 v123, v123
    v_sub_f32 v124, v124, v9
    v_mul_f32 v124, s55, v124
    v_exp_f32 v124, v124
    v_sub_f32 v125, v125, v9
    v_mul_f32 v125, s55, v125
    v_exp_f32 v125, v125
    v_sub_f32 v126, v126, v9
    v_mul_f32 v126, s55, v126
    v_exp_f32 v126, v126
    v_sub_f32 v127, v127, v9
    v_mul_f32 v127, s55, v127
    v_exp_f32 v127, v127
    v_sub_f32 v128, v128, v9
    v_mul_f32 v128, s55, v128
    v_exp_f32 v128, v128
    v_sub_f32 v129, v129, v9
    v_mul_f32 v129, s55, v129
    v_exp_f32 v129, v129
    v_sub_f32 v130, v130, v9
    v_mul_f32 v130, s55, v130
    v_exp_f32 v130, v130
    v_sub_f32 v131, v131, v9
    v_mul_f32 v131, s55, v131
    v_exp_f32 v131, v131
    v_sub_f32 v132, v132, v9
    v_mul_f32 v132, s55, v132
    v_exp_f32 v132, v132
    v_sub_f32 v133, v133, v9
    v_mul_f32 v133, s55, v133
    v_exp_f32 v133, v133
    v_sub_f32 v134, v134, v9
    v_mul_f32 v134, s55, v134
    v_exp_f32 v134, v134
    v_sub_f32 v135, v135, v9
    v_mul_f32 v135, s55, v135
    v_exp_f32 v135, v135
    v_sub_f32 v136, v136, v9
    v_mul_f32 v136, s55, v136
    v_exp_f32 v136, v136
    v_sub_f32 v137, v137, v9
    v_mul_f32 v137, s55, v137
    v_exp_f32 v137, v137
    v_sub_f32 v138, v138, v9
    v_mul_f32 v138, s55, v138
    v_exp_f32 v138, v138
    v_sub_f32 v139, v139, v9
    v_mul_f32 v139, s55, v139
    v_exp_f32 v139, v139
    s_nop 0
    v_add_f32 v9, v120, v121
    v_add_f32 v9, v9, v122
    v_add_f32 v9, v9, v123
    v_add_f32 v9, v9, v124
    v_add_f32 v9, v9, v125
    v_add_f32 v9, v9, v126
    v_add_f32 v9, v9, v127
    v_add_f32 v9, v9, v128
    v_add_f32 v9, v9, v129
    v_add_f32 v9, v9, v130
    v_add_f32 v9, v9, v131
    v_add_f32 v9, v9, v132
    v_add_f32 v9, v9, v133
    v_add_f32 v9, v9, v134
    v_add_f32 v9, v9, v135
    v_add_f32 v9, v9, v136
    v_add_f32 v9, v9, v137
    v_add_f32 v9, v9, v138
    v_add_f32 v9, v9, v139
    ds_bpermute_b32 v10, v12, v9
    s_waitcnt lgkmcnt(0)
    v_add_f32 v9, v9, v10
    v_rcp_f32 v9, v9
    s_nop 0
    v_mul_f32 v120, v120, v9
    v_mul_f32 v121, v121, v9
    v_mul_f32 v122, v122, v9
    v_mul_f32 v123, v123, v9
    v_mul_f32 v124, v124, v9
    v_mul_f32 v125, v125, v9
    v_mul_f32 v126, v126, v9
    v_mul_f32 v127, v127, v9
    v_mul_f32 v128, v128, v9
    v_mul_f32 v129, v129, v9
    v_mul_f32 v130, v130, v9
    v_mul_f32 v131, v131, v9
    v_mul_f32 v132, v132, v9
    v_mul_f32 v133, v133, v9
    v_mul_f32 v134, v134, v9
    v_mul_f32 v135, v135, v9
    v_mul_f32 v136, v136, v9
    v_mul_f32 v137, v137, v9
    v_mul_f32 v138, v138, v9
    v_mul_f32 v139, v139, v9
    v_cvt_pk_bf16_f32 v16, v120, v121
    v_cvt_pk_bf16_f32 v17, v122, v123
    v_cvt_pk_bf16_f32 v18, v124, v125
    v_cvt_pk_bf16_f32 v19, v126, v127
    v_cvt_pk_bf16_f32 v20, v128, v129
    v_cvt_pk_bf16_f32 v21, v130, v131
    v_cvt_pk_bf16_f32 v22, v132, v133
    v_cvt_pk_bf16_f32 v23, v134, v135
    v_cvt_pk_bf16_f32 v24, v136, v137
    v_cvt_pk_bf16_f32 v25, v138, v139
    v_mov_b32 v26, 0
    v_mov_b32 v27, 0
    v_and_b32 v9, 15, v1
    v_lshrrev_b32 v10, 2, v9
    v_lshl_add_u32 v10, v3, 2, v10
    v_lshlrev_b32 v10, 8, v10
    v_and_b32 v9, 3, v9
    v_lshl_add_u32 v10, v9, 3, v10
    v_bfe_u32 v9, v1, 4, 1
    v_lshl_add_u32 v10, v9, 5, v10
    v_add_u32 v10, s46, v10
    s_waitcnt vmcnt(0)
    ds_read_b64_tr_b16 v[48:49], v10 offset:0
    ds_read_b64_tr_b16 v[50:51], v10 offset:2048
    ds_read_b64_tr_b16 v[52:53], v10 offset:4096
    ds_read_b64_tr_b16 v[54:55], v10 offset:6144
    ds_read_b64_tr_b16 v[56:57], v10 offset:64
    ds_read_b64_tr_b16 v[58:59], v10 offset:2112
    ds_read_b64_tr_b16 v[60:61], v10 offset:4160
    ds_read_b64_tr_b16 v[62:63], v10 offset:6208
    ds_read_b64_tr_b16 v[64:65], v10 offset:128
    ds_read_b64_tr_b16 v[66:67], v10 offset:2176
    ds_read_b64_tr_b16 v[68:69], v10 offset:4224
    ds_read_b64_tr_b16 v[70:71], v10 offset:6272
    ds_read_b64_tr_b16 v[72:73], v10 offset:192
    ds_read_b64_tr_b16 v[74:75], v10 offset:2240
    ds_read_b64_tr_b16 v[76:77], v10 offset:4288
    ds_read_b64_tr_b16 v[78:79], v10 offset:6336
    v_mov_b32 v80, v112
    v_mov_b32 v81, v113
    v_mov_b32 v82, 0
    v_mov_b32 v83, 0
    v_mov_b32 v84, v114
    v_mov_b32 v85, v115
    v_mov_b32 v86, 0
    v_mov_b32 v87, 0
    v_mov_b32 v88, v116
    v_mov_b32 v89, v117
    v_mov_b32 v90, 0
    v_mov_b32 v91, 0
    v_mov_b32 v92, v118
    v_mov_b32 v93, v119
    v_mov_b32 v94, 0
    v_mov_b32 v95, 0
    v_mov_b32 v96, 0
    v_mov_b32 v97, 0
    v_mov_b32 v98, 0
    v_mov_b32 v99, 0
    v_mov_b32 v100, 0
    v_mov_b32 v101, 0
    v_mov_b32 v102, 0
    v_mov_b32 v103, 0
    v_mov_b32 v104, 0
    v_mov_b32 v105, 0
    v_mov_b32 v106, 0
    v_mov_b32 v107, 0
    v_mov_b32 v108, 0
    v_mov_b32 v109, 0
    v_mov_b32 v110, 0
    v_mov_b32 v111, 0
    v_mov_b32 v112, 0
    v_mov_b32 v113, 0
    v_mov_b32 v114, 0
    v_mov_b32 v115, 0
    v_mov_b32 v116, 0
    v_mov_b32 v117, 0
    v_mov_b32 v118, 0
    v_mov_b32 v119, 0
    v_mov_b32 v120, 0
    v_mov_b32 v121, 0
    v_mov_b32 v122, 0
    v_mov_b32 v123, 0
    v_mov_b32 v124, 0
    v_mov_b32 v125, 0
    v_mov_b32 v126, 0
    v_mov_b32 v127, 0
    v_mov_b32 v128, 0
    v_mov_b32 v129, 0
    v_mov_b32 v130, 0
    v_mov_b32 v131, 0
    v_mov_b32 v132, 0
    v_mov_b32 v133, 0
    v_mov_b32 v134, 0
    v_mov_b32 v135, 0
    v_mov_b32 v136, 0
    v_mov_b32 v137, 0
    v_mov_b32 v138, 0
    v_mov_b32 v139, 0
    v_mov_b32 v140, 0
    v_mov_b32 v141, 0
    v_mov_b32 v142, 0
    v_mov_b32 v143, 0
    v_mov_b32 v144, 0
    v_mov_b32 v145, 0
    v_mov_b32 v146, 0
    v_mov_b32 v147, 0
    v_mov_b32 v148, 0
    v_mov_b32 v149, 0
    v_mov_b32 v150, 0
    v_mov_b32 v151, 0
    v_mov_b32 v152, 0
    v_mov_b32 v153, 0
    v_mov_b32 v154, 0
    v_mov_b32 v155, 0
    v_mov_b32 v156, 0
    v_mov_b32 v157, 0
    v_mov_b32 v158, 0
    v_mov_b32 v159, 0
    s_waitcnt lgkmcnt(0)
    v_mfma_f32_32x32x16_bf16 v[96:111], v[48:51], v[16:19], v[96:111]
    v_mfma_f32_32x32x16_bf16 v[96:111], v[52:55], v[20:23], v[96:111]
    v_mfma_f32_32x32x16_bf16 v[96:111], v[80:83], v[24:27], v[96:111]
    v_mfma_f32_32x32x16_bf16 v[112:127], v[56:59], v[16:19], v[112:127]
    v_mfma_f32_32x32x16_bf16 v[112:127], v[60:63], v[20:23], v[112:127]
    v_mfma_f32_32x32x16_bf16 v[112:127], v[84:87], v[24:27], v[112:127]
    v_mfma_f32_32x32x16_bf16 v[128:143], v[64:67], v[16:19], v[128:143]
    v_mfma_f32_32x32x16_bf16 v[128:143], v[68:71], v[20:23], v[128:143]
    v_mfma_f32_32x32x16_bf16 v[128:143], v[88:91], v[24:27], v[128:143]
    v_mfma_f32_32x32x16_bf16 v[144:159], v[72:75], v[16:19], v[144:159]
    v_mfma_f32_32x32x16_bf16 v[144:159], v[76:79], v[20:23], v[144:159]
    v_mfma_f32_32x32x16_bf16 v[144:159], v[92:95], v[24:27], v[144:159]
    s_nop 15
    s_nop 3
    v_lshlrev_b32 v4, 13, v2
    v_lshl_add_u32 v4, v3, 3, v4
    s_lshl_b32 s40, s33, 18
    s_add_u32 s40, s40, s41
    v_cvt_pk_bf16_f32 v8, v96, v97
    v_cvt_pk_bf16_f32 v9, v98, v99
    buffer_store_dwordx2 v[8:9], v4, s[20:23], s40 offen offset:0
    s_nop 1
    v_cvt_pk_bf16_f32 v8, v100, v101
    v_cvt_pk_bf16_f32 v9, v102, v103
    buffer_store_dwordx2 v[8:9], v4, s[20:23], s40 offen offset:16
    s_nop 1
    v_cvt_pk_bf16_f32 v8, v104, v105
    v_cvt_pk_bf16_f32 v9, v106, v107
    buffer_store_dwordx2 v[8:9], v4, s[20:23], s40 offen offset:32
    s_nop 1
    v_cvt_pk_bf16_f32 v8, v108, v109
    v_cvt_pk_bf16_f32 v9, v110, v111
    buffer_store_dwordx2 v[8:9], v4, s[20:23], s40 offen offset:48
    s_nop 1
    v_cvt_pk_bf16_f32 v8, v112, v113
    v_cvt_pk_bf16_f32 v9, v114, v115
    buffer_store_dwordx2 v[8:9], v4, s[20:23], s40 offen offset:64
    s_nop 1
    v_cvt_pk_bf16_f32 v8, v116, v117
    v_cvt_pk_bf16_f32 v9, v118, v119
    buffer_store_dwordx2 v[8:9], v4, s[20:23], s40 offen offset:80
    s_nop 1
    v_cvt_pk_bf16_f32 v8, v120, v121
    v_cvt_pk_bf16_f32 v9, v122, v123
    buffer_store_dwordx2 v[8:9], v4, s[20:23], s40 offen offset:96
    s_nop 1
    v_cvt_pk_bf16_f32 v8, v124, v125
    v_cvt_pk_bf16_f32 v9, v126, v127
    buffer_store_dwordx2 v[8:9], v4, s[20:23], s40 offen offset:112
    s_nop 1
    v_cvt_pk_bf16_f32 v8, v128, v129
    v_cvt_pk_bf16_f32 v9, v130, v131
    buffer_store_dwordx2 v[8:9], v4, s[20:23], s40 offen offset:128
    s_nop 1
    v_cvt_pk_bf16_f32 v8, v132, v133
    v_cvt_pk_bf16_f32 v9, v134, v135
    buffer_store_dwordx2 v[8:9], v4, s[20:23], s40 offen offset:144
    s_nop 1
    v_cvt_pk_bf16_f32 v8, v136, v137
    v_cvt_pk_bf16_f32 v9, v138, v139
    buffer_store_dwordx2 v[8:9], v4, s[20:23], s40 offen offset:160
    s_nop 1
    v_cvt_pk_bf16_f32 v8, v140, v141
    v_cvt_pk_bf16_f32 v9, v142, v143
    buffer_store_dwordx2 v[8:9], v4, s[20:23], s40 offen offset:176
    s_nop 1
    v_cvt_pk_bf16_f32 v8, v144, v145
    v_cvt_pk_bf16_f32 v9, v146, v147
    buffer_store_dwordx2 v[8:9], v4, s[20:23], s40 offen offset:192
    s_nop 1
    v_cvt_pk_bf16_f32 v8, v148, v149
    v_cvt_pk_bf16_f32 v9, v150, v151
    buffer_store_dwordx2 v[8:9], v4, s[20:23], s40 offen offset:208
    s_nop 1
    v_cvt_pk_bf16_f32 v8, v152, v153
    v_cvt_pk_bf16_f32 v9, v154, v155
    buffer_store_dwordx2 v[8:9], v4, s[20:23], s40 offen offset:224
    s_nop 1
    v_cvt_pk_bf16_f32 v8, v156, v157
    v_cvt_pk_bf16_f32 v9, v158, v159
    buffer_store_dwordx2 v[8:9], v4, s[20:23], s40 offen offset:240
    s_nop 1
att_kernel_done1:
    s_endpgm
.globl goa_kernel
.p2align 8
.type goa_kernel,@function
goa_kernel:
    s_cmp_ge_u32 s2, 256
    s_cbranch_scc1 goa_kernel_done1
    s_load_dwordx2 s[4:5], s[0:1], 112
    s_load_dwordx2 s[40:41], s[0:1], 40
    s_load_dwordx2 s[52:53], s[0:1], 0
    s_mov_b32 s34, 268435457
    s_mul_hi_u32 s35, s2, s34
    s_mul_i32 s36, s35, 16
    s_sub_u32 s34, s2, s36
    v_and_b32 v1, 63, v0
    v_lshrrev_b32 v17, 6, v0
    s_nop 0
    v_readfirstlane_b32 s37, v17
    s_waitcnt lgkmcnt(0)
    s_mul_i32 s38, s35, 1048576
    s_add_u32 s38, s38, 54525952
    s_add_u32 s8, s4, s38
    s_addc_u32 s9, s5, 0
    s_and_b32 s9, s9, 0xffff
    s_mov_b32 s10, 1048576
    s_mov_b32 s11, 0x00020000
    s_mul_i32 s38, s34, 64
    s_add_u32 s38, s38, 0
    s_mov_b32 s54, s40
    s_mov_b32 s55, s41
    s_lshl_b32 s38, s38, 1
    s_add_u32 s12, s54, s38
    s_addc_u32 s13, s55, 0
    s_and_b32 s13, s13, 0xffff
    s_sub_u32 s14, 8388608, s38
    s_mov_b32 s15, 0x00020000
    s_add_u32 s28, s4, 71303168
    s_addc_u32 s29, s5, 0
    s_and_b32 s29, s29, 0xffff
    s_mov_b32 s30, 4194304
    s_mov_b32 s31, 0x00020000
    s_mov_b32 s56, s52
    s_and_b32 s57, s53, 0xffff
    s_mov_b32 s58, 4194304
    s_mov_b32 s59, 0x00020000
    v_lshrrev_b32 v17, 3, v1
    v_and_b32 v18, 7, v1
    v_lshrrev_b32 v19, 4, v1
    v_xor_b32 v20, v18, v19
    v_xor_b32 v21, 4, v20
    s_mov_b32 s38, 8192
    v_mul_lo_u32 v22, s38, v17
    v_lshl_add_u32 v2, v20, 4, v22
    v_lshl_add_u32 v3, v21, 4, v22
    v_and_b32 v20, 1, v19
    v_lshlrev_b32 v20, 2, v20
    v_xor_b32 v20, v18, v20
    s_mov_b32 s38, 2048
    v_mul_lo_u32 v22, s38, v17
    v_lshl_add_u32 v4, v20, 4, v22
    s_and_b32 s38, s37, 3
    s_lshr_b32 s39, s37, 2
    v_and_b32 v17, 31, v1
    v_lshrrev_b32 v18, 5, v1
    v_lshrrev_b32 v19, 1, v17
    v_and_b32 v19, 7, v19
    s_mul_i32 s54, s38, 4096
    v_add_u32 v20, 0, v18
    v_xor_b32 v20, v20, v19
    v_lshlrev_b32 v20, 4, v20
    v_lshl_add_u32 v20, v17, 7, v20
    v_add_u32 v5, s54, v20
    v_add_u32 v20, 2, v18
    v_xor_b32 v20, v20, v19
    v_lshlrev_b32 v20, 4, v20
    v_lshl_add_u32 v20, v17, 7, v20
    v_add_u32 v6, s54, v20
    v_add_u32 v20, 4, v18
    v_xor_b32 v20, v20, v19
    v_lshlrev_b32 v20, 4, v20
    v_lshl_add_u32 v20, v17, 7, v20
    v_add_u32 v7, s54, v20
    v_add_u32 v20, 6, v18
    v_xor_b32 v20, v20, v19
    v_lshlrev_b32 v20, 4, v20
    v_lshl_add_u32 v20, v17, 7, v20
    v_add_u32 v8, s54, v20
    v_and_b32 v17, 15, v1
    v_lshrrev_b32 v19, 2, v17
    v_and_b32 v20, 3, v17
    v_bfe_u32 v21, v1, 4, 1
    v_lshlrev_b32 v22, 1, v21
    v_lshrrev_b32 v23, 1, v20
    v_add_u32 v22, v22, v23
    v_bfe_u32 v23, v19, 1, 1
    v_lshlrev_b32 v23, 2, v23
    v_xor_b32 v22, v22, v23
    v_lshlrev_b32 v22, 4, v22
    v_and_b32 v23, 1, v20
    v_lshl_add_u32 v22, v23, 3, v22
    v_lshl_add_u32 v23, v18, 3, v19
    v_lshl_add_u32 v22, v23, 7, v22
    v_add_u32 v9, 16384, v22
    v_xor_b32 v10, 64, v9
    s_mul_i32 s55, s39, 2
    v_accvgpr_write_b32 a0, 0
    v_accvgpr_write_b32 a1, 0
    v_accvgpr_write_b32 a2, 0
    v_accvgpr_write_b32 a3, 0
    v_accvgpr_write_b32 a4, 0
    v_accvgpr_write_b32 a5, 0
    v_accvgpr_write_b32 a6, 0
    v_accvgpr_write_b32 a7, 0
    v_accvgpr_write_b32 a8, 0
    v_accvgpr_write_b32 a9, 0
    v_accvgpr_write_b32 a10, 0
    v_accvgpr_write_b32 a11, 0
    v_accvgpr_write_b32 a12, 0
    v_accvgpr_write_b32 a13, 0
    v_accvgpr_write_b32 a14, 0
    v_accvgpr_write_b32 a15, 0
    v_accvgpr_write_b32 a16, 0
    v_accvgpr_write_b32 a17, 0
    v_accvgpr_write_b32 a18, 0
    v_accvgpr_write_b32 a19, 0
    v_accvgpr_write_b32 a20, 0
    v_accvgpr_write_b32 a21, 0
    v_accvgpr_write_b32 a22, 0
    v_accvgpr_write_b32 a23, 0
    v_accvgpr_write_b32 a24, 0
    v_accvgpr_write_b32 a25, 0
    v_accvgpr_write_b32 a26, 0
    v_accvgpr_write_b32 a27, 0
    v_accvgpr_write_b32 a28, 0
    v_accvgpr_write_b32 a29, 0
    v_accvgpr_write_b32 a30, 0
    v_accvgpr_write_b32 a31, 0
    s_mul_i32 s67, s37, 4
    s_mul_i32 s68, s37, 2
    s_mov_b32 s64, 0
    s_mov_b32 s65, 0
    s_mov_b32 s66, 0
    s_add_u32 s69, s67, 0
    s_mul_i32 s70, s69, 65536
    s_add_u32 s70, s70, s64
    s_lshl_b32 s69, s69, 10
    s_add_u32 m0, s69, s66
    buffer_load_dwordx4 v2, s[8:11], s70 offen lds
    s_add_u32 s69, s67, 1
    s_mul_i32 s70, s69, 65536
    s_add_u32 s70, s70, s64
    s_lshl_b32 s69, s69, 10
    s_add_u32 m0, s69, s66
    buffer_load_dwordx4 v3, s[8:11], s70 offen lds
    s_add_u32 s69, s67, 2
    s_mul_i32 s70, s69, 65536
    s_add_u32 s70, s70, s64
    s_lshl_b32 s69, s69, 10
    s_add_u32 m0, s69, s66
    buffer_load_dwordx4 v2, s[8:11], s70 offen lds
    s_add_u32 s69, s67, 3
    s_mul_i32 s70, s69, 65536
    s_add_u32 s70, s70, s64
    s_lshl_b32 s69, s69, 10
    s_add_u32 m0, s69, s66
    buffer_load_dwordx4 v3, s[8:11], s70 offen lds
    s_add_u32 s69, s68, 0
    s_and_b32 s71, s69, 7
    s_mul_i32 s70, s71, 16384
    s_add_u32 s70, s70, s65
    s_lshl_b32 s72, s69, 10
    s_add_u32 s72, s72, s66
    s_add_u32 m0, s72, 16384
    buffer_load_dwordx4 v4, s[12:15], s70 offen lds
    s_add_u32 s69, s68, 1
    s_and_b32 s71, s69, 7
    s_mul_i32 s70, s71, 16384
    s_add_u32 s70, s70, s65
    s_lshl_b32 s72, s69, 10
    s_add_u32 s72, s72, s66
    s_add_u32 m0, s72, 16384
    buffer_load_dwordx4 v4, s[12:15], s70 offen lds
    s_mov_b32 s64, 128
    s_mov_b32 s65, 131072
    s_mov_b32 s66, 24576
    s_add_u32 s69, s67, 0
    s_mul_i32 s70, s69, 65536
    s_add_u32 s70, s70, s64
    s_lshl_b32 s69, s69, 10
    s_add_u32 m0, s69, s66
    buffer_load_dwordx4 v2, s[8:11], s70 offen lds
    s_add_u32 s69, s67, 1
    s_mul_i32 s70, s69, 65536
    s_add_u32 s70, s70, s64
    s_lshl_b32 s69, s69, 10
    s_add_u32 m0, s69, s66
    buffer_load_dwordx4 v3, s[8:11], s70 offen lds
    s_add_u32 s69, s67, 2
    s_mul_i32 s70, s69, 65536
    s_add_u32 s70, s70, s64
    s_lshl_b32 s69, s69, 10
    s_add_u32 m0, s69, s66
    buffer_load_dwordx4 v2, s[8:11], s70 offen lds
    s_add_u32 s69, s67, 3
    s_mul_i32 s70, s69, 65536
    s_add_u32 s70, s70, s64
    s_lshl_b32 s69, s69, 10
    s_add_u32 m0, s69, s66
    buffer_load_dwordx4 v3, s[8:11], s70 offen lds
    s_add_u32 s69, s68, 0
    s_and_b32 s71, s69, 7
    s_mul_i32 s70, s71, 16384
    s_add_u32 s70, s70, s65
    s_lshl_b32 s72, s69, 10
    s_add_u32 s72, s72, s66
    s_add_u32 m0, s72, 16384
    buffer_load_dwordx4 v4, s[12:15], s70 offen lds
    s_add_u32 s69, s68, 1
    s_and_b32 s71, s69, 7
    s_mul_i32 s70, s71, 16384
    s_add_u32 s70, s70, s65
    s_lshl_b32 s72, s69, 10
    s_add_u32 s72, s72, s66
    s_add_u32 m0, s72, 16384
    buffer_load_dwordx4 v4, s[12:15], s70 offen lds
    s_mov_b32 s73, 0
    s_mov_b32 s74, 0
    s_mov_b32 s66, 49152
goa_kernel_loop2:
    s_waitcnt vmcnt(6)
    s_barrier
    s_add_u32 s64, s64, 128
    s_add_u32 s65, s65, 131072
    s_add_u32 s69, s67, 0
    s_mul_i32 s70, s69, 65536
    s_add_u32 s70, s70, s64
    s_lshl_b32 s69, s69, 10
    s_add_u32 m0, s69, s66
    buffer_load_dwordx4 v2, s[8:11], s70 offen lds
    s_add_u32 s69, s67, 1
    s_mul_i32 s70, s69, 65536
    s_add_u32 s70, s70, s64
    s_lshl_b32 s69, s69, 10
    s_add_u32 m0, s69, s66
    buffer_load_dwordx4 v3, s[8:11], s70 offen lds
    s_add_u32 s69, s67, 2
    s_mul_i32 s70, s69, 65536
    s_add_u32 s70, s70, s64
    s_lshl_b32 s69, s69, 10
    s_add_u32 m0, s69, s66
    buffer_load_dwordx4 v2, s[8:11], s70 offen lds
    s_add_u32 s69, s67, 3
    s_mul_i32 s70, s69, 65536
    s_add_u32 s70, s70, s64
    s_lshl_b32 s69, s69, 10
    s_add_u32 m0, s69, s66
    buffer_load_dwordx4 v3, s[8:11], s70 offen lds
    s_add_u32 s69, s68, 0
    s_and_b32 s71, s69, 7
    s_mul_i32 s70, s71, 16384
    s_add_u32 s70, s70, s65
    s_lshl_b32 s72, s69, 10
    s_add_u32 s72, s72, s66
    s_add_u32 m0, s72, 16384
    buffer_load_dwordx4 v4, s[12:15], s70 offen lds
    s_add_u32 s69, s68, 1
    s_and_b32 s71, s69, 7
    s_mul_i32 s70, s71, 16384
    s_add_u32 s70, s70, s65
    s_lshl_b32 s72, s69, 10
    s_add_u32 s72, s72, s66
    s_add_u32 m0, s72, 16384
    buffer_load_dwordx4 v4, s[12:15], s70 offen lds
    s_add_u32 s66, s66, 24576
    s_cmp_ge_u32 s66, 73728
    s_cselect_b32 s75, 73728, 0
    s_sub_u32 s66, s66, s75
    v_add_u32 v11, s74, v5
    v_add_u32 v12, s74, v6
    v_add_u32 v13, s74, v7
    v_add_u32 v14, s74, v8
    v_add_u32 v15, s74, v9
    v_add_u32 v16, s74, v10
    s_add_u32 s76, s55, 0
    s_and_b32 s77, s76, 1
    s_lshr_b32 s76, s76, 1
    s_mul_i32 s76, s76, 8192
    s_cmp_eq_u32 s77, 0
    s_cselect_b64 s[78:79], -1, 0
    v_cndmask_b32 v17, v16, v15, s[78:79]
    v_add_u32 v17, s76, v17
    s_add_u32 s76, s55, 1
    s_and_b32 s77, s76, 1
    s_lshr_b32 s76, s76, 1
    s_mul_i32 s76, s76, 8192
    s_cmp_eq_u32 s77, 0
    s_cselect_b64 s[78:79], -1, 0
    v_cndmask_b32 v18, v16, v15, s[78:79]
    v_add_u32 v18, s76, v18
    ds_read_b128 v[24:27], v11 offset:0
    ds_read_b64_tr_b16 v[32:33], v17 offset:0
    ds_read_b64_tr_b16 v[34:35], v17 offset:512
    ds_read_b64_tr_b16 v[36:37], v18 offset:0
    ds_read_b64_tr_b16 v[38:39], v18 offset:512
    ds_read_b128 v[28:31], v12 offset:0
    ds_read_b64_tr_b16 v[40:41], v17 offset:2048
    ds_read_b64_tr_b16 v[42:43], v17 offset:2560
    ds_read_b64_tr_b16 v[44:45], v18 offset:2048
    ds_read_b64_tr_b16 v[46:47], v18 offset:2560
    s_waitcnt lgkmcnt(5)
    v_mfma_f32_32x32x16_bf16 a[0:15], v[32:35], v[24:27], a[0:15]
    v_mfma_f32_32x32x16_bf16 a[16:31], v[36:39], v[24:27], a[16:31]
    ds_read_b128 v[24:27], v13 offset:0
    ds_read_b64_tr_b16 v[32:33], v17 offset:4096
    ds_read_b64_tr_b16 v[34:35], v17 offset:4608
    ds_read_b64_tr_b16 v[36:37], v18 offset:4096
    ds_read_b64_tr_b16 v[38:39], v18 offset:4608
    s_waitcnt lgkmcnt(5)
    v_mfma_f32_32x32x16_bf16 a[0:15], v[40:43], v[28:31], a[0:15]
    v_mfma_f32_32x32x16_bf16 a[16:31], v[44:47], v[28:31], a[16:31]
    ds_read_b128 v[28:31], v14 offset:0
    ds_read_b64_tr_b16 v[40:41], v17 offset:6144
    ds_read_b64_tr_b16 v[42:43], v17 offset:6656
    ds_read_b64_tr_b16 v[44:45], v18 offset:6144
    ds_read_b64_tr_b16 v[46:47], v18 offset:6656
    s_waitcnt lgkmcnt(5)
    v_mfma_f32_32x32x16_bf16 a[0:15], v[32:35], v[24:27], a[0:15]
    v_mfma_f32_32x32x16_bf16 a[16:31], v[36:39], v[24:27], a[16:31]
    s_waitcnt lgkmcnt(0)
    v_mfma_f32_32x32x16_bf16 a[0:15], v[40:43], v[28:31], a[0:15]
    v_mfma_f32_32x32x16_bf16 a[16:31], v[44:47], v[28:31], a[16:31]
    s_add_u32 s74, s74, 24576
    s_cmp_ge_u32 s74, 73728
    s_cselect_b32 s75, 73728, 0
    s_sub_u32 s74, s74, s75
    s_add_u32 s73, s73, 1
    s_cmp_lt_u32 s73, 64
    s_cbranch_scc1 goa_kernel_loop2
    s_nop 15
    s_nop 3
    v_and_b32 v17, 31, v1
    v_lshrrev_b32 v18, 5, v1
    s_mul_i32 s64, s35, 128
    s_mul_i32 s65, s38, 32
    s_add_u32 s64, s64, s65
    v_add_u32 v17, s64, v17
    s_mov_b32 s65, 2048
    v_mul_lo_u32 v17, s65, v17
    s_mul_i32 s64, s34, 64
    s_lshl_b32 s65, s55, 5
    s_add_u32 s64, s64, s65
    v_lshlrev_b32 v18, 2, v18
    v_add_u32 v18, s64, v18
    v_lshlrev_b32 v18, 1, v18
    v_add_u32 v17, v17, v18
    s_mov_b32 s66, 0
    buffer_load_dwordx2 v[20:21], v17, s[56:59], s66 offen offset:0
    v_accvgpr_read_b32 v24, a0
    v_accvgpr_read_b32 v25, a1
    v_accvgpr_read_b32 v26, a2
    v_accvgpr_read_b32 v27, a3
    s_waitcnt vmcnt(0)
    v_cvt_pk_bf16_f32 v28, v24, v25
    v_cvt_pk_bf16_f32 v29, v26, v27
    v_lshlrev_b32 v24, 16, v28
    v_and_b32 v25, 0xffff0000, v28
    v_lshlrev_b32 v26, 16, v29
    v_and_b32 v27, 0xffff0000, v29
    v_lshlrev_b32 v28, 16, v20
    v_and_b32 v29, 0xffff0000, v20
    v_lshlrev_b32 v30, 16, v21
    v_and_b32 v31, 0xffff0000, v21
    v_add_f32 v24, v24, v28
    v_add_f32 v25, v25, v29
    v_add_f32 v26, v26, v30
    v_add_f32 v27, v27, v31
    v_cvt_pk_bf16_f32 v28, v24, v25
    v_cvt_pk_bf16_f32 v29, v26, v27
    s_mov_b32 s66, 0
    buffer_store_dwordx2 v[28:29], v17, s[28:31], s66 offen offset:0
    s_nop 1
    s_mov_b32 s66, 0
    buffer_load_dwordx2 v[20:21], v17, s[56:59], s66 offen offset:16
    v_accvgpr_read_b32 v24, a4
    v_accvgpr_read_b32 v25, a5
    v_accvgpr_read_b32 v26, a6
    v_accvgpr_read_b32 v27, a7
    s_waitcnt vmcnt(0)
    v_cvt_pk_bf16_f32 v28, v24, v25
    v_cvt_pk_bf16_f32 v29, v26, v27
    v_lshlrev_b32 v24, 16, v28
    v_and_b32 v25, 0xffff0000, v28
    v_lshlrev_b32 v26, 16, v29
    v_and_b32 v27, 0xffff0000, v29
    v_lshlrev_b32 v28, 16, v20
    v_and_b32 v29, 0xffff0000, v20
    v_lshlrev_b32 v30, 16, v21
    v_and_b32 v31, 0xffff0000, v21
    v_add_f32 v24, v24, v28
    v_add_f32 v25, v25, v29
    v_add_f32 v26, v26, v30
    v_add_f32 v27, v27, v31
    v_cvt_pk_bf16_f32 v28, v24, v25
    v_cvt_pk_bf16_f32 v29, v26, v27
    s_mov_b32 s66, 0
    buffer_store_dwordx2 v[28:29], v17, s[28:31], s66 offen offset:16
    s_nop 1
    s_mov_b32 s66, 0
    buffer_load_dwordx2 v[20:21], v17, s[56:59], s66 offen offset:32
    v_accvgpr_read_b32 v24, a8
    v_accvgpr_read_b32 v25, a9
    v_accvgpr_read_b32 v26, a10
    v_accvgpr_read_b32 v27, a11
    s_waitcnt vmcnt(0)
    v_cvt_pk_bf16_f32 v28, v24, v25
    v_cvt_pk_bf16_f32 v29, v26, v27
    v_lshlrev_b32 v24, 16, v28
    v_and_b32 v25, 0xffff0000, v28
    v_lshlrev_b32 v26, 16, v29
    v_and_b32 v27, 0xffff0000, v29
    v_lshlrev_b32 v28, 16, v20
    v_and_b32 v29, 0xffff0000, v20
    v_lshlrev_b32 v30, 16, v21
    v_and_b32 v31, 0xffff0000, v21
    v_add_f32 v24, v24, v28
    v_add_f32 v25, v25, v29
    v_add_f32 v26, v26, v30
    v_add_f32 v27, v27, v31
    v_cvt_pk_bf16_f32 v28, v24, v25
    v_cvt_pk_bf16_f32 v29, v26, v27
    s_mov_b32 s66, 0
    buffer_store_dwordx2 v[28:29], v17, s[28:31], s66 offen offset:32
    s_nop 1
    s_mov_b32 s66, 0
    buffer_load_dwordx2 v[20:21], v17, s[56:59], s66 offen offset:48
    v_accvgpr_read_b32 v24, a12
    v_accvgpr_read_b32 v25, a13
    v_accvgpr_read_b32 v26, a14
    v_accvgpr_read_b32 v27, a15
    s_waitcnt vmcnt(0)
    v_cvt_pk_bf16_f32 v28, v24, v25
    v_cvt_pk_bf16_f32 v29, v26, v27
    v_lshlrev_b32 v24, 16, v28
    v_and_b32 v25, 0xffff0000, v28
    v_lshlrev_b32 v26, 16, v29
    v_and_b32 v27, 0xffff0000, v29
    v_lshlrev_b32 v28, 16, v20
    v_and_b32 v29, 0xffff0000, v20
    v_lshlrev_b32 v30, 16, v21
    v_and_b32 v31, 0xffff0000, v21
    v_add_f32 v24, v24, v28
    v_add_f32 v25, v25, v29
    v_add_f32 v26, v26, v30
    v_add_f32 v27, v27, v31
    v_cvt_pk_bf16_f32 v28, v24, v25
    v_cvt_pk_bf16_f32 v29, v26, v27
    s_mov_b32 s66, 0
    buffer_store_dwordx2 v[28:29], v17, s[28:31], s66 offen offset:48
    s_nop 1
    s_mov_b32 s66, 0
    buffer_load_dwordx2 v[20:21], v17, s[56:59], s66 offen offset:64
    v_accvgpr_read_b32 v24, a16
    v_accvgpr_read_b32 v25, a17
    v_accvgpr_read_b32 v26, a18
    v_accvgpr_read_b32 v27, a19
    s_waitcnt vmcnt(0)
    v_cvt_pk_bf16_f32 v28, v24, v25
    v_cvt_pk_bf16_f32 v29, v26, v27
    v_lshlrev_b32 v24, 16, v28
    v_and_b32 v25, 0xffff0000, v28
    v_lshlrev_b32 v26, 16, v29
    v_and_b32 v27, 0xffff0000, v29
    v_lshlrev_b32 v28, 16, v20
    v_and_b32 v29, 0xffff0000, v20
    v_lshlrev_b32 v30, 16, v21
    v_and_b32 v31, 0xffff0000, v21
    v_add_f32 v24, v24, v28
    v_add_f32 v25, v25, v29
    v_add_f32 v26, v26, v30
    v_add_f32 v27, v27, v31
    v_cvt_pk_bf16_f32 v28, v24, v25
    v_cvt_pk_bf16_f32 v29, v26, v27
    s_mov_b32 s66, 0
    buffer_store_dwordx2 v[28:29], v17, s[28:31], s66 offen offset:64
    s_nop 1
    s_mov_b32 s66, 0
    buffer_load_dwordx2 v[20:21], v17, s[56:59], s66 offen offset:80
    v_accvgpr_read_b32 v24, a20
    v_accvgpr_read_b32 v25, a21
    v_accvgpr_read_b32 v26, a22
    v_accvgpr_read_b32 v27, a23
    s_waitcnt vmcnt(0)
    v_cvt_pk_bf16_f32 v28, v24, v25
    v_cvt_pk_bf16_f32 v29, v26, v27
    v_lshlrev_b32 v24, 16, v28
    v_and_b32 v25, 0xffff0000, v28
    v_lshlrev_b32 v26, 16, v29
    v_and_b32 v27, 0xffff0000, v29
    v_lshlrev_b32 v28, 16, v20
    v_and_b32 v29, 0xffff0000, v20
    v_lshlrev_b32 v30, 16, v21
    v_and_b32 v31, 0xffff0000, v21
    v_add_f32 v24, v24, v28
    v_add_f32 v25, v25, v29
    v_add_f32 v26, v26, v30
    v_add_f32 v27, v27, v31
    v_cvt_pk_bf16_f32 v28, v24, v25
    v_cvt_pk_bf16_f32 v29, v26, v27
    s_mov_b32 s66, 0
    buffer_store_dwordx2 v[28:29], v17, s[28:31], s66 offen offset:80
    s_nop 1
    s_mov_b32 s66, 0
    buffer_load_dwordx2 v[20:21], v17, s[56:59], s66 offen offset:96
    v_accvgpr_read_b32 v24, a24
    v_accvgpr_read_b32 v25, a25
    v_accvgpr_read_b32 v26, a26
    v_accvgpr_read_b32 v27, a27
    s_waitcnt vmcnt(0)
    v_cvt_pk_bf16_f32 v28, v24, v25
    v_cvt_pk_bf16_f32 v29, v26, v27
    v_lshlrev_b32 v24, 16, v28
    v_and_b32 v25, 0xffff0000, v28
    v_lshlrev_b32 v26, 16, v29
    v_and_b32 v27, 0xffff0000, v29
    v_lshlrev_b32 v28, 16, v20
    v_and_b32 v29, 0xffff0000, v20
    v_lshlrev_b32 v30, 16, v21
    v_and_b32 v31, 0xffff0000, v21
    v_add_f32 v24, v24, v28
    v_add_f32 v25, v25, v29
    v_add_f32 v26, v26, v30
    v_add_f32 v27, v27, v31
    v_cvt_pk_bf16_f32 v28, v24, v25
    v_cvt_pk_bf16_f32 v29, v26, v27
    s_mov_b32 s66, 0
    buffer_store_dwordx2 v[28:29], v17, s[28:31], s66 offen offset:96
    s_nop 1
    s_mov_b32 s66, 0
    buffer_load_dwordx2 v[20:21], v17, s[56:59], s66 offen offset:112
    v_accvgpr_read_b32 v24, a28
    v_accvgpr_read_b32 v25, a29
    v_accvgpr_read_b32 v26, a30
    v_accvgpr_read_b32 v27, a31
    s_waitcnt vmcnt(0)
    v_cvt_pk_bf16_f32 v28, v24, v25
    v_cvt_pk_bf16_f32 v29, v26, v27
    v_lshlrev_b32 v24, 16, v28
    v_and_b32 v25, 0xffff0000, v28
    v_lshlrev_b32 v26, 16, v29
    v_and_b32 v27, 0xffff0000, v29
    v_lshlrev_b32 v28, 16, v20
    v_and_b32 v29, 0xffff0000, v20
    v_lshlrev_b32 v30, 16, v21
    v_and_b32 v31, 0xffff0000, v21
    v_add_f32 v24, v24, v28
    v_add_f32 v25, v25, v29
    v_add_f32 v26, v26, v30
    v_add_f32 v27, v27, v31
    v_cvt_pk_bf16_f32 v28, v24, v25
    v_cvt_pk_bf16_f32 v29, v26, v27
    s_mov_b32 s66, 0
    buffer_store_dwordx2 v[28:29], v17, s[28:31], s66 offen offset:112
    s_nop 1
goa_kernel_done1:
    s_endpgm
.globl ln2_kernel
.p2align 8
.type ln2_kernel,@function
ln2_kernel:
    s_cmp_ge_u32 s2, 512
    s_cbranch_scc1 ln2_kernel_done1
    s_load_dwordx2 s[4:5], s[0:1], 112
    s_waitcnt lgkmcnt(0)
    s_add_u32 s8, s4, 71303168
    s_addc_u32 s9, s5, 0
    s_and_b32 s9, s9, 0xffff
    s_mov_b32 s10, 4194304
    s_mov_b32 s11, 0x00020000
    s_add_u32 s12, s4, 0
    s_addc_u32 s13, s5, 0
    s_and_b32 s13, s13, 0xffff
    s_mov_b32 s14, 4194304
    s_mov_b32 s15, 0x00020000
    v_and_b32 v1, 63, v0
    v_lshrrev_b32 v2, 6, v0
    s_lshl_b32 s3, s2, 2
    v_add_u32 v2, s3, v2
    v_lshlrev_b32 v3, 11, v2
    v_lshl_add_u32 v3, v1, 4, v3
    buffer_load_dwordx4 v[4:7], v3, s[8:11], 0 offen
    buffer_load_dwordx4 v[8:11], v3, s[8:11], 0 offen offset:1024
    v_xor_b32 v50, 1, v1
    v_lshlrev_b32 v50, 2, v50
    v_xor_b32 v51, 2, v1
    v_lshlrev_b32 v51, 2, v51
    v_xor_b32 v52, 4, v1
    v_lshlrev_b32 v52, 2, v52
    v_xor_b32 v53, 8, v1
    v_lshlrev_b32 v53, 2, v53
    v_xor_b32 v54, 16, v1
    v_lshlrev_b32 v54, 2, v54
    v_xor_b32 v55, 32, v1
    v_lshlrev_b32 v55, 2, v55
    s_waitcnt vmcnt(0)
    v_lshlrev_b32 v16, 16, v4
    v_and_b32 v17, 0xffff0000, v4
    v_lshlrev_b32 v18, 16, v5
    v_and_b32 v19, 0xffff0000, v5
    v_lshlrev_b32 v20, 16, v6
    v_and_b32 v21, 0xffff0000, v6
    v_lshlrev_b32 v22, 16, v7
    v_and_b32 v23, 0xffff0000, v7
    v_lshlrev_b32 v24, 16, v8
    v_and_b32 v25, 0xffff0000, v8
    v_lshlrev_b32 v26, 16, v9
    v_and_b32 v27, 0xffff0000, v9
    v_lshlrev_b32 v28, 16, v10
    v_and_b32 v29, 0xffff0000, v10
    v_lshlrev_b32 v30, 16, v11
    v_and_b32 v31, 0xffff0000, v11
    v_add_f32 v40, v16, v17
    v_add_f32 v40, v40, v18
    v_add_f32 v40, v40, v19
    v_add_f32 v40, v40, v20
    v_add_f32 v40, v40, v21
    v_add_f32 v40, v40, v22
    v_add_f32 v40, v40, v23
    v_add_f32 v40, v40, v24
    v_add_f32 v40, v40, v25
    v_add_f32 v40, v40, v26
    v_add_f32 v40, v40, v27
    v_add_f32 v40, v40, v28
    v_add_f32 v40, v40, v29
    v_add_f32 v40, v40, v30
    v_add_f32 v40, v40, v31
    ds_bpermute_b32 v48, v50, v40
    s_waitcnt lgkmcnt(0)
    v_add_f32 v40, v40, v48
    ds_bpermute_b32 v48, v51, v40
    s_waitcnt lgkmcnt(0)
    v_add_f32 v40, v40, v48
    ds_bpermute_b32 v48, v52, v40
    s_waitcnt lgkmcnt(0)
    v_add_f32 v40, v40, v48
    ds_bpermute_b32 v48, v53, v40
    s_waitcnt lgkmcnt(0)
    v_add_f32 v40, v40, v48
    ds_bpermute_b32 v48, v54, v40
    s_waitcnt lgkmcnt(0)
    v_add_f32 v40, v40, v48
    ds_bpermute_b32 v48, v55, v40
    s_waitcnt lgkmcnt(0)
    v_add_f32 v40, v40, v48
    v_mul_f32 v40, 0x3a800000, v40
    v_sub_f32 v41, v16, v40
    v_mul_f32 v42, v41, v41
    v_sub_f32 v41, v17, v40
    v_fmac_f32 v42, v41, v41
    v_sub_f32 v41, v18, v40
    v_fmac_f32 v42, v41, v41
    v_sub_f32 v41, v19, v40
    v_fmac_f32 v42, v41, v41
    v_sub_f32 v41, v20, v40
    v_fmac_f32 v42, v41, v41
    v_sub_f32 v41, v21, v40
    v_fmac_f32 v42, v41, v41
    v_sub_f32 v41, v22, v40
    v_fmac_f32 v42, v41, v41
    v_sub_f32 v41, v23, v40
    v_fmac_f32 v42, v41, v41
    v_sub_f32 v41, v24, v40
    v_fmac_f32 v42, v41, v41
    v_sub_f32 v41, v25, v40
    v_fmac_f32 v42, v41, v41
    v_sub_f32 v41, v26, v40
    v_fmac_f32 v42, v41, v41
    v_sub_f32 v41, v27, v40
    v_fmac_f32 v42, v41, v41
    v_sub_f32 v41, v28, v40
    v_fmac_f32 v42, v41, v41
    v_sub_f32 v41, v29, v40
    v_fmac_f32 v42, v41, v41
    v_sub_f32 v41, v30, v40
    v_fmac_f32 v42, v41, v41
    v_sub_f32 v41, v31, v40
    v_fmac_f32 v42, v41, v41
    ds_bpermute_b32 v48, v50, v42
    s_waitcnt lgkmcnt(0)
    v_add_f32 v42, v42, v48
    ds_bpermute_b32 v48, v51, v42
    s_waitcnt lgkmcnt(0)
    v_add_f32 v42, v42, v48
    ds_bpermute_b32 v48, v52, v42
    s_waitcnt lgkmcnt(0)
    v_add_f32 v42, v42, v48
    ds_bpermute_b32 v48, v53, v42
    s_waitcnt lgkmcnt(0)
    v_add_f32 v42, v42, v48
    ds_bpermute_b32 v48, v54, v42
    s_waitcnt lgkmcnt(0)
    v_add_f32 v42, v42, v48
    ds_bpermute_b32 v48, v55, v42
    s_waitcnt lgkmcnt(0)
    v_add_f32 v42, v42, v48
    v_mul_f32 v42, 0x3a800000, v42
    v_cvt_pk_bf16_f32 v40, v40, v40
    v_lshlrev_b32 v40, 16, v40
    v_cvt_pk_bf16_f32 v42, v42, v42
    v_lshlrev_b32 v42, 16, v42
    v_add_f32 v42, 0x3727c5ac, v42
    v_cvt_pk_bf16_f32 v42, v42, v42
    v_lshlrev_b32 v42, 16, v42
    v_sqrt_f32 v42, v42
    s_nop 0
    v_cvt_pk_bf16_f32 v42, v42, v42
    v_lshlrev_b32 v42, 16, v42
    v_rcp_f32 v43, v42
    s_nop 0
    v_fma_f32 v44, -v42, v43, 2.0
    v_mul_f32 v43, v43, v44
    v_sub_f32 v16, v16, v40
    v_sub_f32 v17, v17, v40
    v_cvt_pk_bf16_f32 v44, v16, v17
    v_lshlrev_b32 v16, 16, v44
    v_and_b32 v17, 0xffff0000, v44
    v_mul_f32 v16, v16, v43
    v_mul_f32 v17, v17, v43
    v_cvt_pk_bf16_f32 v4, v16, v17
    v_lshlrev_b32 v16, 16, v4
    v_and_b32 v17, 0xffff0000, v4
    v_sub_f32 v18, v18, v40
    v_sub_f32 v19, v19, v40
    v_cvt_pk_bf16_f32 v44, v18, v19
    v_lshlrev_b32 v18, 16, v44
    v_and_b32 v19, 0xffff0000, v44
    v_mul_f32 v18, v18, v43
    v_mul_f32 v19, v19, v43
    v_cvt_pk_bf16_f32 v5, v18, v19
    v_lshlrev_b32 v18, 16, v5
    v_and_b32 v19, 0xffff0000, v5
    v_sub_f32 v20, v20, v40
    v_sub_f32 v21, v21, v40
    v_cvt_pk_bf16_f32 v44, v20, v21
    v_lshlrev_b32 v20, 16, v44
    v_and_b32 v21, 0xffff0000, v44
    v_mul_f32 v20, v20, v43
    v_mul_f32 v21, v21, v43
    v_cvt_pk_bf16_f32 v6, v20, v21
    v_lshlrev_b32 v20, 16, v6
    v_and_b32 v21, 0xffff0000, v6
    v_sub_f32 v22, v22, v40
    v_sub_f32 v23, v23, v40
    v_cvt_pk_bf16_f32 v44, v22, v23
    v_lshlrev_b32 v22, 16, v44
    v_and_b32 v23, 0xffff0000, v44
    v_mul_f32 v22, v22, v43
    v_mul_f32 v23, v23, v43
    v_cvt_pk_bf16_f32 v7, v22, v23
    v_lshlrev_b32 v22, 16, v7
    v_and_b32 v23, 0xffff0000, v7
    v_sub_f32 v24, v24, v40
    v_sub_f32 v25, v25, v40
    v_cvt_pk_bf16_f32 v44, v24, v25
    v_lshlrev_b32 v24, 16, v44
    v_and_b32 v25, 0xffff0000, v44
    v_mul_f32 v24, v24, v43
    v_mul_f32 v25, v25, v43
    v_cvt_pk_bf16_f32 v8, v24, v25
    v_lshlrev_b32 v24, 16, v8
    v_and_b32 v25, 0xffff0000, v8
    v_sub_f32 v26, v26, v40
    v_sub_f32 v27, v27, v40
    v_cvt_pk_bf16_f32 v44, v26, v27
    v_lshlrev_b32 v26, 16, v44
    v_and_b32 v27, 0xffff0000, v44
    v_mul_f32 v26, v26, v43
    v_mul_f32 v27, v27, v43
    v_cvt_pk_bf16_f32 v9, v26, v27
    v_lshlrev_b32 v26, 16, v9
    v_and_b32 v27, 0xffff0000, v9
    v_sub_f32 v28, v28, v40
    v_sub_f32 v29, v29, v40
    v_cvt_pk_bf16_f32 v44, v28, v29
    v_lshlrev_b32 v28, 16, v44
    v_and_b32 v29, 0xffff0000, v44
    v_mul_f32 v28, v28, v43
    v_mul_f32 v29, v29, v43
    v_cvt_pk_bf16_f32 v10, v28, v29
    v_lshlrev_b32 v28, 16, v10
    v_and_b32 v29, 0xffff0000, v10
    v_sub_f32 v30, v30, v40
    v_sub_f32 v31, v31, v40
    v_cvt_pk_bf16_f32 v44, v30, v31
    v_lshlrev_b32 v30, 16, v44
    v_and_b32 v31, 0xffff0000, v44
    v_mul_f32 v30, v30, v43
    v_mul_f32 v31, v31, v43
    v_cvt_pk_bf16_f32 v11, v30, v31
    v_lshlrev_b32 v30, 16, v11
    v_and_b32 v31, 0xffff0000, v11
    v_add_f32 v40, v16, v17
    v_add_f32 v40, v40, v18
    v_add_f32 v40, v40, v19
    v_add_f32 v40, v40, v20
    v_add_f32 v40, v40, v21
    v_add_f32 v40, v40, v22
    v_add_f32 v40, v40, v23
    v_add_f32 v40, v40, v24
    v_add_f32 v40, v40, v25
    v_add_f32 v40, v40, v26
    v_add_f32 v40, v40, v27
    v_add_f32 v40, v40, v28
    v_add_f32 v40, v40, v29
    v_add_f32 v40, v40, v30
    v_add_f32 v40, v40, v31
    ds_bpermute_b32 v48, v50, v40
    s_waitcnt lgkmcnt(0)
    v_add_f32 v40, v40, v48
    ds_bpermute_b32 v48, v51, v40
    s_waitcnt lgkmcnt(0)
    v_add_f32 v40, v40, v48
    ds_bpermute_b32 v48, v52, v40
    s_waitcnt lgkmcnt(0)
    v_add_f32 v40, v40, v48
    ds_bpermute_b32 v48, v53, v40
    s_waitcnt lgkmcnt(0)
    v_add_f32 v40, v40, v48
    ds_bpermute_b32 v48, v54, v40
    s_waitcnt lgkmcnt(0)
    v_add_f32 v40, v40, v48
    ds_bpermute_b32 v48, v55, v40
    s_waitcnt lgkmcnt(0)
    v_add_f32 v40, v40, v48
    v_mul_f32 v40, 0x3a800000, v40
    v_sub_f32 v41, v16, v40
    v_mul_f32 v42, v41, v41
    v_sub_f32 v41, v17, v40
    v_fmac_f32 v42, v41, v41
    v_sub_f32 v41, v18, v40
    v_fmac_f32 v42, v41, v41
    v_sub_f32 v41, v19, v40
    v_fmac_f32 v42, v41, v41
    v_sub_f32 v41, v20, v40
    v_fmac_f32 v42, v41, v41
    v_sub_f32 v41, v21, v40
    v_fmac_f32 v42, v41, v41
    v_sub_f32 v41, v22, v40
    v_fmac_f32 v42, v41, v41
    v_sub_f32 v41, v23, v40
    v_fmac_f32 v42, v41, v41
    v_sub_f32 v41, v24, v40
    v_fmac_f32 v42, v41, v41
    v_sub_f32 v41, v25, v40
    v_fmac_f32 v42, v41, v41
    v_sub_f32 v41, v26, v40
    v_fmac_f32 v42, v41, v41
    v_sub_f32 v41, v27, v40
    v_fmac_f32 v42, v41, v41
    v_sub_f32 v41, v28, v40
    v_fmac_f32 v42, v41, v41
    v_sub_f32 v41, v29, v40
    v_fmac_f32 v42, v41, v41
    v_sub_f32 v41, v30, v40
    v_fmac_f32 v42, v41, v41
    v_sub_f32 v41, v31, v40
    v_fmac_f32 v42, v41, v41
    ds_bpermute_b32 v48, v50, v42
    s_waitcnt lgkmcnt(0)
    v_add_f32 v42, v42, v48
    ds_bpermute_b32 v48, v51, v42
    s_waitcnt lgkmcnt(0)
    v_add_f32 v42, v42, v48
    ds_bpermute_b32 v48, v52, v42
    s_waitcnt lgkmcnt(0)
    v_add_f32 v42, v42, v48
    ds_bpermute_b32 v48, v53, v42
    s_waitcnt lgkmcnt(0)
    v_add_f32 v42, v42, v48
    ds_bpermute_b32 v48, v54, v42
    s_waitcnt lgkmcnt(0)
    v_add_f32 v42, v42, v48
    ds_bpermute_b32 v48, v55, v42
    s_waitcnt lgkmcnt(0)
    v_add_f32 v42, v42, v48
    v_mul_f32 v42, 0x3a800000, v42
    v_cvt_pk_bf16_f32 v40, v40, v40
    v_lshlrev_b32 v40, 16, v40
    v_cvt_pk_bf16_f32 v42, v42, v42
    v_lshlrev_b32 v42, 16, v42
    v_add_f32 v42, 0x3727c5ac, v42
    v_cvt_pk_bf16_f32 v42, v42, v42
    v_lshlrev_b32 v42, 16, v42
    v_sqrt_f32 v42, v42
    s_nop 0
    v_cvt_pk_bf16_f32 v42, v42, v42
    v_lshlrev_b32 v42, 16, v42
    v_rcp_f32 v43, v42
    s_nop 0
    v_fma_f32 v44, -v42, v43, 2.0
    v_mul_f32 v43, v43, v44
    v_sub_f32 v16, v16, v40
    v_sub_f32 v17, v17, v40
    v_cvt_pk_bf16_f32 v44, v16, v17
    v_lshlrev_b32 v16, 16, v44
    v_and_b32 v17, 0xffff0000, v44
    v_mul_f32 v16, v16, v43
    v_mul_f32 v17, v17, v43
    v_cvt_pk_bf16_f32 v4, v16, v17
    v_lshlrev_b32 v16, 16, v4
    v_and_b32 v17, 0xffff0000, v4
    v_sub_f32 v18, v18, v40
    v_sub_f32 v19, v19, v40
    v_cvt_pk_bf16_f32 v44, v18, v19
    v_lshlrev_b32 v18, 16, v44
    v_and_b32 v19, 0xffff0000, v44
    v_mul_f32 v18, v18, v43
    v_mul_f32 v19, v19, v43
    v_cvt_pk_bf16_f32 v5, v18, v19
    v_lshlrev_b32 v18, 16, v5
    v_and_b32 v19, 0xffff0000, v5
    v_sub_f32 v20, v20, v40
    v_sub_f32 v21, v21, v40
    v_cvt_pk_bf16_f32 v44, v20, v21
    v_lshlrev_b32 v20, 16, v44
    v_and_b32 v21, 0xffff0000, v44
    v_mul_f32 v20, v20, v43
    v_mul_f32 v21, v21, v43
    v_cvt_pk_bf16_f32 v6, v20, v21
    v_lshlrev_b32 v20, 16, v6
    v_and_b32 v21, 0xffff0000, v6
    v_sub_f32 v22, v22, v40
    v_sub_f32 v23, v23, v40
    v_cvt_pk_bf16_f32 v44, v22, v23
    v_lshlrev_b32 v22, 16, v44
    v_and_b32 v23, 0xffff0000, v44
    v_mul_f32 v22, v22, v43
    v_mul_f32 v23, v23, v43
    v_cvt_pk_bf16_f32 v7, v22, v23
    v_lshlrev_b32 v22, 16, v7
    v_and_b32 v23, 0xffff0000, v7
    v_sub_f32 v24, v24, v40
    v_sub_f32 v25, v25, v40
    v_cvt_pk_bf16_f32 v44, v24, v25
    v_lshlrev_b32 v24, 16, v44
    v_and_b32 v25, 0xffff0000, v44
    v_mul_f32 v24, v24, v43
    v_mul_f32 v25, v25, v43
    v_cvt_pk_bf16_f32 v8, v24, v25
    v_lshlrev_b32 v24, 16, v8
    v_and_b32 v25, 0xffff0000, v8
    v_sub_f32 v26, v26, v40
    v_sub_f32 v27, v27, v40
    v_cvt_pk_bf16_f32 v44, v26, v27
    v_lshlrev_b32 v26, 16, v44
    v_and_b32 v27, 0xffff0000, v44
    v_mul_f32 v26, v26, v43
    v_mul_f32 v27, v27, v43
    v_cvt_pk_bf16_f32 v9, v26, v27
    v_lshlrev_b32 v26, 16, v9
    v_and_b32 v27, 0xffff0000, v9
    v_sub_f32 v28, v28, v40
    v_sub_f32 v29, v29, v40
    v_cvt_pk_bf16_f32 v44, v28, v29
    v_lshlrev_b32 v28, 16, v44
    v_and_b32 v29, 0xffff0000, v44
    v_mul_f32 v28, v28, v43
    v_mul_f32 v29, v29, v43
    v_cvt_pk_bf16_f32 v10, v28, v29
    v_lshlrev_b32 v28, 16, v10
    v_and_b32 v29, 0xffff0000, v10
    v_sub_f32 v30, v30, v40
    v_sub_f32 v31, v31, v40
    v_cvt_pk_bf16_f32 v44, v30, v31
    v_lshlrev_b32 v30, 16, v44
    v_and_b32 v31, 0xffff0000, v44
    v_mul_f32 v30, v30, v43
    v_mul_f32 v31, v31, v43
    v_cvt_pk_bf16_f32 v11, v30, v31
    v_lshlrev_b32 v30, 16, v11
    v_and_b32 v31, 0xffff0000, v11
    buffer_store_dwordx4 v[4:7], v3, s[12:15], 0 offen
    buffer_store_dwordx4 v[8:11], v3, s[12:15], 0 offen offset:1024
ln2_kernel_done1:
    s_endpgm
.globl g1_kernel
.p2align 8
.type g1_kernel,@function
g1_kernel:
    s_cmp_ge_u32 s2, 224
    s_cbranch_scc1 g1_kernel_done1
    s_load_dwordx2 s[4:5], s[0:1], 112
    s_load_dwordx2 s[40:41], s[0:1], 64
    s_load_dwordx2 s[50:51], s[0:1], 72
    s_mov_b32 s34, 153391690
    s_mul_hi_u32 s35, s2, s34
    s_mul_i32 s36, s35, 28
    s_sub_u32 s34, s2, s36
    v_and_b32 v1, 63, v0
    v_lshrrev_b32 v17, 6, v0
    s_nop 0
    v_readfirstlane_b32 s37, v17
    s_waitcnt lgkmcnt(0)
    s_mul_i32 s38, s35, 524288
    s_add_u32 s38, s38, 0
    s_add_u32 s8, s4, s38
    s_addc_u32 s9, s5, 0
    s_and_b32 s9, s9, 0xffff
    s_mov_b32 s10, 524288
    s_mov_b32 s11, 0x00020000
    s_mul_i32 s38, s34, 128
    s_add_u32 s38, s38, 0
    s_mov_b32 s54, s40
    s_mov_b32 s55, s41
    s_lshl_b32 s38, s38, 1
    s_add_u32 s12, s54, s38
    s_addc_u32 s13, s55, 0
    s_and_b32 s13, s13, 0xffff
    s_sub_u32 s14, 7340032, s38
    s_mov_b32 s15, 0x00020000
    s_mul_i32 s38, s34, 128
    s_add_u32 s38, s38, 64
    s_mov_b32 s54, s40
    s_mov_b32 s55, s41
    s_lshl_b32 s38, s38, 1
    s_add_u32 s16, s54, s38
    s_addc_u32 s17, s55, 0
    s_and_b32 s17, s17, 0xffff
    s_sub_u32 s18, 7340032, s38
    s_mov_b32 s19, 0x00020000
    s_add_u32 s28, s4, 75497472
    s_addc_u32 s29, s5, 0
    s_and_b32 s29, s29, 0xffff
    s_mov_b32 s30, 14680064
    s_mov_b32 s31, 0x00020000
    s_mov_b32 s60, s50
    s_and_b32 s61, s51, 0xffff
    s_mov_b32 s62, 7168
    s_mov_b32 s63, 0x00020000
    v_lshrrev_b32 v17, 3, v1
    v_and_b32 v18, 7, v1
    v_lshrrev_b32 v19, 4, v1
    v_xor_b32 v20, v18, v19
    v_xor_b32 v21, 4, v20
    s_mov_b32 s38, 2048
    v_mul_lo_u32 v22, s38, v17
    v_lshl_add_u32 v2, v20, 4, v22
    v_lshl_add_u32 v3, v21, 4, v22
    v_and_b32 v20, 1, v19
    v_lshlrev_b32 v20, 2, v20
    v_xor_b32 v20, v18, v20
    s_mov_b32 s38, 7168
    v_mul_lo_u32 v22, s38, v17
    v_lshl_add_u32 v4, v20, 4, v22
    s_and_b32 s38, s37, 3
    s_lshr_b32 s39, s37, 2
    v_and_b32 v17, 31, v1
    v_lshrrev_b32 v18, 5, v1
    v_lshrrev_b32 v19, 1, v17
    v_and_b32 v19, 7, v19
    s_mul_i32 s54, s38, 8192
    v_add_u32 v20, 0, v18
    v_xor_b32 v20, v20, v19
    v_lshlrev_b32 v20, 4, v20
    v_lshl_add_u32 v20, v17, 7, v20
    v_add_u32 v5, s54, v20
    v_add_u32 v20, 2, v18
    v_xor_b32 v20, v20, v19
    v_lshlrev_b32 v20, 4, v20
    v_lshl_add_u32 v20, v17, 7, v20
    v_add_u32 v6, s54, v20
    v_add_u32 v20, 4, v18
    v_xor_b32 v20, v20, v19
    v_lshlrev_b32 v20, 4, v20
    v_lshl_add_u32 v20, v17, 7, v20
    v_add_u32 v7, s54, v20
    v_add_u32 v20, 6, v18
    v_xor_b32 v20, v20, v19
    v_lshlrev_b32 v20, 4, v20
    v_lshl_add_u32 v20, v17, 7, v20
    v_add_u32 v8, s54, v20
    v_and_b32 v17, 15, v1
    v_lshrrev_b32 v19, 2, v17
    v_and_b32 v20, 3, v17
    v_bfe_u32 v21, v1, 4, 1
    v_lshlrev_b32 v22, 1, v21
    v_lshrrev_b32 v23, 1, v20
    v_add_u32 v22, v22, v23
    v_bfe_u32 v23, v19, 1, 1
    v_lshlrev_b32 v23, 2, v23
    v_xor_b32 v22, v22, v23
    v_lshlrev_b32 v22, 4, v22
    v_and_b32 v23, 1, v20
    v_lshl_add_u32 v22, v23, 3, v22
    v_lshl_add_u32 v23, v18, 3, v19
    v_lshl_add_u32 v22, v23, 7, v22
    v_add_u32 v9, 32768, v22
    v_xor_b32 v10, 64, v9
    s_mul_i32 s55, s39, 4
    v_accvgpr_write_b32 a0, 0
    v_accvgpr_write_b32 a1, 0
    v_accvgpr_write_b32 a2, 0
    v_accvgpr_write_b32 a3, 0
    v_accvgpr_write_b32 a4, 0
    v_accvgpr_write_b32 a5, 0
    v_accvgpr_write_b32 a6, 0
    v_accvgpr_write_b32 a7, 0
    v_accvgpr_write_b32 a8, 0
    v_accvgpr_write_b32 a9, 0
    v_accvgpr_write_b32 a10, 0
    v_accvgpr_write_b32 a11, 0
    v_accvgpr_write_b32 a12, 0
    v_accvgpr_write_b32 a13, 0
    v_accvgpr_write_b32 a14, 0
    v_accvgpr_write_b32 a15, 0
    v_accvgpr_write_b32 a16, 0
    v_accvgpr_write_b32 a17, 0
    v_accvgpr_write_b32 a18, 0
    v_accvgpr_write_b32 a19, 0
    v_accvgpr_write_b32 a20, 0
    v_accvgpr_write_b32 a21, 0
    v_accvgpr_write_b32 a22, 0
    v_accvgpr_write_b32 a23, 0
    v_accvgpr_write_b32 a24, 0
    v_accvgpr_write_b32 a25, 0
    v_accvgpr_write_b32 a26, 0
    v_accvgpr_write_b32 a27, 0
    v_accvgpr_write_b32 a28, 0
    v_accvgpr_write_b32 a29, 0
    v_accvgpr_write_b32 a30, 0
    v_accvgpr_write_b32 a31, 0
    v_accvgpr_write_b32 a32, 0
    v_accvgpr_write_b32 a33, 0
    v_accvgpr_write_b32 a34, 0
    v_accvgpr_write_b32 a35, 0
    v_accvgpr_write_b32 a36, 0
    v_accvgpr_write_b32 a37, 0
    v_accvgpr_write_b32 a38, 0
    v_accvgpr_write_b32 a39, 0
    v_accvgpr_write_b32 a40, 0
    v_accvgpr_write_b32 a41, 0
    v_accvgpr_write_b32 a42, 0
    v_accvgpr_write_b32 a43, 0
    v_accvgpr_write_b32 a44, 0
    v_accvgpr_write_b32 a45, 0
    v_accvgpr_write_b32 a46, 0
    v_accvgpr_write_b32 a47, 0
    v_accvgpr_write_b32 a48, 0
    v_accvgpr_write_b32 a49, 0
    v_accvgpr_write_b32 a50, 0
    v_accvgpr_write_b32 a51, 0
    v_accvgpr_write_b32 a52, 0
    v_accvgpr_write_b32 a53, 0
    v_accvgpr_write_b32 a54, 0
    v_accvgpr_write_b32 a55, 0
    v_accvgpr_write_b32 a56, 0
    v_accvgpr_write_b32 a57, 0
    v_accvgpr_write_b32 a58, 0
    v_accvgpr_write_b32 a59, 0
    v_accvgpr_write_b32 a60, 0
    v_accvgpr_write_b32 a61, 0
    v_accvgpr_write_b32 a62, 0
    v_accvgpr_write_b32 a63, 0
    v_accvgpr_write_b32 a64, 0
    v_accvgpr_write_b32 a65, 0
    v_accvgpr_write_b32 a66, 0
    v_accvgpr_write_b32 a67, 0
    v_accvgpr_write_b32 a68, 0
    v_accvgpr_write_b32 a69, 0
    v_accvgpr_write_b32 a70, 0
    v_accvgpr_write_b32 a71, 0
    v_accvgpr_write_b32 a72, 0
    v_accvgpr_write_b32 a73, 0
    v_accvgpr_write_b32 a74, 0
    v_accvgpr_write_b32 a75, 0
    v_accvgpr_write_b32 a76, 0
    v_accvgpr_write_b32 a77, 0
    v_accvgpr_write_b32 a78, 0
    v_accvgpr_write_b32 a79, 0
    v_accvgpr_write_b32 a80, 0
    v_accvgpr_write_b32 a81, 0
    v_accvgpr_write_b32 a82, 0
    v_accvgpr_write_b32 a83, 0
    v_accvgpr_write_b32 a84, 0
    v_accvgpr_write_b32 a85, 0
    v_accvgpr_write_b32 a86, 0
    v_accvgpr_write_b32 a87, 0
    v_accvgpr_write_b32 a88, 0
    v_accvgpr_write_b32 a89, 0
    v_accvgpr_write_b32 a90, 0
    v_accvgpr_write_b32 a91, 0
    v_accvgpr_write_b32 a92, 0
    v_accvgpr_write_b32 a93, 0
    v_accvgpr_write_b32 a94, 0
    v_accvgpr_write_b32 a95, 0
    v_accvgpr_write_b32 a96, 0
    v_accvgpr_write_b32 a97, 0
    v_accvgpr_write_b32 a98, 0
    v_accvgpr_write_b32 a99, 0
    v_accvgpr_write_b32 a100, 0
    v_accvgpr_write_b32 a101, 0
    v_accvgpr_write_b32 a102, 0
    v_accvgpr_write_b32 a103, 0
    v_accvgpr_write_b32 a104, 0
    v_accvgpr_write_b32 a105, 0
    v_accvgpr_write_b32 a106, 0
    v_accvgpr_write_b32 a107, 0
    v_accvgpr_write_b32 a108, 0
    v_accvgpr_write_b32 a109, 0
    v_accvgpr_write_b32 a110, 0
    v_accvgpr_write_b32 a111, 0
    v_accvgpr_write_b32 a112, 0
    v_accvgpr_write_b32 a113, 0
    v_accvgpr_write_b32 a114, 0
    v_accvgpr_write_b32 a115, 0
    v_accvgpr_write_b32 a116, 0
    v_accvgpr_write_b32 a117, 0
    v_accvgpr_write_b32 a118, 0
    v_accvgpr_write_b32 a119, 0
    v_accvgpr_write_b32 a120, 0
    v_accvgpr_write_b32 a121, 0
    v_accvgpr_write_b32 a122, 0
    v_accvgpr_write_b32 a123, 0
    v_accvgpr_write_b32 a124, 0
    v_accvgpr_write_b32 a125, 0
    v_accvgpr_write_b32 a126, 0
    v_accvgpr_write_b32 a127, 0
    s_mul_i32 s67, s37, 8
    s_mul_i32 s68, s37, 4
    s_mov_b32 s64, 0
    s_mov_b32 s65, 0
    s_mov_b32 s66, 0
    s_add_u32 s69, s67, 0
    s_mul_i32 s70, s69, 16384
    s_add_u32 s70, s70, s64
    s_lshl_b32 s69, s69, 10
    s_add_u32 m0, s69, s66
    buffer_load_dwordx4 v2, s[8:11], s70 offen lds
    s_add_u32 s69, s67, 1
    s_mul_i32 s70, s69, 16384
    s_add_u32 s70, s70, s64
    s_lshl_b32 s69, s69, 10
    s_add_u32 m0, s69, s66
    buffer_load_dwordx4 v3, s[8:11], s70 offen lds
    s_add_u32 s69, s67, 2
    s_mul_i32 s70, s69, 16384
    s_add_u32 s70, s70, s64
    s_lshl_b32 s69, s69, 10
    s_add_u32 m0, s69, s66
    buffer_load_dwordx4 v2, s[8:11], s70 offen lds
    s_add_u32 s69, s67, 3
    s_mul_i32 s70, s69, 16384
    s_add_u32 s70, s70, s64
    s_lshl_b32 s69, s69, 10
    s_add_u32 m0, s69, s66
    buffer_load_dwordx4 v3, s[8:11], s70 offen lds
    s_add_u32 s69, s67, 4
    s_mul_i32 s70, s69, 16384
    s_add_u32 s70, s70, s64
    s_lshl_b32 s69, s69, 10
    s_add_u32 m0, s69, s66
    buffer_load_dwordx4 v2, s[8:11], s70 offen lds
    s_add_u32 s69, s67, 5
    s_mul_i32 s70, s69, 16384
    s_add_u32 s70, s70, s64
    s_lshl_b32 s69, s69, 10
    s_add_u32 m0, s69, s66
    buffer_load_dwordx4 v3, s[8:11], s70 offen lds
    s_add_u32 s69, s67, 6
    s_mul_i32 s70, s69, 16384
    s_add_u32 s70, s70, s64
    s_lshl_b32 s69, s69, 10
    s_add_u32 m0, s69, s66
    buffer_load_dwordx4 v2, s[8:11], s70 offen lds
    s_add_u32 s69, s67, 7
    s_mul_i32 s70, s69, 16384
    s_add_u32 s70, s70, s64
    s_lshl_b32 s69, s69, 10
    s_add_u32 m0, s69, s66
    buffer_load_dwordx4 v3, s[8:11], s70 offen lds
    s_add_u32 s69, s68, 0
    s_and_b32 s71, s69, 7
    s_mul_i32 s70, s71, 57344
    s_add_u32 s70, s70, s65
    s_lshl_b32 s72, s69, 10
    s_add_u32 s72, s72, s66
    s_add_u32 m0, s72, 32768
    s_lshr_b32 s69, s69, 3
    s_cmp_lg_u32 s69, 0
    s_cbranch_scc1 g1_kernel_wb3
    buffer_load_dwordx4 v4, s[12:15], s70 offen lds
    s_branch g1_kernel_we2
g1_kernel_wb3:
    buffer_load_dwordx4 v4, s[16:19], s70 offen lds
g1_kernel_we2:
    s_add_u32 s69, s68, 1
    s_and_b32 s71, s69, 7
    s_mul_i32 s70, s71, 57344
    s_add_u32 s70, s70, s65
    s_lshl_b32 s72, s69, 10
    s_add_u32 s72, s72, s66
    s_add_u32 m0, s72, 32768
    s_lshr_b32 s69, s69, 3
    s_cmp_lg_u32 s69, 0
    s_cbranch_scc1 g1_kernel_wb6
    buffer_load_dwordx4 v4, s[12:15], s70 offen lds
    s_branch g1_kernel_we5
g1_kernel_wb6:
    buffer_load_dwordx4 v4, s[16:19], s70 offen lds
g1_kernel_we5:
    s_add_u32 s69, s68, 2
    s_and_b32 s71, s69, 7
    s_mul_i32 s70, s71, 57344
    s_add_u32 s70, s70, s65
    s_lshl_b32 s72, s69, 10
    s_add_u32 s72, s72, s66
    s_add_u32 m0, s72, 32768
    s_lshr_b32 s69, s69, 3
    s_cmp_lg_u32 s69, 0
    s_cbranch_scc1 g1_kernel_wb9
    buffer_load_dwordx4 v4, s[12:15], s70 offen lds
    s_branch g1_kernel_we8
g1_kernel_wb9:
    buffer_load_dwordx4 v4, s[16:19], s70 offen lds
g1_kernel_we8:
    s_add_u32 s69, s68, 3
    s_and_b32 s71, s69, 7
    s_mul_i32 s70, s71, 57344
    s_add_u32 s70, s70, s65
    s_lshl_b32 s72, s69, 10
    s_add_u32 s72, s72, s66
    s_add_u32 m0, s72, 32768
    s_lshr_b32 s69, s69, 3
    s_cmp_lg_u32 s69, 0
    s_cbranch_scc1 g1_kernel_wb12
    buffer_load_dwordx4 v4, s[12:15], s70 offen lds
    s_branch g1_kernel_we11
g1_kernel_wb12:
    buffer_load_dwordx4 v4, s[16:19], s70 offen lds
g1_kernel_we11:
    s_mov_b32 s64, 128
    s_mov_b32 s65, 458752
    s_mov_b32 s66, 49152
    s_add_u32 s69, s67, 0
    s_mul_i32 s70, s69, 16384
    s_add_u32 s70, s70, s64
    s_lshl_b32 s69, s69, 10
    s_add_u32 m0, s69, s66
    buffer_load_dwordx4 v2, s[8:11], s70 offen lds
    s_add_u32 s69, s67, 1
    s_mul_i32 s70, s69, 16384
    s_add_u32 s70, s70, s64
    s_lshl_b32 s69, s69, 10
    s_add_u32 m0, s69, s66
    buffer_load_dwordx4 v3, s[8:11], s70 offen lds
    s_add_u32 s69, s67, 2
    s_mul_i32 s70, s69, 16384
    s_add_u32 s70, s70, s64
    s_lshl_b32 s69, s69, 10
    s_add_u32 m0, s69, s66
    buffer_load_dwordx4 v2, s[8:11], s70 offen lds
    s_add_u32 s69, s67, 3
    s_mul_i32 s70, s69, 16384
    s_add_u32 s70, s70, s64
    s_lshl_b32 s69, s69, 10
    s_add_u32 m0, s69, s66
    buffer_load_dwordx4 v3, s[8:11], s70 offen lds
    s_add_u32 s69, s67, 4
    s_mul_i32 s70, s69, 16384
    s_add_u32 s70, s70, s64
    s_lshl_b32 s69, s69, 10
    s_add_u32 m0, s69, s66
    buffer_load_dwordx4 v2, s[8:11], s70 offen lds
    s_add_u32 s69, s67, 5
    s_mul_i32 s70, s69, 16384
    s_add_u32 s70, s70, s64
    s_lshl_b32 s69, s69, 10
    s_add_u32 m0, s69, s66
    buffer_load_dwordx4 v3, s[8:11], s70 offen lds
    s_add_u32 s69, s67, 6
    s_mul_i32 s70, s69, 16384
    s_add_u32 s70, s70, s64
    s_lshl_b32 s69, s69, 10
    s_add_u32 m0, s69, s66
    buffer_load_dwordx4 v2, s[8:11], s70 offen lds
    s_add_u32 s69, s67, 7
    s_mul_i32 s70, s69, 16384
    s_add_u32 s70, s70, s64
    s_lshl_b32 s69, s69, 10
    s_add_u32 m0, s69, s66
    buffer_load_dwordx4 v3, s[8:11], s70 offen lds
    s_add_u32 s69, s68, 0
    s_and_b32 s71, s69, 7
    s_mul_i32 s70, s71, 57344
    s_add_u32 s70, s70, s65
    s_lshl_b32 s72, s69, 10
    s_add_u32 s72, s72, s66
    s_add_u32 m0, s72, 32768
    s_lshr_b32 s69, s69, 3
    s_cmp_lg_u32 s69, 0
    s_cbranch_scc1 g1_kernel_wb15
    buffer_load_dwordx4 v4, s[12:15], s70 offen lds
    s_branch g1_kernel_we14
g1_kernel_wb15:
    buffer_load_dwordx4 v4, s[16:19], s70 offen lds
g1_kernel_we14:
    s_add_u32 s69, s68, 1
    s_and_b32 s71, s69, 7
    s_mul_i32 s70, s71, 57344
    s_add_u32 s70, s70, s65
    s_lshl_b32 s72, s69, 10
    s_add_u32 s72, s72, s66
    s_add_u32 m0, s72, 32768
    s_lshr_b32 s69, s69, 3
    s_cmp_lg_u32 s69, 0
    s_cbranch_scc1 g1_kernel_wb18
    buffer_load_dwordx4 v4, s[12:15], s70 offen lds
    s_branch g1_kernel_we17
g1_kernel_wb18:
    buffer_load_dwordx4 v4, s[16:19], s70 offen lds
g1_kernel_we17:
    s_add_u32 s69, s68, 2
    s_and_b32 s71, s69, 7
    s_mul_i32 s70, s71, 57344
    s_add_u32 s70, s70, s65
    s_lshl_b32 s72, s69, 10
    s_add_u32 s72, s72, s66
    s_add_u32 m0, s72, 32768
    s_lshr_b32 s69, s69, 3
    s_cmp_lg_u32 s69, 0
    s_cbranch_scc1 g1_kernel_wb21
    buffer_load_dwordx4 v4, s[12:15], s70 offen lds
    s_branch g1_kernel_we20
g1_kernel_wb21:
    buffer_load_dwordx4 v4, s[16:19], s70 offen lds
g1_kernel_we20:
    s_add_u32 s69, s68, 3
    s_and_b32 s71, s69, 7
    s_mul_i32 s70, s71, 57344
    s_add_u32 s70, s70, s65
    s_lshl_b32 s72, s69, 10
    s_add_u32 s72, s72, s66
    s_add_u32 m0, s72, 32768
    s_lshr_b32 s69, s69, 3
    s_cmp_lg_u32 s69, 0
    s_cbranch_scc1 g1_kernel_wb24
    buffer_load_dwordx4 v4, s[12:15], s70 offen lds
    s_branch g1_kernel_we23
g1_kernel_wb24:
    buffer_load_dwordx4 v4, s[16:19], s70 offen lds
g1_kernel_we23:
    s_mov_b32 s73, 0
    s_mov_b32 s74, 0
    s_mov_b32 s66, 98304
g1_kernel_loop26:
    s_waitcnt vmcnt(12)
    s_barrier
    s_add_u32 s64, s64, 128
    s_add_u32 s65, s65, 458752
    s_add_u32 s69, s67, 0
    s_mul_i32 s70, s69, 16384
    s_add_u32 s70, s70, s64
    s_lshl_b32 s69, s69, 10
    s_add_u32 m0, s69, s66
    buffer_load_dwordx4 v2, s[8:11], s70 offen lds
    s_add_u32 s69, s67, 1
    s_mul_i32 s70, s69, 16384
    s_add_u32 s70, s70, s64
    s_lshl_b32 s69, s69, 10
    s_add_u32 m0, s69, s66
    buffer_load_dwordx4 v3, s[8:11], s70 offen lds
    s_add_u32 s69, s67, 2
    s_mul_i32 s70, s69, 16384
    s_add_u32 s70, s70, s64
    s_lshl_b32 s69, s69, 10
    s_add_u32 m0, s69, s66
    buffer_load_dwordx4 v2, s[8:11], s70 offen lds
    s_add_u32 s69, s67, 3
    s_mul_i32 s70, s69, 16384
    s_add_u32 s70, s70, s64
    s_lshl_b32 s69, s69, 10
    s_add_u32 m0, s69, s66
    buffer_load_dwordx4 v3, s[8:11], s70 offen lds
    s_add_u32 s69, s67, 4
    s_mul_i32 s70, s69, 16384
    s_add_u32 s70, s70, s64
    s_lshl_b32 s69, s69, 10
    s_add_u32 m0, s69, s66
    buffer_load_dwordx4 v2, s[8:11], s70 offen lds
    s_add_u32 s69, s67, 5
    s_mul_i32 s70, s69, 16384
    s_add_u32 s70, s70, s64
    s_lshl_b32 s69, s69, 10
    s_add_u32 m0, s69, s66
    buffer_load_dwordx4 v3, s[8:11], s70 offen lds
    s_add_u32 s69, s67, 6
    s_mul_i32 s70, s69, 16384
    s_add_u32 s70, s70, s64
    s_lshl_b32 s69, s69, 10
    s_add_u32 m0, s69, s66
    buffer_load_dwordx4 v2, s[8:11], s70 offen lds
    s_add_u32 s69, s67, 7
    s_mul_i32 s70, s69, 16384
    s_add_u32 s70, s70, s64
    s_lshl_b32 s69, s69, 10
    s_add_u32 m0, s69, s66
    buffer_load_dwordx4 v3, s[8:11], s70 offen lds
    s_add_u32 s69, s68, 0
    s_and_b32 s71, s69, 7
    s_mul_i32 s70, s71, 57344
    s_add_u32 s70, s70, s65
    s_lshl_b32 s72, s69, 10
    s_add_u32 s72, s72, s66
    s_add_u32 m0, s72, 32768
    s_lshr_b32 s69, s69, 3
    s_cmp_lg_u32 s69, 0
    s_cbranch_scc1 g1_kernel_wb28
    buffer_load_dwordx4 v4, s[12:15], s70 offen lds
    s_branch g1_kernel_we27
g1_kernel_wb28:
    buffer_load_dwordx4 v4, s[16:19], s70 offen lds
g1_kernel_we27:
    s_add_u32 s69, s68, 1
    s_and_b32 s71, s69, 7
    s_mul_i32 s70, s71, 57344
    s_add_u32 s70, s70, s65
    s_lshl_b32 s72, s69, 10
    s_add_u32 s72, s72, s66
    s_add_u32 m0, s72, 32768
    s_lshr_b32 s69, s69, 3
    s_cmp_lg_u32 s69, 0
    s_cbranch_scc1 g1_kernel_wb31
    buffer_load_dwordx4 v4, s[12:15], s70 offen lds
    s_branch g1_kernel_we30
g1_kernel_wb31:
    buffer_load_dwordx4 v4, s[16:19], s70 offen lds
g1_kernel_we30:
    s_add_u32 s69, s68, 2
    s_and_b32 s71, s69, 7
    s_mul_i32 s70, s71, 57344
    s_add_u32 s70, s70, s65
    s_lshl_b32 s72, s69, 10
    s_add_u32 s72, s72, s66
    s_add_u32 m0, s72, 32768
    s_lshr_b32 s69, s69, 3
    s_cmp_lg_u32 s69, 0
    s_cbranch_scc1 g1_kernel_wb34
    buffer_load_dwordx4 v4, s[12:15], s70 offen lds
    s_branch g1_kernel_we33
g1_kernel_wb34:
    buffer_load_dwordx4 v4, s[16:19], s70 offen lds
g1_kernel_we33:
    s_add_u32 s69, s68, 3
    s_and_b32 s71, s69, 7
    s_mul_i32 s70, s71, 57344
    s_add_u32 s70, s70, s65
    s_lshl_b32 s72, s69, 10
    s_add_u32 s72, s72, s66
    s_add_u32 m0, s72, 32768
    s_lshr_b32 s69, s69, 3
    s_cmp_lg_u32 s69, 0
    s_cbranch_scc1 g1_kernel_wb37
    buffer_load_dwordx4 v4, s[12:15], s70 offen lds
    s_branch g1_kernel_we36
g1_kernel_wb37:
    buffer_load_dwordx4 v4, s[16:19], s70 offen lds
g1_kernel_we36:
    s_add_u32 s66, s66, 49152
    s_cmp_ge_u32 s66, 147456
    s_cselect_b32 s75, 147456, 0
    s_sub_u32 s66, s66, s75
    v_add_u32 v11, s74, v5
    v_add_u32 v12, s74, v6
    v_add_u32 v13, s74, v7
    v_add_u32 v14, s74, v8
    v_add_u32 v15, s74, v9
    v_add_u32 v16, s74, v10
    s_add_u32 s76, s55, 0
    s_and_b32 s77, s76, 1
    s_lshr_b32 s76, s76, 1
    s_mul_i32 s76, s76, 8192
    s_cmp_eq_u32 s77, 0
    s_cselect_b64 s[78:79], -1, 0
    v_cndmask_b32 v17, v16, v15, s[78:79]
    v_add_u32 v17, s76, v17
    s_add_u32 s76, s55, 1
    s_and_b32 s77, s76, 1
    s_lshr_b32 s76, s76, 1
    s_mul_i32 s76, s76, 8192
    s_cmp_eq_u32 s77, 0
    s_cselect_b64 s[78:79], -1, 0
    v_cndmask_b32 v18, v16, v15, s[78:79]
    v_add_u32 v18, s76, v18
    s_add_u32 s76, s55, 2
    s_and_b32 s77, s76, 1
    s_lshr_b32 s76, s76, 1
    s_mul_i32 s76, s76, 8192
    s_cmp_eq_u32 s77, 0
    s_cselect_b64 s[78:79], -1, 0
    v_cndmask_b32 v19, v16, v15, s[78:79]
    v_add_u32 v19, s76, v19
    s_add_u32 s76, s55, 3
    s_and_b32 s77, s76, 1
    s_lshr_b32 s76, s76, 1
    s_mul_i32 s76, s76, 8192
    s_cmp_eq_u32 s77, 0
    s_cselect_b64 s[78:79], -1, 0
    v_cndmask_b32 v20, v16, v15, s[78:79]
    v_add_u32 v20, s76, v20
    ds_read_b128 v[24:27], v11 offset:0
    ds_read_b128 v[28:31], v11 offset:4096
    ds_read_b64_tr_b16 v[40:41], v17 offset:0
    ds_read_b64_tr_b16 v[42:43], v17 offset:512
    ds_read_b64_tr_b16 v[44:45], v18 offset:0
    ds_read_b64_tr_b16 v[46:47], v18 offset:512
    ds_read_b64_tr_b16 v[48:49], v19 offset:0
    ds_read_b64_tr_b16 v[50:51], v19 offset:512
    ds_read_b64_tr_b16 v[52:53], v20 offset:0
    ds_read_b64_tr_b16 v[54:55], v20 offset:512
    ds_read_b128 v[32:35], v12 offset:0
    ds_read_b128 v[36:39], v12 offset:4096
    ds_read_b64_tr_b16 v[56:57], v17 offset:2048
    ds_read_b64_tr_b16 v[58:59], v17 offset:2560
    ds_read_b64_tr_b16 v[60:61], v18 offset:2048
    ds_read_b64_tr_b16 v[62:63], v18 offset:2560
    ds_read_b64_tr_b16 v[64:65], v19 offset:2048
    ds_read_b64_tr_b16 v[66:67], v19 offset:2560
    ds_read_b64_tr_b16 v[68:69], v20 offset:2048
    ds_read_b64_tr_b16 v[70:71], v20 offset:2560
    s_waitcnt lgkmcnt(10)
    v_mfma_f32_32x32x16_bf16 a[0:15], v[40:43], v[24:27], a[0:15]
    v_mfma_f32_32x32x16_bf16 a[16:31], v[44:47], v[24:27], a[16:31]
    v_mfma_f32_32x32x16_bf16 a[32:47], v[48:51], v[24:27], a[32:47]
    v_mfma_f32_32x32x16_bf16 a[48:63], v[52:55], v[24:27], a[48:63]
    v_mfma_f32_32x32x16_bf16 a[64:79], v[40:43], v[28:31], a[64:79]
    v_mfma_f32_32x32x16_bf16 a[80:95], v[44:47], v[28:31], a[80:95]
    v_mfma_f32_32x32x16_bf16 a[96:111], v[48:51], v[28:31], a[96:111]
    v_mfma_f32_32x32x16_bf16 a[112:127], v[52:55], v[28:31], a[112:127]
    ds_read_b128 v[24:27], v13 offset:0
    ds_read_b128 v[28:31], v13 offset:4096
    ds_read_b64_tr_b16 v[40:41], v17 offset:4096
    ds_read_b64_tr_b16 v[42:43], v17 offset:4608
    ds_read_b64_tr_b16 v[44:45], v18 offset:4096
    ds_read_b64_tr_b16 v[46:47], v18 offset:4608
    ds_read_b64_tr_b16 v[48:49], v19 offset:4096
    ds_read_b64_tr_b16 v[50:51], v19 offset:4608
    ds_read_b64_tr_b16 v[52:53], v20 offset:4096
    ds_read_b64_tr_b16 v[54:55], v20 offset:4608
    s_waitcnt lgkmcnt(10)
    v_mfma_f32_32x32x16_bf16 a[0:15], v[56:59], v[32:35], a[0:15]
    v_mfma_f32_32x32x16_bf16 a[16:31], v[60:63], v[32:35], a[16:31]
    v_mfma_f32_32x32x16_bf16 a[32:47], v[64:67], v[32:35], a[32:47]
    v_mfma_f32_32x32x16_bf16 a[48:63], v[68:71], v[32:35], a[48:63]
    v_mfma_f32_32x32x16_bf16 a[64:79], v[56:59], v[36:39], a[64:79]
    v_mfma_f32_32x32x16_bf16 a[80:95], v[60:63], v[36:39], a[80:95]
    v_mfma_f32_32x32x16_bf16 a[96:111], v[64:67], v[36:39], a[96:111]
    v_mfma_f32_32x32x16_bf16 a[112:127], v[68:71], v[36:39], a[112:127]
    ds_read_b128 v[32:35], v14 offset:0
    ds_read_b128 v[36:39], v14 offset:4096
    ds_read_b64_tr_b16 v[56:57], v17 offset:6144
    ds_read_b64_tr_b16 v[58:59], v17 offset:6656
    ds_read_b64_tr_b16 v[60:61], v18 offset:6144
    ds_read_b64_tr_b16 v[62:63], v18 offset:6656
    ds_read_b64_tr_b16 v[64:65], v19 offset:6144
    ds_read_b64_tr_b16 v[66:67], v19 offset:6656
    ds_read_b64_tr_b16 v[68:69], v20 offset:6144
    ds_read_b64_tr_b16 v[70:71], v20 offset:6656
    s_waitcnt lgkmcnt(10)
    v_mfma_f32_32x32x16_bf16 a[0:15], v[40:43], v[24:27], a[0:15]
    v_mfma_f32_32x32x16_bf16 a[16:31], v[44:47], v[24:27], a[16:31]
    v_mfma_f32_32x32x16_bf16 a[32:47], v[48:51], v[24:27], a[32:47]
    v_mfma_f32_32x32x16_bf16 a[48:63], v[52:55], v[24:27], a[48:63]
    v_mfma_f32_32x32x16_bf16 a[64:79], v[40:43], v[28:31], a[64:79]
    v_mfma_f32_32x32x16_bf16 a[80:95], v[44:47], v[28:31], a[80:95]
    v_mfma_f32_32x32x16_bf16 a[96:111], v[48:51], v[28:31], a[96:111]
    v_mfma_f32_32x32x16_bf16 a[112:127], v[52:55], v[28:31], a[112:127]
    s_waitcnt lgkmcnt(0)
    v_mfma_f32_32x32x16_bf16 a[0:15], v[56:59], v[32:35], a[0:15]
    v_mfma_f32_32x32x16_bf16 a[16:31], v[60:63], v[32:35], a[16:31]
    v_mfma_f32_32x32x16_bf16 a[32:47], v[64:67], v[32:35], a[32:47]
    v_mfma_f32_32x32x16_bf16 a[48:63], v[68:71], v[32:35], a[48:63]
    v_mfma_f32_32x32x16_bf16 a[64:79], v[56:59], v[36:39], a[64:79]
    v_mfma_f32_32x32x16_bf16 a[80:95], v[60:63], v[36:39], a[80:95]
    v_mfma_f32_32x32x16_bf16 a[96:111], v[64:67], v[36:39], a[96:111]
    v_mfma_f32_32x32x16_bf16 a[112:127], v[68:71], v[36:39], a[112:127]
    s_add_u32 s74, s74, 49152
    s_cmp_ge_u32 s74, 147456
    s_cselect_b32 s75, 147456, 0
    s_sub_u32 s74, s74, s75
    s_add_u32 s73, s73, 1
    s_cmp_lt_u32 s73, 16
    s_cbranch_scc1 g1_kernel_loop26
    s_nop 15
    s_nop 3
    v_and_b32 v17, 31, v1
    v_lshrrev_b32 v18, 5, v1
    s_mul_i32 s64, s35, 256
    s_mul_i32 s65, s38, 64
    s_add_u32 s64, s64, s65
    v_add_u32 v17, s64, v17
    s_mov_b32 s65, 7168
    v_mul_lo_u32 v17, s65, v17
    s_mul_i32 s64, s34, 128
    s_lshl_b32 s65, s55, 5
    s_add_u32 s64, s64, s65
    v_lshlrev_b32 v18, 2, v18
    v_add_u32 v18, s64, v18
    v_lshlrev_b32 v18, 1, v18
    v_add_u32 v17, v17, v18
    buffer_load_dwordx2 v[22:23], v18, s[60:63], 0 offen offset:0
    v_accvgpr_read_b32 v24, a0
    v_accvgpr_read_b32 v25, a1
    v_accvgpr_read_b32 v26, a2
    v_accvgpr_read_b32 v27, a3
    s_waitcnt vmcnt(0)
    v_cvt_pk_bf16_f32 v28, v24, v25
    v_cvt_pk_bf16_f32 v29, v26, v27
    v_lshlrev_b32 v24, 16, v28
    v_and_b32 v25, 0xffff0000, v28
    v_lshlrev_b32 v26, 16, v29
    v_and_b32 v27, 0xffff0000, v29
    v_lshlrev_b32 v28, 16, v22
    v_and_b32 v29, 0xffff0000, v22
    v_lshlrev_b32 v30, 16, v23
    v_and_b32 v31, 0xffff0000, v23
    v_add_f32 v24, v24, v28
    v_add_f32 v25, v25, v29
    v_add_f32 v26, v26, v30
    v_add_f32 v27, v27, v31
    v_cvt_pk_bf16_f32 v28, v24, v25
    v_cvt_pk_bf16_f32 v29, v26, v27
    v_lshlrev_b32 v24, 16, v28
    v_and_b32 v25, 0xffff0000, v28
    v_lshlrev_b32 v26, 16, v29
    v_and_b32 v27, 0xffff0000, v29
    s_mov_b32 s66, 0x3d372713
    s_mov_b32 s67, 0xc0135761
    v_mul_f32 v28, v24, v24
    v_mul_f32 v28, v28, v24
    v_fma_f32 v28, s66, v28, v24
    v_mul_f32 v28, s67, v28
    v_exp_f32 v28, v28
    s_nop 0
    v_add_f32 v28, 1.0, v28
    v_rcp_f32 v28, v28
    s_nop 0
    v_mul_f32 v24, v24, v28
    v_mul_f32 v28, v25, v25
    v_mul_f32 v28, v28, v25
    v_fma_f32 v28, s66, v28, v25
    v_mul_f32 v28, s67, v28
    v_exp_f32 v28, v28
    s_nop 0
    v_add_f32 v28, 1.0, v28
    v_rcp_f32 v28, v28
    s_nop 0
    v_mul_f32 v25, v25, v28
    v_mul_f32 v28, v26, v26
    v_mul_f32 v28, v28, v26
    v_fma_f32 v28, s66, v28, v26
    v_mul_f32 v28, s67, v28
    v_exp_f32 v28, v28
    s_nop 0
    v_add_f32 v28, 1.0, v28
    v_rcp_f32 v28, v28
    s_nop 0
    v_mul_f32 v26, v26, v28
    v_mul_f32 v28, v27, v27
    v_mul_f32 v28, v28, v27
    v_fma_f32 v28, s66, v28, v27
    v_mul_f32 v28, s67, v28
    v_exp_f32 v28, v28
    s_nop 0
    v_add_f32 v28, 1.0, v28
    v_rcp_f32 v28, v28
    s_nop 0
    v_mul_f32 v27, v27, v28
    v_cvt_pk_bf16_f32 v28, v24, v25
    v_cvt_pk_bf16_f32 v29, v26, v27
    s_mov_b32 s66, 0
    buffer_store_dwordx2 v[28:29], v17, s[28:31], s66 offen offset:0
    s_nop 1
    buffer_load_dwordx2 v[22:23], v18, s[60:63], 0 offen offset:16
    v_accvgpr_read_b32 v24, a4
    v_accvgpr_read_b32 v25, a5
    v_accvgpr_read_b32 v26, a6
    v_accvgpr_read_b32 v27, a7
    s_waitcnt vmcnt(0)
    v_cvt_pk_bf16_f32 v28, v24, v25
    v_cvt_pk_bf16_f32 v29, v26, v27
    v_lshlrev_b32 v24, 16, v28
    v_and_b32 v25, 0xffff0000, v28
    v_lshlrev_b32 v26, 16, v29
    v_and_b32 v27, 0xffff0000, v29
    v_lshlrev_b32 v28, 16, v22
    v_and_b32 v29, 0xffff0000, v22
    v_lshlrev_b32 v30, 16, v23
    v_and_b32 v31, 0xffff0000, v23
    v_add_f32 v24, v24, v28
    v_add_f32 v25, v25, v29
    v_add_f32 v26, v26, v30
    v_add_f32 v27, v27, v31
    v_cvt_pk_bf16_f32 v28, v24, v25
    v_cvt_pk_bf16_f32 v29, v26, v27
    v_lshlrev_b32 v24, 16, v28
    v_and_b32 v25, 0xffff0000, v28
    v_lshlrev_b32 v26, 16, v29
    v_and_b32 v27, 0xffff0000, v29
    s_mov_b32 s66, 0x3d372713
    s_mov_b32 s67, 0xc0135761
    v_mul_f32 v28, v24, v24
    v_mul_f32 v28, v28, v24
    v_fma_f32 v28, s66, v28, v24
    v_mul_f32 v28, s67, v28
    v_exp_f32 v28, v28
    s_nop 0
    v_add_f32 v28, 1.0, v28
    v_rcp_f32 v28, v28
    s_nop 0
    v_mul_f32 v24, v24, v28
    v_mul_f32 v28, v25, v25
    v_mul_f32 v28, v28, v25
    v_fma_f32 v28, s66, v28, v25
    v_mul_f32 v28, s67, v28
    v_exp_f32 v28, v28
    s_nop 0
    v_add_f32 v28, 1.0, v28
    v_rcp_f32 v28, v28
    s_nop 0
    v_mul_f32 v25, v25, v28
    v_mul_f32 v28, v26, v26
    v_mul_f32 v28, v28, v26
    v_fma_f32 v28, s66, v28, v26
    v_mul_f32 v28, s67, v28
    v_exp_f32 v28, v28
    s_nop 0
    v_add_f32 v28, 1.0, v28
    v_rcp_f32 v28, v28
    s_nop 0
    v_mul_f32 v26, v26, v28
    v_mul_f32 v28, v27, v27
    v_mul_f32 v28, v28, v27
    v_fma_f32 v28, s66, v28, v27
    v_mul_f32 v28, s67, v28
    v_exp_f32 v28, v28
    s_nop 0
    v_add_f32 v28, 1.0, v28
    v_rcp_f32 v28, v28
    s_nop 0
    v_mul_f32 v27, v27, v28
    v_cvt_pk_bf16_f32 v28, v24, v25
    v_cvt_pk_bf16_f32 v29, v26, v27
    s_mov_b32 s66, 0
    buffer_store_dwordx2 v[28:29], v17, s[28:31], s66 offen offset:16
    s_nop 1
    buffer_load_dwordx2 v[22:23], v18, s[60:63], 0 offen offset:32
    v_accvgpr_read_b32 v24, a8
    v_accvgpr_read_b32 v25, a9
    v_accvgpr_read_b32 v26, a10
    v_accvgpr_read_b32 v27, a11
    s_waitcnt vmcnt(0)
    v_cvt_pk_bf16_f32 v28, v24, v25
    v_cvt_pk_bf16_f32 v29, v26, v27
    v_lshlrev_b32 v24, 16, v28
    v_and_b32 v25, 0xffff0000, v28
    v_lshlrev_b32 v26, 16, v29
    v_and_b32 v27, 0xffff0000, v29
    v_lshlrev_b32 v28, 16, v22
    v_and_b32 v29, 0xffff0000, v22
    v_lshlrev_b32 v30, 16, v23
    v_and_b32 v31, 0xffff0000, v23
    v_add_f32 v24, v24, v28
    v_add_f32 v25, v25, v29
    v_add_f32 v26, v26, v30
    v_add_f32 v27, v27, v31
    v_cvt_pk_bf16_f32 v28, v24, v25
    v_cvt_pk_bf16_f32 v29, v26, v27
    v_lshlrev_b32 v24, 16, v28
    v_and_b32 v25, 0xffff0000, v28
    v_lshlrev_b32 v26, 16, v29
    v_and_b32 v27, 0xffff0000, v29
    s_mov_b32 s66, 0x3d372713
    s_mov_b32 s67, 0xc0135761
    v_mul_f32 v28, v24, v24
    v_mul_f32 v28, v28, v24
    v_fma_f32 v28, s66, v28, v24
    v_mul_f32 v28, s67, v28
    v_exp_f32 v28, v28
    s_nop 0
    v_add_f32 v28, 1.0, v28
    v_rcp_f32 v28, v28
    s_nop 0
    v_mul_f32 v24, v24, v28
    v_mul_f32 v28, v25, v25
    v_mul_f32 v28, v28, v25
    v_fma_f32 v28, s66, v28, v25
    v_mul_f32 v28, s67, v28
    v_exp_f32 v28, v28
    s_nop 0
    v_add_f32 v28, 1.0, v28
    v_rcp_f32 v28, v28
    s_nop 0
    v_mul_f32 v25, v25, v28
    v_mul_f32 v28, v26, v26
    v_mul_f32 v28, v28, v26
    v_fma_f32 v28, s66, v28, v26
    v_mul_f32 v28, s67, v28
    v_exp_f32 v28, v28
    s_nop 0
    v_add_f32 v28, 1.0, v28
    v_rcp_f32 v28, v28
    s_nop 0
    v_mul_f32 v26, v26, v28
    v_mul_f32 v28, v27, v27
    v_mul_f32 v28, v28, v27
    v_fma_f32 v28, s66, v28, v27
    v_mul_f32 v28, s67, v28
    v_exp_f32 v28, v28
    s_nop 0
    v_add_f32 v28, 1.0, v28
    v_rcp_f32 v28, v28
    s_nop 0
    v_mul_f32 v27, v27, v28
    v_cvt_pk_bf16_f32 v28, v24, v25
    v_cvt_pk_bf16_f32 v29, v26, v27
    s_mov_b32 s66, 0
    buffer_store_dwordx2 v[28:29], v17, s[28:31], s66 offen offset:32
    s_nop 1
    buffer_load_dwordx2 v[22:23], v18, s[60:63], 0 offen offset:48
    v_accvgpr_read_b32 v24, a12
    v_accvgpr_read_b32 v25, a13
    v_accvgpr_read_b32 v26, a14
    v_accvgpr_read_b32 v27, a15
    s_waitcnt vmcnt(0)
    v_cvt_pk_bf16_f32 v28, v24, v25
    v_cvt_pk_bf16_f32 v29, v26, v27
    v_lshlrev_b32 v24, 16, v28
    v_and_b32 v25, 0xffff0000, v28
    v_lshlrev_b32 v26, 16, v29
    v_and_b32 v27, 0xffff0000, v29
    v_lshlrev_b32 v28, 16, v22
    v_and_b32 v29, 0xffff0000, v22
    v_lshlrev_b32 v30, 16, v23
    v_and_b32 v31, 0xffff0000, v23
    v_add_f32 v24, v24, v28
    v_add_f32 v25, v25, v29
    v_add_f32 v26, v26, v30
    v_add_f32 v27, v27, v31
    v_cvt_pk_bf16_f32 v28, v24, v25
    v_cvt_pk_bf16_f32 v29, v26, v27
    v_lshlrev_b32 v24, 16, v28
    v_and_b32 v25, 0xffff0000, v28
    v_lshlrev_b32 v26, 16, v29
    v_and_b32 v27, 0xffff0000, v29
    s_mov_b32 s66, 0x3d372713
    s_mov_b32 s67, 0xc0135761
    v_mul_f32 v28, v24, v24
    v_mul_f32 v28, v28, v24
    v_fma_f32 v28, s66, v28, v24
    v_mul_f32 v28, s67, v28
    v_exp_f32 v28, v28
    s_nop 0
    v_add_f32 v28, 1.0, v28
    v_rcp_f32 v28, v28
    s_nop 0
    v_mul_f32 v24, v24, v28
    v_mul_f32 v28, v25, v25
    v_mul_f32 v28, v28, v25
    v_fma_f32 v28, s66, v28, v25
    v_mul_f32 v28, s67, v28
    v_exp_f32 v28, v28
    s_nop 0
    v_add_f32 v28, 1.0, v28
    v_rcp_f32 v28, v28
    s_nop 0
    v_mul_f32 v25, v25, v28
    v_mul_f32 v28, v26, v26
    v_mul_f32 v28, v28, v26
    v_fma_f32 v28, s66, v28, v26
    v_mul_f32 v28, s67, v28
    v_exp_f32 v28, v28
    s_nop 0
    v_add_f32 v28, 1.0, v28
    v_rcp_f32 v28, v28
    s_nop 0
    v_mul_f32 v26, v26, v28
    v_mul_f32 v28, v27, v27
    v_mul_f32 v28, v28, v27
    v_fma_f32 v28, s66, v28, v27
    v_mul_f32 v28, s67, v28
    v_exp_f32 v28, v28
    s_nop 0
    v_add_f32 v28, 1.0, v28
    v_rcp_f32 v28, v28
    s_nop 0
    v_mul_f32 v27, v27, v28
    v_cvt_pk_bf16_f32 v28, v24, v25
    v_cvt_pk_bf16_f32 v29, v26, v27
    s_mov_b32 s66, 0
    buffer_store_dwordx2 v[28:29], v17, s[28:31], s66 offen offset:48
    s_nop 1
    buffer_load_dwordx2 v[22:23], v18, s[60:63], 0 offen offset:64
    v_accvgpr_read_b32 v24, a16
    v_accvgpr_read_b32 v25, a17
    v_accvgpr_read_b32 v26, a18
    v_accvgpr_read_b32 v27, a19
    s_waitcnt vmcnt(0)
    v_cvt_pk_bf16_f32 v28, v24, v25
    v_cvt_pk_bf16_f32 v29, v26, v27
    v_lshlrev_b32 v24, 16, v28
    v_and_b32 v25, 0xffff0000, v28
    v_lshlrev_b32 v26, 16, v29
    v_and_b32 v27, 0xffff0000, v29
    v_lshlrev_b32 v28, 16, v22
    v_and_b32 v29, 0xffff0000, v22
    v_lshlrev_b32 v30, 16, v23
    v_and_b32 v31, 0xffff0000, v23
    v_add_f32 v24, v24, v28
    v_add_f32 v25, v25, v29
    v_add_f32 v26, v26, v30
    v_add_f32 v27, v27, v31
    v_cvt_pk_bf16_f32 v28, v24, v25
    v_cvt_pk_bf16_f32 v29, v26, v27
    v_lshlrev_b32 v24, 16, v28
    v_and_b32 v25, 0xffff0000, v28
    v_lshlrev_b32 v26, 16, v29
    v_and_b32 v27, 0xffff0000, v29
    s_mov_b32 s66, 0x3d372713
    s_mov_b32 s67, 0xc0135761
    v_mul_f32 v28, v24, v24
    v_mul_f32 v28, v28, v24
    v_fma_f32 v28, s66, v28, v24
    v_mul_f32 v28, s67, v28
    v_exp_f32 v28, v28
    s_nop 0
    v_add_f32 v28, 1.0, v28
    v_rcp_f32 v28, v28
    s_nop 0
    v_mul_f32 v24, v24, v28
    v_mul_f32 v28, v25, v25
    v_mul_f32 v28, v28, v25
    v_fma_f32 v28, s66, v28, v25
    v_mul_f32 v28, s67, v28
    v_exp_f32 v28, v28
    s_nop 0
    v_add_f32 v28, 1.0, v28
    v_rcp_f32 v28, v28
    s_nop 0
    v_mul_f32 v25, v25, v28
    v_mul_f32 v28, v26, v26
    v_mul_f32 v28, v28, v26
    v_fma_f32 v28, s66, v28, v26
    v_mul_f32 v28, s67, v28
    v_exp_f32 v28, v28
    s_nop 0
    v_add_f32 v28, 1.0, v28
    v_rcp_f32 v28, v28
    s_nop 0
    v_mul_f32 v26, v26, v28
    v_mul_f32 v28, v27, v27
    v_mul_f32 v28, v28, v27
    v_fma_f32 v28, s66, v28, v27
    v_mul_f32 v28, s67, v28
    v_exp_f32 v28, v28
    s_nop 0
    v_add_f32 v28, 1.0, v28
    v_rcp_f32 v28, v28
    s_nop 0
    v_mul_f32 v27, v27, v28
    v_cvt_pk_bf16_f32 v28, v24, v25
    v_cvt_pk_bf16_f32 v29, v26, v27
    s_mov_b32 s66, 0
    buffer_store_dwordx2 v[28:29], v17, s[28:31], s66 offen offset:64
    s_nop 1
    buffer_load_dwordx2 v[22:23], v18, s[60:63], 0 offen offset:80
    v_accvgpr_read_b32 v24, a20
    v_accvgpr_read_b32 v25, a21
    v_accvgpr_read_b32 v26, a22
    v_accvgpr_read_b32 v27, a23
    s_waitcnt vmcnt(0)
    v_cvt_pk_bf16_f32 v28, v24, v25
    v_cvt_pk_bf16_f32 v29, v26, v27
    v_lshlrev_b32 v24, 16, v28
    v_and_b32 v25, 0xffff0000, v28
    v_lshlrev_b32 v26, 16, v29
    v_and_b32 v27, 0xffff0000, v29
    v_lshlrev_b32 v28, 16, v22
    v_and_b32 v29, 0xffff0000, v22
    v_lshlrev_b32 v30, 16, v23
    v_and_b32 v31, 0xffff0000, v23
    v_add_f32 v24, v24, v28
    v_add_f32 v25, v25, v29
    v_add_f32 v26, v26, v30
    v_add_f32 v27, v27, v31
    v_cvt_pk_bf16_f32 v28, v24, v25
    v_cvt_pk_bf16_f32 v29, v26, v27
    v_lshlrev_b32 v24, 16, v28
    v_and_b32 v25, 0xffff0000, v28
    v_lshlrev_b32 v26, 16, v29
    v_and_b32 v27, 0xffff0000, v29
    s_mov_b32 s66, 0x3d372713
    s_mov_b32 s67, 0xc0135761
    v_mul_f32 v28, v24, v24
    v_mul_f32 v28, v28, v24
    v_fma_f32 v28, s66, v28, v24
    v_mul_f32 v28, s67, v28
    v_exp_f32 v28, v28
    s_nop 0
    v_add_f32 v28, 1.0, v28
    v_rcp_f32 v28, v28
    s_nop 0
    v_mul_f32 v24, v24, v28
    v_mul_f32 v28, v25, v25
    v_mul_f32 v28, v28, v25
    v_fma_f32 v28, s66, v28, v25
    v_mul_f32 v28, s67, v28
    v_exp_f32 v28, v28
    s_nop 0
    v_add_f32 v28, 1.0, v28
    v_rcp_f32 v28, v28
    s_nop 0
    v_mul_f32 v25, v25, v28
    v_mul_f32 v28, v26, v26
    v_mul_f32 v28, v28, v26
    v_fma_f32 v28, s66, v28, v26
    v_mul_f32 v28, s67, v28
    v_exp_f32 v28, v28
    s_nop 0
    v_add_f32 v28, 1.0, v28
    v_rcp_f32 v28, v28
    s_nop 0
    v_mul_f32 v26, v26, v28
    v_mul_f32 v28, v27, v27
    v_mul_f32 v28, v28, v27
    v_fma_f32 v28, s66, v28, v27
    v_mul_f32 v28, s67, v28
    v_exp_f32 v28, v28
    s_nop 0
    v_add_f32 v28, 1.0, v28
    v_rcp_f32 v28, v28
    s_nop 0
    v_mul_f32 v27, v27, v28
    v_cvt_pk_bf16_f32 v28, v24, v25
    v_cvt_pk_bf16_f32 v29, v26, v27
    s_mov_b32 s66, 0
    buffer_store_dwordx2 v[28:29], v17, s[28:31], s66 offen offset:80
    s_nop 1
    buffer_load_dwordx2 v[22:23], v18, s[60:63], 0 offen offset:96
    v_accvgpr_read_b32 v24, a24
    v_accvgpr_read_b32 v25, a25
    v_accvgpr_read_b32 v26, a26
    v_accvgpr_read_b32 v27, a27
    s_waitcnt vmcnt(0)
    v_cvt_pk_bf16_f32 v28, v24, v25
    v_cvt_pk_bf16_f32 v29, v26, v27
    v_lshlrev_b32 v24, 16, v28
    v_and_b32 v25, 0xffff0000, v28
    v_lshlrev_b32 v26, 16, v29
    v_and_b32 v27, 0xffff0000, v29
    v_lshlrev_b32 v28, 16, v22
    v_and_b32 v29, 0xffff0000, v22
    v_lshlrev_b32 v30, 16, v23
    v_and_b32 v31, 0xffff0000, v23
    v_add_f32 v24, v24, v28
    v_add_f32 v25, v25, v29
    v_add_f32 v26, v26, v30
    v_add_f32 v27, v27, v31
    v_cvt_pk_bf16_f32 v28, v24, v25
    v_cvt_pk_bf16_f32 v29, v26, v27
    v_lshlrev_b32 v24, 16, v28
    v_and_b32 v25, 0xffff0000, v28
    v_lshlrev_b32 v26, 16, v29
    v_and_b32 v27, 0xffff0000, v29
    s_mov_b32 s66, 0x3d372713
    s_mov_b32 s67, 0xc0135761
    v_mul_f32 v28, v24, v24
    v_mul_f32 v28, v28, v24
    v_fma_f32 v28, s66, v28, v24
    v_mul_f32 v28, s67, v28
    v_exp_f32 v28, v28
    s_nop 0
    v_add_f32 v28, 1.0, v28
    v_rcp_f32 v28, v28
    s_nop 0
    v_mul_f32 v24, v24, v28
    v_mul_f32 v28, v25, v25
    v_mul_f32 v28, v28, v25
    v_fma_f32 v28, s66, v28, v25
    v_mul_f32 v28, s67, v28
    v_exp_f32 v28, v28
    s_nop 0
    v_add_f32 v28, 1.0, v28
    v_rcp_f32 v28, v28
    s_nop 0
    v_mul_f32 v25, v25, v28
    v_mul_f32 v28, v26, v26
    v_mul_f32 v28, v28, v26
    v_fma_f32 v28, s66, v28, v26
    v_mul_f32 v28, s67, v28
    v_exp_f32 v28, v28
    s_nop 0
    v_add_f32 v28, 1.0, v28
    v_rcp_f32 v28, v28
    s_nop 0
    v_mul_f32 v26, v26, v28
    v_mul_f32 v28, v27, v27
    v_mul_f32 v28, v28, v27
    v_fma_f32 v28, s66, v28, v27
    v_mul_f32 v28, s67, v28
    v_exp_f32 v28, v28
    s_nop 0
    v_add_f32 v28, 1.0, v28
    v_rcp_f32 v28, v28
    s_nop 0
    v_mul_f32 v27, v27, v28
    v_cvt_pk_bf16_f32 v28, v24, v25
    v_cvt_pk_bf16_f32 v29, v26, v27
    s_mov_b32 s66, 0
    buffer_store_dwordx2 v[28:29], v17, s[28:31], s66 offen offset:96
    s_nop 1
    buffer_load_dwordx2 v[22:23], v18, s[60:63], 0 offen offset:112
    v_accvgpr_read_b32 v24, a28
    v_accvgpr_read_b32 v25, a29
    v_accvgpr_read_b32 v26, a30
    v_accvgpr_read_b32 v27, a31
    s_waitcnt vmcnt(0)
    v_cvt_pk_bf16_f32 v28, v24, v25
    v_cvt_pk_bf16_f32 v29, v26, v27
    v_lshlrev_b32 v24, 16, v28
    v_and_b32 v25, 0xffff0000, v28
    v_lshlrev_b32 v26, 16, v29
    v_and_b32 v27, 0xffff0000, v29
    v_lshlrev_b32 v28, 16, v22
    v_and_b32 v29, 0xffff0000, v22
    v_lshlrev_b32 v30, 16, v23
    v_and_b32 v31, 0xffff0000, v23
    v_add_f32 v24, v24, v28
    v_add_f32 v25, v25, v29
    v_add_f32 v26, v26, v30
    v_add_f32 v27, v27, v31
    v_cvt_pk_bf16_f32 v28, v24, v25
    v_cvt_pk_bf16_f32 v29, v26, v27
    v_lshlrev_b32 v24, 16, v28
    v_and_b32 v25, 0xffff0000, v28
    v_lshlrev_b32 v26, 16, v29
    v_and_b32 v27, 0xffff0000, v29
    s_mov_b32 s66, 0x3d372713
    s_mov_b32 s67, 0xc0135761
    v_mul_f32 v28, v24, v24
    v_mul_f32 v28, v28, v24
    v_fma_f32 v28, s66, v28, v24
    v_mul_f32 v28, s67, v28
    v_exp_f32 v28, v28
    s_nop 0
    v_add_f32 v28, 1.0, v28
    v_rcp_f32 v28, v28
    s_nop 0
    v_mul_f32 v24, v24, v28
    v_mul_f32 v28, v25, v25
    v_mul_f32 v28, v28, v25
    v_fma_f32 v28, s66, v28, v25
    v_mul_f32 v28, s67, v28
    v_exp_f32 v28, v28
    s_nop 0
    v_add_f32 v28, 1.0, v28
    v_rcp_f32 v28, v28
    s_nop 0
    v_mul_f32 v25, v25, v28
    v_mul_f32 v28, v26, v26
    v_mul_f32 v28, v28, v26
    v_fma_f32 v28, s66, v28, v26
    v_mul_f32 v28, s67, v28
    v_exp_f32 v28, v28
    s_nop 0
    v_add_f32 v28, 1.0, v28
    v_rcp_f32 v28, v28
    s_nop 0
    v_mul_f32 v26, v26, v28
    v_mul_f32 v28, v27, v27
    v_mul_f32 v28, v28, v27
    v_fma_f32 v28, s66, v28, v27
    v_mul_f32 v28, s67, v28
    v_exp_f32 v28, v28
    s_nop 0
    v_add_f32 v28, 1.0, v28
    v_rcp_f32 v28, v28
    s_nop 0
    v_mul_f32 v27, v27, v28
    v_cvt_pk_bf16_f32 v28, v24, v25
    v_cvt_pk_bf16_f32 v29, v26, v27
    s_mov_b32 s66, 0
    buffer_store_dwordx2 v[28:29], v17, s[28:31], s66 offen offset:112
    s_nop 1
    buffer_load_dwordx2 v[22:23], v18, s[60:63], 0 offen offset:128
    v_accvgpr_read_b32 v24, a32
    v_accvgpr_read_b32 v25, a33
    v_accvgpr_read_b32 v26, a34
    v_accvgpr_read_b32 v27, a35
    s_waitcnt vmcnt(0)
    v_cvt_pk_bf16_f32 v28, v24, v25
    v_cvt_pk_bf16_f32 v29, v26, v27
    v_lshlrev_b32 v24, 16, v28
    v_and_b32 v25, 0xffff0000, v28
    v_lshlrev_b32 v26, 16, v29
    v_and_b32 v27, 0xffff0000, v29
    v_lshlrev_b32 v28, 16, v22
    v_and_b32 v29, 0xffff0000, v22
    v_lshlrev_b32 v30, 16, v23
    v_and_b32 v31, 0xffff0000, v23
    v_add_f32 v24, v24, v28
    v_add_f32 v25, v25, v29
    v_add_f32 v26, v26, v30
    v_add_f32 v27, v27, v31
    v_cvt_pk_bf16_f32 v28, v24, v25
    v_cvt_pk_bf16_f32 v29, v26, v27
    v_lshlrev_b32 v24, 16, v28
    v_and_b32 v25, 0xffff0000, v28
    v_lshlrev_b32 v26, 16, v29
    v_and_b32 v27, 0xffff0000, v29
    s_mov_b32 s66, 0x3d372713
    s_mov_b32 s67, 0xc0135761
    v_mul_f32 v28, v24, v24
    v_mul_f32 v28, v28, v24
    v_fma_f32 v28, s66, v28, v24
    v_mul_f32 v28, s67, v28
    v_exp_f32 v28, v28
    s_nop 0
    v_add_f32 v28, 1.0, v28
    v_rcp_f32 v28, v28
    s_nop 0
    v_mul_f32 v24, v24, v28
    v_mul_f32 v28, v25, v25
    v_mul_f32 v28, v28, v25
    v_fma_f32 v28, s66, v28, v25
    v_mul_f32 v28, s67, v28
    v_exp_f32 v28, v28
    s_nop 0
    v_add_f32 v28, 1.0, v28
    v_rcp_f32 v28, v28
    s_nop 0
    v_mul_f32 v25, v25, v28
    v_mul_f32 v28, v26, v26
    v_mul_f32 v28, v28, v26
    v_fma_f32 v28, s66, v28, v26
    v_mul_f32 v28, s67, v28
    v_exp_f32 v28, v28
    s_nop 0
    v_add_f32 v28, 1.0, v28
    v_rcp_f32 v28, v28
    s_nop 0
    v_mul_f32 v26, v26, v28
    v_mul_f32 v28, v27, v27
    v_mul_f32 v28, v28, v27
    v_fma_f32 v28, s66, v28, v27
    v_mul_f32 v28, s67, v28
    v_exp_f32 v28, v28
    s_nop 0
    v_add_f32 v28, 1.0, v28
    v_rcp_f32 v28, v28
    s_nop 0
    v_mul_f32 v27, v27, v28
    v_cvt_pk_bf16_f32 v28, v24, v25
    v_cvt_pk_bf16_f32 v29, v26, v27
    s_mov_b32 s66, 0
    buffer_store_dwordx2 v[28:29], v17, s[28:31], s66 offen offset:128
    s_nop 1
    buffer_load_dwordx2 v[22:23], v18, s[60:63], 0 offen offset:144
    v_accvgpr_read_b32 v24, a36
    v_accvgpr_read_b32 v25, a37
    v_accvgpr_read_b32 v26, a38
    v_accvgpr_read_b32 v27, a39
    s_waitcnt vmcnt(0)
    v_cvt_pk_bf16_f32 v28, v24, v25
    v_cvt_pk_bf16_f32 v29, v26, v27
    v_lshlrev_b32 v24, 16, v28
    v_and_b32 v25, 0xffff0000, v28
    v_lshlrev_b32 v26, 16, v29
    v_and_b32 v27, 0xffff0000, v29
    v_lshlrev_b32 v28, 16, v22
    v_and_b32 v29, 0xffff0000, v22
    v_lshlrev_b32 v30, 16, v23
    v_and_b32 v31, 0xffff0000, v23
    v_add_f32 v24, v24, v28
    v_add_f32 v25, v25, v29
    v_add_f32 v26, v26, v30
    v_add_f32 v27, v27, v31
    v_cvt_pk_bf16_f32 v28, v24, v25
    v_cvt_pk_bf16_f32 v29, v26, v27
    v_lshlrev_b32 v24, 16, v28
    v_and_b32 v25, 0xffff0000, v28
    v_lshlrev_b32 v26, 16, v29
    v_and_b32 v27, 0xffff0000, v29
    s_mov_b32 s66, 0x3d372713
    s_mov_b32 s67, 0xc0135761
    v_mul_f32 v28, v24, v24
    v_mul_f32 v28, v28, v24
    v_fma_f32 v28, s66, v28, v24
    v_mul_f32 v28, s67, v28
    v_exp_f32 v28, v28
    s_nop 0
    v_add_f32 v28, 1.0, v28
    v_rcp_f32 v28, v28
    s_nop 0
    v_mul_f32 v24, v24, v28
    v_mul_f32 v28, v25, v25
    v_mul_f32 v28, v28, v25
    v_fma_f32 v28, s66, v28, v25
    v_mul_f32 v28, s67, v28
    v_exp_f32 v28, v28
    s_nop 0
    v_add_f32 v28, 1.0, v28
    v_rcp_f32 v28, v28
    s_nop 0
    v_mul_f32 v25, v25, v28
    v_mul_f32 v28, v26, v26
    v_mul_f32 v28, v28, v26
    v_fma_f32 v28, s66, v28, v26
    v_mul_f32 v28, s67, v28
    v_exp_f32 v28, v28
    s_nop 0
    v_add_f32 v28, 1.0, v28
    v_rcp_f32 v28, v28
    s_nop 0
    v_mul_f32 v26, v26, v28
    v_mul_f32 v28, v27, v27
    v_mul_f32 v28, v28, v27
    v_fma_f32 v28, s66, v28, v27
    v_mul_f32 v28, s67, v28
    v_exp_f32 v28, v28
    s_nop 0
    v_add_f32 v28, 1.0, v28
    v_rcp_f32 v28, v28
    s_nop 0
    v_mul_f32 v27, v27, v28
    v_cvt_pk_bf16_f32 v28, v24, v25
    v_cvt_pk_bf16_f32 v29, v26, v27
    s_mov_b32 s66, 0
    buffer_store_dwordx2 v[28:29], v17, s[28:31], s66 offen offset:144
    s_nop 1
    buffer_load_dwordx2 v[22:23], v18, s[60:63], 0 offen offset:160
    v_accvgpr_read_b32 v24, a40
    v_accvgpr_read_b32 v25, a41
    v_accvgpr_read_b32 v26, a42
    v_accvgpr_read_b32 v27, a43
    s_waitcnt vmcnt(0)
    v_cvt_pk_bf16_f32 v28, v24, v25
    v_cvt_pk_bf16_f32 v29, v26, v27
    v_lshlrev_b32 v24, 16, v28
    v_and_b32 v25, 0xffff0000, v28
    v_lshlrev_b32 v26, 16, v29
    v_and_b32 v27, 0xffff0000, v29
    v_lshlrev_b32 v28, 16, v22
    v_and_b32 v29, 0xffff0000, v22
    v_lshlrev_b32 v30, 16, v23
    v_and_b32 v31, 0xffff0000, v23
    v_add_f32 v24, v24, v28
    v_add_f32 v25, v25, v29
    v_add_f32 v26, v26, v30
    v_add_f32 v27, v27, v31
    v_cvt_pk_bf16_f32 v28, v24, v25
    v_cvt_pk_bf16_f32 v29, v26, v27
    v_lshlrev_b32 v24, 16, v28
    v_and_b32 v25, 0xffff0000, v28
    v_lshlrev_b32 v26, 16, v29
    v_and_b32 v27, 0xffff0000, v29
    s_mov_b32 s66, 0x3d372713
    s_mov_b32 s67, 0xc0135761
    v_mul_f32 v28, v24, v24
    v_mul_f32 v28, v28, v24
    v_fma_f32 v28, s66, v28, v24
    v_mul_f32 v28, s67, v28
    v_exp_f32 v28, v28
    s_nop 0
    v_add_f32 v28, 1.0, v28
    v_rcp_f32 v28, v28
    s_nop 0
    v_mul_f32 v24, v24, v28
    v_mul_f32 v28, v25, v25
    v_mul_f32 v28, v28, v25
    v_fma_f32 v28, s66, v28, v25
    v_mul_f32 v28, s67, v28
    v_exp_f32 v28, v28
    s_nop 0
    v_add_f32 v28, 1.0, v28
    v_rcp_f32 v28, v28
    s_nop 0
    v_mul_f32 v25, v25, v28
    v_mul_f32 v28, v26, v26
    v_mul_f32 v28, v28, v26
    v_fma_f32 v28, s66, v28, v26
    v_mul_f32 v28, s67, v28
    v_exp_f32 v28, v28
    s_nop 0
    v_add_f32 v28, 1.0, v28
    v_rcp_f32 v28, v28
    s_nop 0
    v_mul_f32 v26, v26, v28
    v_mul_f32 v28, v27, v27
    v_mul_f32 v28, v28, v27
    v_fma_f32 v28, s66, v28, v27
    v_mul_f32 v28, s67, v28
    v_exp_f32 v28, v28
    s_nop 0
    v_add_f32 v28, 1.0, v28
    v_rcp_f32 v28, v28
    s_nop 0
    v_mul_f32 v27, v27, v28
    v_cvt_pk_bf16_f32 v28, v24, v25
    v_cvt_pk_bf16_f32 v29, v26, v27
    s_mov_b32 s66, 0
    buffer_store_dwordx2 v[28:29], v17, s[28:31], s66 offen offset:160
    s_nop 1
    buffer_load_dwordx2 v[22:23], v18, s[60:63], 0 offen offset:176
    v_accvgpr_read_b32 v24, a44
    v_accvgpr_read_b32 v25, a45
    v_accvgpr_read_b32 v26, a46
    v_accvgpr_read_b32 v27, a47
    s_waitcnt vmcnt(0)
    v_cvt_pk_bf16_f32 v28, v24, v25
    v_cvt_pk_bf16_f32 v29, v26, v27
    v_lshlrev_b32 v24, 16, v28
    v_and_b32 v25, 0xffff0000, v28
    v_lshlrev_b32 v26, 16, v29
    v_and_b32 v27, 0xffff0000, v29
    v_lshlrev_b32 v28, 16, v22
    v_and_b32 v29, 0xffff0000, v22
    v_lshlrev_b32 v30, 16, v23
    v_and_b32 v31, 0xffff0000, v23
    v_add_f32 v24, v24, v28
    v_add_f32 v25, v25, v29
    v_add_f32 v26, v26, v30
    v_add_f32 v27, v27, v31
    v_cvt_pk_bf16_f32 v28, v24, v25
    v_cvt_pk_bf16_f32 v29, v26, v27
    v_lshlrev_b32 v24, 16, v28
    v_and_b32 v25, 0xffff0000, v28
    v_lshlrev_b32 v26, 16, v29
    v_and_b32 v27, 0xffff0000, v29
    s_mov_b32 s66, 0x3d372713
    s_mov_b32 s67, 0xc0135761
    v_mul_f32 v28, v24, v24
    v_mul_f32 v28, v28, v24
    v_fma_f32 v28, s66, v28, v24
    v_mul_f32 v28, s67, v28
    v_exp_f32 v28, v28
    s_nop 0
    v_add_f32 v28, 1.0, v28
    v_rcp_f32 v28, v28
    s_nop 0
    v_mul_f32 v24, v24, v28
    v_mul_f32 v28, v25, v25
    v_mul_f32 v28, v28, v25
    v_fma_f32 v28, s66, v28, v25
    v_mul_f32 v28, s67, v28
    v_exp_f32 v28, v28
    s_nop 0
    v_add_f32 v28, 1.0, v28
    v_rcp_f32 v28, v28
    s_nop 0
    v_mul_f32 v25, v25, v28
    v_mul_f32 v28, v26, v26
    v_mul_f32 v28, v28, v26
    v_fma_f32 v28, s66, v28, v26
    v_mul_f32 v28, s67, v28
    v_exp_f32 v28, v28
    s_nop 0
    v_add_f32 v28, 1.0, v28
    v_rcp_f32 v28, v28
    s_nop 0
    v_mul_f32 v26, v26, v28
    v_mul_f32 v28, v27, v27
    v_mul_f32 v28, v28, v27
    v_fma_f32 v28, s66, v28, v27
    v_mul_f32 v28, s67, v28
    v_exp_f32 v28, v28
    s_nop 0
    v_add_f32 v28, 1.0, v28
    v_rcp_f32 v28, v28
    s_nop 0
    v_mul_f32 v27, v27, v28
    v_cvt_pk_bf16_f32 v28, v24, v25
    v_cvt_pk_bf16_f32 v29, v26, v27
    s_mov_b32 s66, 0
    buffer_store_dwordx2 v[28:29], v17, s[28:31], s66 offen offset:176
    s_nop 1
    buffer_load_dwordx2 v[22:23], v18, s[60:63], 0 offen offset:192
    v_accvgpr_read_b32 v24, a48
    v_accvgpr_read_b32 v25, a49
    v_accvgpr_read_b32 v26, a50
    v_accvgpr_read_b32 v27, a51
    s_waitcnt vmcnt(0)
    v_cvt_pk_bf16_f32 v28, v24, v25
    v_cvt_pk_bf16_f32 v29, v26, v27
    v_lshlrev_b32 v24, 16, v28
    v_and_b32 v25, 0xffff0000, v28
    v_lshlrev_b32 v26, 16, v29
    v_and_b32 v27, 0xffff0000, v29
    v_lshlrev_b32 v28, 16, v22
    v_and_b32 v29, 0xffff0000, v22
    v_lshlrev_b32 v30, 16, v23
    v_and_b32 v31, 0xffff0000, v23
    v_add_f32 v24, v24, v28
    v_add_f32 v25, v25, v29
    v_add_f32 v26, v26, v30
    v_add_f32 v27, v27, v31
    v_cvt_pk_bf16_f32 v28, v24, v25
    v_cvt_pk_bf16_f32 v29, v26, v27
    v_lshlrev_b32 v24, 16, v28
    v_and_b32 v25, 0xffff0000, v28
    v_lshlrev_b32 v26, 16, v29
    v_and_b32 v27, 0xffff0000, v29
    s_mov_b32 s66, 0x3d372713
    s_mov_b32 s67, 0xc0135761
    v_mul_f32 v28, v24, v24
    v_mul_f32 v28, v28, v24
    v_fma_f32 v28, s66, v28, v24
    v_mul_f32 v28, s67, v28
    v_exp_f32 v28, v28
    s_nop 0
    v_add_f32 v28, 1.0, v28
    v_rcp_f32 v28, v28
    s_nop 0
    v_mul_f32 v24, v24, v28
    v_mul_f32 v28, v25, v25
    v_mul_f32 v28, v28, v25
    v_fma_f32 v28, s66, v28, v25
    v_mul_f32 v28, s67, v28
    v_exp_f32 v28, v28
    s_nop 0
    v_add_f32 v28, 1.0, v28
    v_rcp_f32 v28, v28
    s_nop 0
    v_mul_f32 v25, v25, v28
    v_mul_f32 v28, v26, v26
    v_mul_f32 v28, v28, v26
    v_fma_f32 v28, s66, v28, v26
    v_mul_f32 v28, s67, v28
    v_exp_f32 v28, v28
    s_nop 0
    v_add_f32 v28, 1.0, v28
    v_rcp_f32 v28, v28
    s_nop 0
    v_mul_f32 v26, v26, v28
    v_mul_f32 v28, v27, v27
    v_mul_f32 v28, v28, v27
    v_fma_f32 v28, s66, v28, v27
    v_mul_f32 v28, s67, v28
    v_exp_f32 v28, v28
    s_nop 0
    v_add_f32 v28, 1.0, v28
    v_rcp_f32 v28, v28
    s_nop 0
    v_mul_f32 v27, v27, v28
    v_cvt_pk_bf16_f32 v28, v24, v25
    v_cvt_pk_bf16_f32 v29, v26, v27
    s_mov_b32 s66, 0
    buffer_store_dwordx2 v[28:29], v17, s[28:31], s66 offen offset:192
    s_nop 1
    buffer_load_dwordx2 v[22:23], v18, s[60:63], 0 offen offset:208
    v_accvgpr_read_b32 v24, a52
    v_accvgpr_read_b32 v25, a53
    v_accvgpr_read_b32 v26, a54
    v_accvgpr_read_b32 v27, a55
    s_waitcnt vmcnt(0)
    v_cvt_pk_bf16_f32 v28, v24, v25
    v_cvt_pk_bf16_f32 v29, v26, v27
    v_lshlrev_b32 v24, 16, v28
    v_and_b32 v25, 0xffff0000, v28
    v_lshlrev_b32 v26, 16, v29
    v_and_b32 v27, 0xffff0000, v29
    v_lshlrev_b32 v28, 16, v22
    v_and_b32 v29, 0xffff0000, v22
    v_lshlrev_b32 v30, 16, v23
    v_and_b32 v31, 0xffff0000, v23
    v_add_f32 v24, v24, v28
    v_add_f32 v25, v25, v29
    v_add_f32 v26, v26, v30
    v_add_f32 v27, v27, v31
    v_cvt_pk_bf16_f32 v28, v24, v25
    v_cvt_pk_bf16_f32 v29, v26, v27
    v_lshlrev_b32 v24, 16, v28
    v_and_b32 v25, 0xffff0000, v28
    v_lshlrev_b32 v26, 16, v29
    v_and_b32 v27, 0xffff0000, v29
    s_mov_b32 s66, 0x3d372713
    s_mov_b32 s67, 0xc0135761
    v_mul_f32 v28, v24, v24
    v_mul_f32 v28, v28, v24
    v_fma_f32 v28, s66, v28, v24
    v_mul_f32 v28, s67, v28
    v_exp_f32 v28, v28
    s_nop 0
    v_add_f32 v28, 1.0, v28
    v_rcp_f32 v28, v28
    s_nop 0
    v_mul_f32 v24, v24, v28
    v_mul_f32 v28, v25, v25
    v_mul_f32 v28, v28, v25
    v_fma_f32 v28, s66, v28, v25
    v_mul_f32 v28, s67, v28
    v_exp_f32 v28, v28
    s_nop 0
    v_add_f32 v28, 1.0, v28
    v_rcp_f32 v28, v28
    s_nop 0
    v_mul_f32 v25, v25, v28
    v_mul_f32 v28, v26, v26
    v_mul_f32 v28, v28, v26
    v_fma_f32 v28, s66, v28, v26
    v_mul_f32 v28, s67, v28
    v_exp_f32 v28, v28
    s_nop 0
    v_add_f32 v28, 1.0, v28
    v_rcp_f32 v28, v28
    s_nop 0
    v_mul_f32 v26, v26, v28
    v_mul_f32 v28, v27, v27
    v_mul_f32 v28, v28, v27
    v_fma_f32 v28, s66, v28, v27
    v_mul_f32 v28, s67, v28
    v_exp_f32 v28, v28
    s_nop 0
    v_add_f32 v28, 1.0, v28
    v_rcp_f32 v28, v28
    s_nop 0
    v_mul_f32 v27, v27, v28
    v_cvt_pk_bf16_f32 v28, v24, v25
    v_cvt_pk_bf16_f32 v29, v26, v27
    s_mov_b32 s66, 0
    buffer_store_dwordx2 v[28:29], v17, s[28:31], s66 offen offset:208
    s_nop 1
    buffer_load_dwordx2 v[22:23], v18, s[60:63], 0 offen offset:224
    v_accvgpr_read_b32 v24, a56
    v_accvgpr_read_b32 v25, a57
    v_accvgpr_read_b32 v26, a58
    v_accvgpr_read_b32 v27, a59
    s_waitcnt vmcnt(0)
    v_cvt_pk_bf16_f32 v28, v24, v25
    v_cvt_pk_bf16_f32 v29, v26, v27
    v_lshlrev_b32 v24, 16, v28
    v_and_b32 v25, 0xffff0000, v28
    v_lshlrev_b32 v26, 16, v29
    v_and_b32 v27, 0xffff0000, v29
    v_lshlrev_b32 v28, 16, v22
    v_and_b32 v29, 0xffff0000, v22
    v_lshlrev_b32 v30, 16, v23
    v_and_b32 v31, 0xffff0000, v23
    v_add_f32 v24, v24, v28
    v_add_f32 v25, v25, v29
    v_add_f32 v26, v26, v30
    v_add_f32 v27, v27, v31
    v_cvt_pk_bf16_f32 v28, v24, v25
    v_cvt_pk_bf16_f32 v29, v26, v27
    v_lshlrev_b32 v24, 16, v28
    v_and_b32 v25, 0xffff0000, v28
    v_lshlrev_b32 v26, 16, v29
    v_and_b32 v27, 0xffff0000, v29
    s_mov_b32 s66, 0x3d372713
    s_mov_b32 s67, 0xc0135761
    v_mul_f32 v28, v24, v24
    v_mul_f32 v28, v28, v24
    v_fma_f32 v28, s66, v28, v24
    v_mul_f32 v28, s67, v28
    v_exp_f32 v28, v28
    s_nop 0
    v_add_f32 v28, 1.0, v28
    v_rcp_f32 v28, v28
    s_nop 0
    v_mul_f32 v24, v24, v28
    v_mul_f32 v28, v25, v25
    v_mul_f32 v28, v28, v25
    v_fma_f32 v28, s66, v28, v25
    v_mul_f32 v28, s67, v28
    v_exp_f32 v28, v28
    s_nop 0
    v_add_f32 v28, 1.0, v28
    v_rcp_f32 v28, v28
    s_nop 0
    v_mul_f32 v25, v25, v28
    v_mul_f32 v28, v26, v26
    v_mul_f32 v28, v28, v26
    v_fma_f32 v28, s66, v28, v26
    v_mul_f32 v28, s67, v28
    v_exp_f32 v28, v28
    s_nop 0
    v_add_f32 v28, 1.0, v28
    v_rcp_f32 v28, v28
    s_nop 0
    v_mul_f32 v26, v26, v28
    v_mul_f32 v28, v27, v27
    v_mul_f32 v28, v28, v27
    v_fma_f32 v28, s66, v28, v27
    v_mul_f32 v28, s67, v28
    v_exp_f32 v28, v28
    s_nop 0
    v_add_f32 v28, 1.0, v28
    v_rcp_f32 v28, v28
    s_nop 0
    v_mul_f32 v27, v27, v28
    v_cvt_pk_bf16_f32 v28, v24, v25
    v_cvt_pk_bf16_f32 v29, v26, v27
    s_mov_b32 s66, 0
    buffer_store_dwordx2 v[28:29], v17, s[28:31], s66 offen offset:224
    s_nop 1
    buffer_load_dwordx2 v[22:23], v18, s[60:63], 0 offen offset:240
    v_accvgpr_read_b32 v24, a60
    v_accvgpr_read_b32 v25, a61
    v_accvgpr_read_b32 v26, a62
    v_accvgpr_read_b32 v27, a63
    s_waitcnt vmcnt(0)
    v_cvt_pk_bf16_f32 v28, v24, v25
    v_cvt_pk_bf16_f32 v29, v26, v27
    v_lshlrev_b32 v24, 16, v28
    v_and_b32 v25, 0xffff0000, v28
    v_lshlrev_b32 v26, 16, v29
    v_and_b32 v27, 0xffff0000, v29
    v_lshlrev_b32 v28, 16, v22
    v_and_b32 v29, 0xffff0000, v22
    v_lshlrev_b32 v30, 16, v23
    v_and_b32 v31, 0xffff0000, v23
    v_add_f32 v24, v24, v28
    v_add_f32 v25, v25, v29
    v_add_f32 v26, v26, v30
    v_add_f32 v27, v27, v31
    v_cvt_pk_bf16_f32 v28, v24, v25
    v_cvt_pk_bf16_f32 v29, v26, v27
    v_lshlrev_b32 v24, 16, v28
    v_and_b32 v25, 0xffff0000, v28
    v_lshlrev_b32 v26, 16, v29
    v_and_b32 v27, 0xffff0000, v29
    s_mov_b32 s66, 0x3d372713
    s_mov_b32 s67, 0xc0135761
    v_mul_f32 v28, v24, v24
    v_mul_f32 v28, v28, v24
    v_fma_f32 v28, s66, v28, v24
    v_mul_f32 v28, s67, v28
    v_exp_f32 v28, v28
    s_nop 0
    v_add_f32 v28, 1.0, v28
    v_rcp_f32 v28, v28
    s_nop 0
    v_mul_f32 v24, v24, v28
    v_mul_f32 v28, v25, v25
    v_mul_f32 v28, v28, v25
    v_fma_f32 v28, s66, v28, v25
    v_mul_f32 v28, s67, v28
    v_exp_f32 v28, v28
    s_nop 0
    v_add_f32 v28, 1.0, v28
    v_rcp_f32 v28, v28
    s_nop 0
    v_mul_f32 v25, v25, v28
    v_mul_f32 v28, v26, v26
    v_mul_f32 v28, v28, v26
    v_fma_f32 v28, s66, v28, v26
    v_mul_f32 v28, s67, v28
    v_exp_f32 v28, v28
    s_nop 0
    v_add_f32 v28, 1.0, v28
    v_rcp_f32 v28, v28
    s_nop 0
    v_mul_f32 v26, v26, v28
    v_mul_f32 v28, v27, v27
    v_mul_f32 v28, v28, v27
    v_fma_f32 v28, s66, v28, v27
    v_mul_f32 v28, s67, v28
    v_exp_f32 v28, v28
    s_nop 0
    v_add_f32 v28, 1.0, v28
    v_rcp_f32 v28, v28
    s_nop 0
    v_mul_f32 v27, v27, v28
    v_cvt_pk_bf16_f32 v28, v24, v25
    v_cvt_pk_bf16_f32 v29, v26, v27
    s_mov_b32 s66, 0
    buffer_store_dwordx2 v[28:29], v17, s[28:31], s66 offen offset:240
    s_nop 1
    buffer_load_dwordx2 v[22:23], v18, s[60:63], 0 offen offset:0
    v_accvgpr_read_b32 v24, a64
    v_accvgpr_read_b32 v25, a65
    v_accvgpr_read_b32 v26, a66
    v_accvgpr_read_b32 v27, a67
    s_waitcnt vmcnt(0)
    v_cvt_pk_bf16_f32 v28, v24, v25
    v_cvt_pk_bf16_f32 v29, v26, v27
    v_lshlrev_b32 v24, 16, v28
    v_and_b32 v25, 0xffff0000, v28
    v_lshlrev_b32 v26, 16, v29
    v_and_b32 v27, 0xffff0000, v29
    v_lshlrev_b32 v28, 16, v22
    v_and_b32 v29, 0xffff0000, v22
    v_lshlrev_b32 v30, 16, v23
    v_and_b32 v31, 0xffff0000, v23
    v_add_f32 v24, v24, v28
    v_add_f32 v25, v25, v29
    v_add_f32 v26, v26, v30
    v_add_f32 v27, v27, v31
    v_cvt_pk_bf16_f32 v28, v24, v25
    v_cvt_pk_bf16_f32 v29, v26, v27
    v_lshlrev_b32 v24, 16, v28
    v_and_b32 v25, 0xffff0000, v28
    v_lshlrev_b32 v26, 16, v29
    v_and_b32 v27, 0xffff0000, v29
    s_mov_b32 s66, 0x3d372713
    s_mov_b32 s67, 0xc0135761
    v_mul_f32 v28, v24, v24
    v_mul_f32 v28, v28, v24
    v_fma_f32 v28, s66, v28, v24
    v_mul_f32 v28, s67, v28
    v_exp_f32 v28, v28
    s_nop 0
    v_add_f32 v28, 1.0, v28
    v_rcp_f32 v28, v28
    s_nop 0
    v_mul_f32 v24, v24, v28
    v_mul_f32 v28, v25, v25
    v_mul_f32 v28, v28, v25
    v_fma_f32 v28, s66, v28, v25
    v_mul_f32 v28, s67, v28
    v_exp_f32 v28, v28
    s_nop 0
    v_add_f32 v28, 1.0, v28
    v_rcp_f32 v28, v28
    s_nop 0
    v_mul_f32 v25, v25, v28
    v_mul_f32 v28, v26, v26
    v_mul_f32 v28, v28, v26
    v_fma_f32 v28, s66, v28, v26
    v_mul_f32 v28, s67, v28
    v_exp_f32 v28, v28
    s_nop 0
    v_add_f32 v28, 1.0, v28
    v_rcp_f32 v28, v28
    s_nop 0
    v_mul_f32 v26, v26, v28
    v_mul_f32 v28, v27, v27
    v_mul_f32 v28, v28, v27
    v_fma_f32 v28, s66, v28, v27
    v_mul_f32 v28, s67, v28
    v_exp_f32 v28, v28
    s_nop 0
    v_add_f32 v28, 1.0, v28
    v_rcp_f32 v28, v28
    s_nop 0
    v_mul_f32 v27, v27, v28
    v_cvt_pk_bf16_f32 v28, v24, v25
    v_cvt_pk_bf16_f32 v29, v26, v27
    s_mov_b32 s66, 229376
    buffer_store_dwordx2 v[28:29], v17, s[28:31], s66 offen offset:0
    s_nop 1
    buffer_load_dwordx2 v[22:23], v18, s[60:63], 0 offen offset:16
    v_accvgpr_read_b32 v24, a68
    v_accvgpr_read_b32 v25, a69
    v_accvgpr_read_b32 v26, a70
    v_accvgpr_read_b32 v27, a71
    s_waitcnt vmcnt(0)
    v_cvt_pk_bf16_f32 v28, v24, v25
    v_cvt_pk_bf16_f32 v29, v26, v27
    v_lshlrev_b32 v24, 16, v28
    v_and_b32 v25, 0xffff0000, v28
    v_lshlrev_b32 v26, 16, v29
    v_and_b32 v27, 0xffff0000, v29
    v_lshlrev_b32 v28, 16, v22
    v_and_b32 v29, 0xffff0000, v22
    v_lshlrev_b32 v30, 16, v23
    v_and_b32 v31, 0xffff0000, v23
    v_add_f32 v24, v24, v28
    v_add_f32 v25, v25, v29
    v_add_f32 v26, v26, v30
    v_add_f32 v27, v27, v31
    v_cvt_pk_bf16_f32 v28, v24, v25
    v_cvt_pk_bf16_f32 v29, v26, v27
    v_lshlrev_b32 v24, 16, v28
    v_and_b32 v25, 0xffff0000, v28
    v_lshlrev_b32 v26, 16, v29
    v_and_b32 v27, 0xffff0000, v29
    s_mov_b32 s66, 0x3d372713
    s_mov_b32 s67, 0xc0135761
    v_mul_f32 v28, v24, v24
    v_mul_f32 v28, v28, v24
    v_fma_f32 v28, s66, v28, v24
    v_mul_f32 v28, s67, v28
    v_exp_f32 v28, v28
    s_nop 0
    v_add_f32 v28, 1.0, v28
    v_rcp_f32 v28, v28
    s_nop 0
    v_mul_f32 v24, v24, v28
    v_mul_f32 v28, v25, v25
    v_mul_f32 v28, v28, v25
    v_fma_f32 v28, s66, v28, v25
    v_mul_f32 v28, s67, v28
    v_exp_f32 v28, v28
    s_nop 0
    v_add_f32 v28, 1.0, v28
    v_rcp_f32 v28, v28
    s_nop 0
    v_mul_f32 v25, v25, v28
    v_mul_f32 v28, v26, v26
    v_mul_f32 v28, v28, v26
    v_fma_f32 v28, s66, v28, v26
    v_mul_f32 v28, s67, v28
    v_exp_f32 v28, v28
    s_nop 0
    v_add_f32 v28, 1.0, v28
    v_rcp_f32 v28, v28
    s_nop 0
    v_mul_f32 v26, v26, v28
    v_mul_f32 v28, v27, v27
    v_mul_f32 v28, v28, v27
    v_fma_f32 v28, s66, v28, v27
    v_mul_f32 v28, s67, v28
    v_exp_f32 v28, v28
    s_nop 0
    v_add_f32 v28, 1.0, v28
    v_rcp_f32 v28, v28
    s_nop 0
    v_mul_f32 v27, v27, v28
    v_cvt_pk_bf16_f32 v28, v24, v25
    v_cvt_pk_bf16_f32 v29, v26, v27
    s_mov_b32 s66, 229376
    buffer_store_dwordx2 v[28:29], v17, s[28:31], s66 offen offset:16
    s_nop 1
    buffer_load_dwordx2 v[22:23], v18, s[60:63], 0 offen offset:32
    v_accvgpr_read_b32 v24, a72
    v_accvgpr_read_b32 v25, a73
    v_accvgpr_read_b32 v26, a74
    v_accvgpr_read_b32 v27, a75
    s_waitcnt vmcnt(0)
    v_cvt_pk_bf16_f32 v28, v24, v25
    v_cvt_pk_bf16_f32 v29, v26, v27
    v_lshlrev_b32 v24, 16, v28
    v_and_b32 v25, 0xffff0000, v28
    v_lshlrev_b32 v26, 16, v29
    v_and_b32 v27, 0xffff0000, v29
    v_lshlrev_b32 v28, 16, v22
    v_and_b32 v29, 0xffff0000, v22
    v_lshlrev_b32 v30, 16, v23
    v_and_b32 v31, 0xffff0000, v23
    v_add_f32 v24, v24, v28
    v_add_f32 v25, v25, v29
    v_add_f32 v26, v26, v30
    v_add_f32 v27, v27, v31
    v_cvt_pk_bf16_f32 v28, v24, v25
    v_cvt_pk_bf16_f32 v29, v26, v27
    v_lshlrev_b32 v24, 16, v28
    v_and_b32 v25, 0xffff0000, v28
    v_lshlrev_b32 v26, 16, v29
    v_and_b32 v27, 0xffff0000, v29
    s_mov_b32 s66, 0x3d372713
    s_mov_b32 s67, 0xc0135761
    v_mul_f32 v28, v24, v24
    v_mul_f32 v28, v28, v24
    v_fma_f32 v28, s66, v28, v24
    v_mul_f32 v28, s67, v28
    v_exp_f32 v28, v28
    s_nop 0
    v_add_f32 v28, 1.0, v28
    v_rcp_f32 v28, v28
    s_nop 0
    v_mul_f32 v24, v24, v28
    v_mul_f32 v28, v25, v25
    v_mul_f32 v28, v28, v25
    v_fma_f32 v28, s66, v28, v25
    v_mul_f32 v28, s67, v28
    v_exp_f32 v28, v28
    s_nop 0
    v_add_f32 v28, 1.0, v28
    v_rcp_f32 v28, v28
    s_nop 0
    v_mul_f32 v25, v25, v28
    v_mul_f32 v28, v26, v26
    v_mul_f32 v28, v28, v26
    v_fma_f32 v28, s66, v28, v26
    v_mul_f32 v28, s67, v28
    v_exp_f32 v28, v28
    s_nop 0
    v_add_f32 v28, 1.0, v28
    v_rcp_f32 v28, v28
    s_nop 0
    v_mul_f32 v26, v26, v28
    v_mul_f32 v28, v27, v27
    v_mul_f32 v28, v28, v27
    v_fma_f32 v28, s66, v28, v27
    v_mul_f32 v28, s67, v28
    v_exp_f32 v28, v28
    s_nop 0
    v_add_f32 v28, 1.0, v28
    v_rcp_f32 v28, v28
    s_nop 0
    v_mul_f32 v27, v27, v28
    v_cvt_pk_bf16_f32 v28, v24, v25
    v_cvt_pk_bf16_f32 v29, v26, v27
    s_mov_b32 s66, 229376
    buffer_store_dwordx2 v[28:29], v17, s[28:31], s66 offen offset:32
    s_nop 1
    buffer_load_dwordx2 v[22:23], v18, s[60:63], 0 offen offset:48
    v_accvgpr_read_b32 v24, a76
    v_accvgpr_read_b32 v25, a77
    v_accvgpr_read_b32 v26, a78
    v_accvgpr_read_b32 v27, a79
    s_waitcnt vmcnt(0)
    v_cvt_pk_bf16_f32 v28, v24, v25
    v_cvt_pk_bf16_f32 v29, v26, v27
    v_lshlrev_b32 v24, 16, v28
    v_and_b32 v25, 0xffff0000, v28
    v_lshlrev_b32 v26, 16, v29
    v_and_b32 v27, 0xffff0000, v29
    v_lshlrev_b32 v28, 16, v22
    v_and_b32 v29, 0xffff0000, v22
    v_lshlrev_b32 v30, 16, v23
    v_and_b32 v31, 0xffff0000, v23
    v_add_f32 v24, v24, v28
    v_add_f32 v25, v25, v29
    v_add_f32 v26, v26, v30
    v_add_f32 v27, v27, v31
    v_cvt_pk_bf16_f32 v28, v24, v25
    v_cvt_pk_bf16_f32 v29, v26, v27
    v_lshlrev_b32 v24, 16, v28
    v_and_b32 v25, 0xffff0000, v28
    v_lshlrev_b32 v26, 16, v29
    v_and_b32 v27, 0xffff0000, v29
    s_mov_b32 s66, 0x3d372713
    s_mov_b32 s67, 0xc0135761
    v_mul_f32 v28, v24, v24
    v_mul_f32 v28, v28, v24
    v_fma_f32 v28, s66, v28, v24
    v_mul_f32 v28, s67, v28
    v_exp_f32 v28, v28
    s_nop 0
    v_add_f32 v28, 1.0, v28
    v_rcp_f32 v28, v28
    s_nop 0
    v_mul_f32 v24, v24, v28
    v_mul_f32 v28, v25, v25
    v_mul_f32 v28, v28, v25
    v_fma_f32 v28, s66, v28, v25
    v_mul_f32 v28, s67, v28
    v_exp_f32 v28, v28
    s_nop 0
    v_add_f32 v28, 1.0, v28
    v_rcp_f32 v28, v28
    s_nop 0
    v_mul_f32 v25, v25, v28
    v_mul_f32 v28, v26, v26
    v_mul_f32 v28, v28, v26
    v_fma_f32 v28, s66, v28, v26
    v_mul_f32 v28, s67, v28
    v_exp_f32 v28, v28
    s_nop 0
    v_add_f32 v28, 1.0, v28
    v_rcp_f32 v28, v28
    s_nop 0
    v_mul_f32 v26, v26, v28
    v_mul_f32 v28, v27, v27
    v_mul_f32 v28, v28, v27
    v_fma_f32 v28, s66, v28, v27
    v_mul_f32 v28, s67, v28
    v_exp_f32 v28, v28
    s_nop 0
    v_add_f32 v28, 1.0, v28
    v_rcp_f32 v28, v28
    s_nop 0
    v_mul_f32 v27, v27, v28
    v_cvt_pk_bf16_f32 v28, v24, v25
    v_cvt_pk_bf16_f32 v29, v26, v27
    s_mov_b32 s66, 229376
    buffer_store_dwordx2 v[28:29], v17, s[28:31], s66 offen offset:48
    s_nop 1
    buffer_load_dwordx2 v[22:23], v18, s[60:63], 0 offen offset:64
    v_accvgpr_read_b32 v24, a80
    v_accvgpr_read_b32 v25, a81
    v_accvgpr_read_b32 v26, a82
    v_accvgpr_read_b32 v27, a83
    s_waitcnt vmcnt(0)
    v_cvt_pk_bf16_f32 v28, v24, v25
    v_cvt_pk_bf16_f32 v29, v26, v27
    v_lshlrev_b32 v24, 16, v28
    v_and_b32 v25, 0xffff0000, v28
    v_lshlrev_b32 v26, 16, v29
    v_and_b32 v27, 0xffff0000, v29
    v_lshlrev_b32 v28, 16, v22
    v_and_b32 v29, 0xffff0000, v22
    v_lshlrev_b32 v30, 16, v23
    v_and_b32 v31, 0xffff0000, v23
    v_add_f32 v24, v24, v28
    v_add_f32 v25, v25, v29
    v_add_f32 v26, v26, v30
    v_add_f32 v27, v27, v31
    v_cvt_pk_bf16_f32 v28, v24, v25
    v_cvt_pk_bf16_f32 v29, v26, v27
    v_lshlrev_b32 v24, 16, v28
    v_and_b32 v25, 0xffff0000, v28
    v_lshlrev_b32 v26, 16, v29
    v_and_b32 v27, 0xffff0000, v29
    s_mov_b32 s66, 0x3d372713
    s_mov_b32 s67, 0xc0135761
    v_mul_f32 v28, v24, v24
    v_mul_f32 v28, v28, v24
    v_fma_f32 v28, s66, v28, v24
    v_mul_f32 v28, s67, v28
    v_exp_f32 v28, v28
    s_nop 0
    v_add_f32 v28, 1.0, v28
    v_rcp_f32 v28, v28
    s_nop 0
    v_mul_f32 v24, v24, v28
    v_mul_f32 v28, v25, v25
    v_mul_f32 v28, v28, v25
    v_fma_f32 v28, s66, v28, v25
    v_mul_f32 v28, s67, v28
    v_exp_f32 v28, v28
    s_nop 0
    v_add_f32 v28, 1.0, v28
    v_rcp_f32 v28, v28
    s_nop 0
    v_mul_f32 v25, v25, v28
    v_mul_f32 v28, v26, v26
    v_mul_f32 v28, v28, v26
    v_fma_f32 v28, s66, v28, v26
    v_mul_f32 v28, s67, v28
    v_exp_f32 v28, v28
    s_nop 0
    v_add_f32 v28, 1.0, v28
    v_rcp_f32 v28, v28
    s_nop 0
    v_mul_f32 v26, v26, v28
    v_mul_f32 v28, v27, v27
    v_mul_f32 v28, v28, v27
    v_fma_f32 v28, s66, v28, v27
    v_mul_f32 v28, s67, v28
    v_exp_f32 v28, v28
    s_nop 0
    v_add_f32 v28, 1.0, v28
    v_rcp_f32 v28, v28
    s_nop 0
    v_mul_f32 v27, v27, v28
    v_cvt_pk_bf16_f32 v28, v24, v25
    v_cvt_pk_bf16_f32 v29, v26, v27
    s_mov_b32 s66, 229376
    buffer_store_dwordx2 v[28:29], v17, s[28:31], s66 offen offset:64
    s_nop 1
    buffer_load_dwordx2 v[22:23], v18, s[60:63], 0 offen offset:80
    v_accvgpr_read_b32 v24, a84
    v_accvgpr_read_b32 v25, a85
    v_accvgpr_read_b32 v26, a86
    v_accvgpr_read_b32 v27, a87
    s_waitcnt vmcnt(0)
    v_cvt_pk_bf16_f32 v28, v24, v25
    v_cvt_pk_bf16_f32 v29, v26, v27
    v_lshlrev_b32 v24, 16, v28
    v_and_b32 v25, 0xffff0000, v28
    v_lshlrev_b32 v26, 16, v29
    v_and_b32 v27, 0xffff0000, v29
    v_lshlrev_b32 v28, 16, v22
    v_and_b32 v29, 0xffff0000, v22
    v_lshlrev_b32 v30, 16, v23
    v_and_b32 v31, 0xffff0000, v23
    v_add_f32 v24, v24, v28
    v_add_f32 v25, v25, v29
    v_add_f32 v26, v26, v30
    v_add_f32 v27, v27, v31
    v_cvt_pk_bf16_f32 v28, v24, v25
    v_cvt_pk_bf16_f32 v29, v26, v27
    v_lshlrev_b32 v24, 16, v28
    v_and_b32 v25, 0xffff0000, v28
    v_lshlrev_b32 v26, 16, v29
    v_and_b32 v27, 0xffff0000, v29
    s_mov_b32 s66, 0x3d372713
    s_mov_b32 s67, 0xc0135761
    v_mul_f32 v28, v24, v24
    v_mul_f32 v28, v28, v24
    v_fma_f32 v28, s66, v28, v24
    v_mul_f32 v28, s67, v28
    v_exp_f32 v28, v28
    s_nop 0
    v_add_f32 v28, 1.0, v28
    v_rcp_f32 v28, v28
    s_nop 0
    v_mul_f32 v24, v24, v28
    v_mul_f32 v28, v25, v25
    v_mul_f32 v28, v28, v25
    v_fma_f32 v28, s66, v28, v25
    v_mul_f32 v28, s67, v28
    v_exp_f32 v28, v28
    s_nop 0
    v_add_f32 v28, 1.0, v28
    v_rcp_f32 v28, v28
    s_nop 0
    v_mul_f32 v25, v25, v28
    v_mul_f32 v28, v26, v26
    v_mul_f32 v28, v28, v26
    v_fma_f32 v28, s66, v28, v26
    v_mul_f32 v28, s67, v28
    v_exp_f32 v28, v28
    s_nop 0
    v_add_f32 v28, 1.0, v28
    v_rcp_f32 v28, v28
    s_nop 0
    v_mul_f32 v26, v26, v28
    v_mul_f32 v28, v27, v27
    v_mul_f32 v28, v28, v27
    v_fma_f32 v28, s66, v28, v27
    v_mul_f32 v28, s67, v28
    v_exp_f32 v28, v28
    s_nop 0
    v_add_f32 v28, 1.0, v28
    v_rcp_f32 v28, v28
    s_nop 0
    v_mul_f32 v27, v27, v28
    v_cvt_pk_bf16_f32 v28, v24, v25
    v_cvt_pk_bf16_f32 v29, v26, v27
    s_mov_b32 s66, 229376
    buffer_store_dwordx2 v[28:29], v17, s[28:31], s66 offen offset:80
    s_nop 1
    buffer_load_dwordx2 v[22:23], v18, s[60:63], 0 offen offset:96
    v_accvgpr_read_b32 v24, a88
    v_accvgpr_read_b32 v25, a89
    v_accvgpr_read_b32 v26, a90
    v_accvgpr_read_b32 v27, a91
    s_waitcnt vmcnt(0)
    v_cvt_pk_bf16_f32 v28, v24, v25
    v_cvt_pk_bf16_f32 v29, v26, v27
    v_lshlrev_b32 v24, 16, v28
    v_and_b32 v25, 0xffff0000, v28
    v_lshlrev_b32 v26, 16, v29
    v_and_b32 v27, 0xffff0000, v29
    v_lshlrev_b32 v28, 16, v22
    v_and_b32 v29, 0xffff0000, v22
    v_lshlrev_b32 v30, 16, v23
    v_and_b32 v31, 0xffff0000, v23
    v_add_f32 v24, v24, v28
    v_add_f32 v25, v25, v29
    v_add_f32 v26, v26, v30
    v_add_f32 v27, v27, v31
    v_cvt_pk_bf16_f32 v28, v24, v25
    v_cvt_pk_bf16_f32 v29, v26, v27
    v_lshlrev_b32 v24, 16, v28
    v_and_b32 v25, 0xffff0000, v28
    v_lshlrev_b32 v26, 16, v29
    v_and_b32 v27, 0xffff0000, v29
    s_mov_b32 s66, 0x3d372713
    s_mov_b32 s67, 0xc0135761
    v_mul_f32 v28, v24, v24
    v_mul_f32 v28, v28, v24
    v_fma_f32 v28, s66, v28, v24
    v_mul_f32 v28, s67, v28
    v_exp_f32 v28, v28
    s_nop 0
    v_add_f32 v28, 1.0, v28
    v_rcp_f32 v28, v28
    s_nop 0
    v_mul_f32 v24, v24, v28
    v_mul_f32 v28, v25, v25
    v_mul_f32 v28, v28, v25
    v_fma_f32 v28, s66, v28, v25
    v_mul_f32 v28, s67, v28
    v_exp_f32 v28, v28
    s_nop 0
    v_add_f32 v28, 1.0, v28
    v_rcp_f32 v28, v28
    s_nop 0
    v_mul_f32 v25, v25, v28
    v_mul_f32 v28, v26, v26
    v_mul_f32 v28, v28, v26
    v_fma_f32 v28, s66, v28, v26
    v_mul_f32 v28, s67, v28
    v_exp_f32 v28, v28
    s_nop 0
    v_add_f32 v28, 1.0, v28
    v_rcp_f32 v28, v28
    s_nop 0
    v_mul_f32 v26, v26, v28
    v_mul_f32 v28, v27, v27
    v_mul_f32 v28, v28, v27
    v_fma_f32 v28, s66, v28, v27
    v_mul_f32 v28, s67, v28
    v_exp_f32 v28, v28
    s_nop 0
    v_add_f32 v28, 1.0, v28
    v_rcp_f32 v28, v28
    s_nop 0
    v_mul_f32 v27, v27, v28
    v_cvt_pk_bf16_f32 v28, v24, v25
    v_cvt_pk_bf16_f32 v29, v26, v27
    s_mov_b32 s66, 229376
    buffer_store_dwordx2 v[28:29], v17, s[28:31], s66 offen offset:96
    s_nop 1
    buffer_load_dwordx2 v[22:23], v18, s[60:63], 0 offen offset:112
    v_accvgpr_read_b32 v24, a92
    v_accvgpr_read_b32 v25, a93
    v_accvgpr_read_b32 v26, a94
    v_accvgpr_read_b32 v27, a95
    s_waitcnt vmcnt(0)
    v_cvt_pk_bf16_f32 v28, v24, v25
    v_cvt_pk_bf16_f32 v29, v26, v27
    v_lshlrev_b32 v24, 16, v28
    v_and_b32 v25, 0xffff0000, v28
    v_lshlrev_b32 v26, 16, v29
    v_and_b32 v27, 0xffff0000, v29
    v_lshlrev_b32 v28, 16, v22
    v_and_b32 v29, 0xffff0000, v22
    v_lshlrev_b32 v30, 16, v23
    v_and_b32 v31, 0xffff0000, v23
    v_add_f32 v24, v24, v28
    v_add_f32 v25, v25, v29
    v_add_f32 v26, v26, v30
    v_add_f32 v27, v27, v31
    v_cvt_pk_bf16_f32 v28, v24, v25
    v_cvt_pk_bf16_f32 v29, v26, v27
    v_lshlrev_b32 v24, 16, v28
    v_and_b32 v25, 0xffff0000, v28
    v_lshlrev_b32 v26, 16, v29
    v_and_b32 v27, 0xffff0000, v29
    s_mov_b32 s66, 0x3d372713
    s_mov_b32 s67, 0xc0135761
    v_mul_f32 v28, v24, v24
    v_mul_f32 v28, v28, v24
    v_fma_f32 v28, s66, v28, v24
    v_mul_f32 v28, s67, v28
    v_exp_f32 v28, v28
    s_nop 0
    v_add_f32 v28, 1.0, v28
    v_rcp_f32 v28, v28
    s_nop 0
    v_mul_f32 v24, v24, v28
    v_mul_f32 v28, v25, v25
    v_mul_f32 v28, v28, v25
    v_fma_f32 v28, s66, v28, v25
    v_mul_f32 v28, s67, v28
    v_exp_f32 v28, v28
    s_nop 0
    v_add_f32 v28, 1.0, v28
    v_rcp_f32 v28, v28
    s_nop 0
    v_mul_f32 v25, v25, v28
    v_mul_f32 v28, v26, v26
    v_mul_f32 v28, v28, v26
    v_fma_f32 v28, s66, v28, v26
    v_mul_f32 v28, s67, v28
    v_exp_f32 v28, v28
    s_nop 0
    v_add_f32 v28, 1.0, v28
    v_rcp_f32 v28, v28
    s_nop 0
    v_mul_f32 v26, v26, v28
    v_mul_f32 v28, v27, v27
    v_mul_f32 v28, v28, v27
    v_fma_f32 v28, s66, v28, v27
    v_mul_f32 v28, s67, v28
    v_exp_f32 v28, v28
    s_nop 0
    v_add_f32 v28, 1.0, v28
    v_rcp_f32 v28, v28
    s_nop 0
    v_mul_f32 v27, v27, v28
    v_cvt_pk_bf16_f32 v28, v24, v25
    v_cvt_pk_bf16_f32 v29, v26, v27
    s_mov_b32 s66, 229376
    buffer_store_dwordx2 v[28:29], v17, s[28:31], s66 offen offset:112
    s_nop 1
    buffer_load_dwordx2 v[22:23], v18, s[60:63], 0 offen offset:128
    v_accvgpr_read_b32 v24, a96
    v_accvgpr_read_b32 v25, a97
    v_accvgpr_read_b32 v26, a98
    v_accvgpr_read_b32 v27, a99
    s_waitcnt vmcnt(0)
    v_cvt_pk_bf16_f32 v28, v24, v25
    v_cvt_pk_bf16_f32 v29, v26, v27
    v_lshlrev_b32 v24, 16, v28
    v_and_b32 v25, 0xffff0000, v28
    v_lshlrev_b32 v26, 16, v29
    v_and_b32 v27, 0xffff0000, v29
    v_lshlrev_b32 v28, 16, v22
    v_and_b32 v29, 0xffff0000, v22
    v_lshlrev_b32 v30, 16, v23
    v_and_b32 v31, 0xffff0000, v23
    v_add_f32 v24, v24, v28
    v_add_f32 v25, v25, v29
    v_add_f32 v26, v26, v30
    v_add_f32 v27, v27, v31
    v_cvt_pk_bf16_f32 v28, v24, v25
    v_cvt_pk_bf16_f32 v29, v26, v27
    v_lshlrev_b32 v24, 16, v28
    v_and_b32 v25, 0xffff0000, v28
    v_lshlrev_b32 v26, 16, v29
    v_and_b32 v27, 0xffff0000, v29
    s_mov_b32 s66, 0x3d372713
    s_mov_b32 s67, 0xc0135761
    v_mul_f32 v28, v24, v24
    v_mul_f32 v28, v28, v24
    v_fma_f32 v28, s66, v28, v24
    v_mul_f32 v28, s67, v28
    v_exp_f32 v28, v28
    s_nop 0
    v_add_f32 v28, 1.0, v28
    v_rcp_f32 v28, v28
    s_nop 0
    v_mul_f32 v24, v24, v28
    v_mul_f32 v28, v25, v25
    v_mul_f32 v28, v28, v25
    v_fma_f32 v28, s66, v28, v25
    v_mul_f32 v28, s67, v28
    v_exp_f32 v28, v28
    s_nop 0
    v_add_f32 v28, 1.0, v28
    v_rcp_f32 v28, v28
    s_nop 0
    v_mul_f32 v25, v25, v28
    v_mul_f32 v28, v26, v26
    v_mul_f32 v28, v28, v26
    v_fma_f32 v28, s66, v28, v26
    v_mul_f32 v28, s67, v28
    v_exp_f32 v28, v28
    s_nop 0
    v_add_f32 v28, 1.0, v28
    v_rcp_f32 v28, v28
    s_nop 0
    v_mul_f32 v26, v26, v28
    v_mul_f32 v28, v27, v27
    v_mul_f32 v28, v28, v27
    v_fma_f32 v28, s66, v28, v27
    v_mul_f32 v28, s67, v28
    v_exp_f32 v28, v28
    s_nop 0
    v_add_f32 v28, 1.0, v28
    v_rcp_f32 v28, v28
    s_nop 0
    v_mul_f32 v27, v27, v28
    v_cvt_pk_bf16_f32 v28, v24, v25
    v_cvt_pk_bf16_f32 v29, v26, v27
    s_mov_b32 s66, 229376
    buffer_store_dwordx2 v[28:29], v17, s[28:31], s66 offen offset:128
    s_nop 1
    buffer_load_dwordx2 v[22:23], v18, s[60:63], 0 offen offset:144
    v_accvgpr_read_b32 v24, a100
    v_accvgpr_read_b32 v25, a101
    v_accvgpr_read_b32 v26, a102
    v_accvgpr_read_b32 v27, a103
    s_waitcnt vmcnt(0)
    v_cvt_pk_bf16_f32 v28, v24, v25
    v_cvt_pk_bf16_f32 v29, v26, v27
    v_lshlrev_b32 v24, 16, v28
    v_and_b32 v25, 0xffff0000, v28
    v_lshlrev_b32 v26, 16, v29
    v_and_b32 v27, 0xffff0000, v29
    v_lshlrev_b32 v28, 16, v22
    v_and_b32 v29, 0xffff0000, v22
    v_lshlrev_b32 v30, 16, v23
    v_and_b32 v31, 0xffff0000, v23
    v_add_f32 v24, v24, v28
    v_add_f32 v25, v25, v29
    v_add_f32 v26, v26, v30
    v_add_f32 v27, v27, v31
    v_cvt_pk_bf16_f32 v28, v24, v25
    v_cvt_pk_bf16_f32 v29, v26, v27
    v_lshlrev_b32 v24, 16, v28
    v_and_b32 v25, 0xffff0000, v28
    v_lshlrev_b32 v26, 16, v29
    v_and_b32 v27, 0xffff0000, v29
    s_mov_b32 s66, 0x3d372713
    s_mov_b32 s67, 0xc0135761
    v_mul_f32 v28, v24, v24
    v_mul_f32 v28, v28, v24
    v_fma_f32 v28, s66, v28, v24
    v_mul_f32 v28, s67, v28
    v_exp_f32 v28, v28
    s_nop 0
    v_add_f32 v28, 1.0, v28
    v_rcp_f32 v28, v28
    s_nop 0
    v_mul_f32 v24, v24, v28
    v_mul_f32 v28, v25, v25
    v_mul_f32 v28, v28, v25
    v_fma_f32 v28, s66, v28, v25
    v_mul_f32 v28, s67, v28
    v_exp_f32 v28, v28
    s_nop 0
    v_add_f32 v28, 1.0, v28
    v_rcp_f32 v28, v28
    s_nop 0
    v_mul_f32 v25, v25, v28
    v_mul_f32 v28, v26, v26
    v_mul_f32 v28, v28, v26
    v_fma_f32 v28, s66, v28, v26
    v_mul_f32 v28, s67, v28
    v_exp_f32 v28, v28
    s_nop 0
    v_add_f32 v28, 1.0, v28
    v_rcp_f32 v28, v28
    s_nop 0
    v_mul_f32 v26, v26, v28
    v_mul_f32 v28, v27, v27
    v_mul_f32 v28, v28, v27
    v_fma_f32 v28, s66, v28, v27
    v_mul_f32 v28, s67, v28
    v_exp_f32 v28, v28
    s_nop 0
    v_add_f32 v28, 1.0, v28
    v_rcp_f32 v28, v28
    s_nop 0
    v_mul_f32 v27, v27, v28
    v_cvt_pk_bf16_f32 v28, v24, v25
    v_cvt_pk_bf16_f32 v29, v26, v27
    s_mov_b32 s66, 229376
    buffer_store_dwordx2 v[28:29], v17, s[28:31], s66 offen offset:144
    s_nop 1
    buffer_load_dwordx2 v[22:23], v18, s[60:63], 0 offen offset:160
    v_accvgpr_read_b32 v24, a104
    v_accvgpr_read_b32 v25, a105
    v_accvgpr_read_b32 v26, a106
    v_accvgpr_read_b32 v27, a107
    s_waitcnt vmcnt(0)
    v_cvt_pk_bf16_f32 v28, v24, v25
    v_cvt_pk_bf16_f32 v29, v26, v27
    v_lshlrev_b32 v24, 16, v28
    v_and_b32 v25, 0xffff0000, v28
    v_lshlrev_b32 v26, 16, v29
    v_and_b32 v27, 0xffff0000, v29
    v_lshlrev_b32 v28, 16, v22
    v_and_b32 v29, 0xffff0000, v22
    v_lshlrev_b32 v30, 16, v23
    v_and_b32 v31, 0xffff0000, v23
    v_add_f32 v24, v24, v28
    v_add_f32 v25, v25, v29
    v_add_f32 v26, v26, v30
    v_add_f32 v27, v27, v31
    v_cvt_pk_bf16_f32 v28, v24, v25
    v_cvt_pk_bf16_f32 v29, v26, v27
    v_lshlrev_b32 v24, 16, v28
    v_and_b32 v25, 0xffff0000, v28
    v_lshlrev_b32 v26, 16, v29
    v_and_b32 v27, 0xffff0000, v29
    s_mov_b32 s66, 0x3d372713
    s_mov_b32 s67, 0xc0135761
    v_mul_f32 v28, v24, v24
    v_mul_f32 v28, v28, v24
    v_fma_f32 v28, s66, v28, v24
    v_mul_f32 v28, s67, v28
    v_exp_f32 v28, v28
    s_nop 0
    v_add_f32 v28, 1.0, v28
    v_rcp_f32 v28, v28
    s_nop 0
    v_mul_f32 v24, v24, v28
    v_mul_f32 v28, v25, v25
    v_mul_f32 v28, v28, v25
    v_fma_f32 v28, s66, v28, v25
    v_mul_f32 v28, s67, v28
    v_exp_f32 v28, v28
    s_nop 0
    v_add_f32 v28, 1.0, v28
    v_rcp_f32 v28, v28
    s_nop 0
    v_mul_f32 v25, v25, v28
    v_mul_f32 v28, v26, v26
    v_mul_f32 v28, v28, v26
    v_fma_f32 v28, s66, v28, v26
    v_mul_f32 v28, s67, v28
    v_exp_f32 v28, v28
    s_nop 0
    v_add_f32 v28, 1.0, v28
    v_rcp_f32 v28, v28
    s_nop 0
    v_mul_f32 v26, v26, v28
    v_mul_f32 v28, v27, v27
    v_mul_f32 v28, v28, v27
    v_fma_f32 v28, s66, v28, v27
    v_mul_f32 v28, s67, v28
    v_exp_f32 v28, v28
    s_nop 0
    v_add_f32 v28, 1.0, v28
    v_rcp_f32 v28, v28
    s_nop 0
    v_mul_f32 v27, v27, v28
    v_cvt_pk_bf16_f32 v28, v24, v25
    v_cvt_pk_bf16_f32 v29, v26, v27
    s_mov_b32 s66, 229376
    buffer_store_dwordx2 v[28:29], v17, s[28:31], s66 offen offset:160
    s_nop 1
    buffer_load_dwordx2 v[22:23], v18, s[60:63], 0 offen offset:176
    v_accvgpr_read_b32 v24, a108
    v_accvgpr_read_b32 v25, a109
    v_accvgpr_read_b32 v26, a110
    v_accvgpr_read_b32 v27, a111
    s_waitcnt vmcnt(0)
    v_cvt_pk_bf16_f32 v28, v24, v25
    v_cvt_pk_bf16_f32 v29, v26, v27
    v_lshlrev_b32 v24, 16, v28
    v_and_b32 v25, 0xffff0000, v28
    v_lshlrev_b32 v26, 16, v29
    v_and_b32 v27, 0xffff0000, v29
    v_lshlrev_b32 v28, 16, v22
    v_and_b32 v29, 0xffff0000, v22
    v_lshlrev_b32 v30, 16, v23
    v_and_b32 v31, 0xffff0000, v23
    v_add_f32 v24, v24, v28
    v_add_f32 v25, v25, v29
    v_add_f32 v26, v26, v30
    v_add_f32 v27, v27, v31
    v_cvt_pk_bf16_f32 v28, v24, v25
    v_cvt_pk_bf16_f32 v29, v26, v27
    v_lshlrev_b32 v24, 16, v28
    v_and_b32 v25, 0xffff0000, v28
    v_lshlrev_b32 v26, 16, v29
    v_and_b32 v27, 0xffff0000, v29
    s_mov_b32 s66, 0x3d372713
    s_mov_b32 s67, 0xc0135761
    v_mul_f32 v28, v24, v24
    v_mul_f32 v28, v28, v24
    v_fma_f32 v28, s66, v28, v24
    v_mul_f32 v28, s67, v28
    v_exp_f32 v28, v28
    s_nop 0
    v_add_f32 v28, 1.0, v28
    v_rcp_f32 v28, v28
    s_nop 0
    v_mul_f32 v24, v24, v28
    v_mul_f32 v28, v25, v25
    v_mul_f32 v28, v28, v25
    v_fma_f32 v28, s66, v28, v25
    v_mul_f32 v28, s67, v28
    v_exp_f32 v28, v28
    s_nop 0
    v_add_f32 v28, 1.0, v28
    v_rcp_f32 v28, v28
    s_nop 0
    v_mul_f32 v25, v25, v28
    v_mul_f32 v28, v26, v26
    v_mul_f32 v28, v28, v26
    v_fma_f32 v28, s66, v28, v26
    v_mul_f32 v28, s67, v28
    v_exp_f32 v28, v28
    s_nop 0
    v_add_f32 v28, 1.0, v28
    v_rcp_f32 v28, v28
    s_nop 0
    v_mul_f32 v26, v26, v28
    v_mul_f32 v28, v27, v27
    v_mul_f32 v28, v28, v27
    v_fma_f32 v28, s66, v28, v27
    v_mul_f32 v28, s67, v28
    v_exp_f32 v28, v28
    s_nop 0
    v_add_f32 v28, 1.0, v28
    v_rcp_f32 v28, v28
    s_nop 0
    v_mul_f32 v27, v27, v28
    v_cvt_pk_bf16_f32 v28, v24, v25
    v_cvt_pk_bf16_f32 v29, v26, v27
    s_mov_b32 s66, 229376
    buffer_store_dwordx2 v[28:29], v17, s[28:31], s66 offen offset:176
    s_nop 1
    buffer_load_dwordx2 v[22:23], v18, s[60:63], 0 offen offset:192
    v_accvgpr_read_b32 v24, a112
    v_accvgpr_read_b32 v25, a113
    v_accvgpr_read_b32 v26, a114
    v_accvgpr_read_b32 v27, a115
    s_waitcnt vmcnt(0)
    v_cvt_pk_bf16_f32 v28, v24, v25
    v_cvt_pk_bf16_f32 v29, v26, v27
    v_lshlrev_b32 v24, 16, v28
    v_and_b32 v25, 0xffff0000, v28
    v_lshlrev_b32 v26, 16, v29
    v_and_b32 v27, 0xffff0000, v29
    v_lshlrev_b32 v28, 16, v22
    v_and_b32 v29, 0xffff0000, v22
    v_lshlrev_b32 v30, 16, v23
    v_and_b32 v31, 0xffff0000, v23
    v_add_f32 v24, v24, v28
    v_add_f32 v25, v25, v29
    v_add_f32 v26, v26, v30
    v_add_f32 v27, v27, v31
    v_cvt_pk_bf16_f32 v28, v24, v25
    v_cvt_pk_bf16_f32 v29, v26, v27
    v_lshlrev_b32 v24, 16, v28
    v_and_b32 v25, 0xffff0000, v28
    v_lshlrev_b32 v26, 16, v29
    v_and_b32 v27, 0xffff0000, v29
    s_mov_b32 s66, 0x3d372713
    s_mov_b32 s67, 0xc0135761
    v_mul_f32 v28, v24, v24
    v_mul_f32 v28, v28, v24
    v_fma_f32 v28, s66, v28, v24
    v_mul_f32 v28, s67, v28
    v_exp_f32 v28, v28
    s_nop 0
    v_add_f32 v28, 1.0, v28
    v_rcp_f32 v28, v28
    s_nop 0
    v_mul_f32 v24, v24, v28
    v_mul_f32 v28, v25, v25
    v_mul_f32 v28, v28, v25
    v_fma_f32 v28, s66, v28, v25
    v_mul_f32 v28, s67, v28
    v_exp_f32 v28, v28
    s_nop 0
    v_add_f32 v28, 1.0, v28
    v_rcp_f32 v28, v28
    s_nop 0
    v_mul_f32 v25, v25, v28
    v_mul_f32 v28, v26, v26
    v_mul_f32 v28, v28, v26
    v_fma_f32 v28, s66, v28, v26
    v_mul_f32 v28, s67, v28
    v_exp_f32 v28, v28
    s_nop 0
    v_add_f32 v28, 1.0, v28
    v_rcp_f32 v28, v28
    s_nop 0
    v_mul_f32 v26, v26, v28
    v_mul_f32 v28, v27, v27
    v_mul_f32 v28, v28, v27
    v_fma_f32 v28, s66, v28, v27
    v_mul_f32 v28, s67, v28
    v_exp_f32 v28, v28
    s_nop 0
    v_add_f32 v28, 1.0, v28
    v_rcp_f32 v28, v28
    s_nop 0
    v_mul_f32 v27, v27, v28
    v_cvt_pk_bf16_f32 v28, v24, v25
    v_cvt_pk_bf16_f32 v29, v26, v27
    s_mov_b32 s66, 229376
    buffer_store_dwordx2 v[28:29], v17, s[28:31], s66 offen offset:192
    s_nop 1
    buffer_load_dwordx2 v[22:23], v18, s[60:63], 0 offen offset:208
    v_accvgpr_read_b32 v24, a116
    v_accvgpr_read_b32 v25, a117
    v_accvgpr_read_b32 v26, a118
    v_accvgpr_read_b32 v27, a119
    s_waitcnt vmcnt(0)
    v_cvt_pk_bf16_f32 v28, v24, v25
    v_cvt_pk_bf16_f32 v29, v26, v27
    v_lshlrev_b32 v24, 16, v28
    v_and_b32 v25, 0xffff0000, v28
    v_lshlrev_b32 v26, 16, v29
    v_and_b32 v27, 0xffff0000, v29
    v_lshlrev_b32 v28, 16, v22
    v_and_b32 v29, 0xffff0000, v22
    v_lshlrev_b32 v30, 16, v23
    v_and_b32 v31, 0xffff0000, v23
    v_add_f32 v24, v24, v28
    v_add_f32 v25, v25, v29
    v_add_f32 v26, v26, v30
    v_add_f32 v27, v27, v31
    v_cvt_pk_bf16_f32 v28, v24, v25
    v_cvt_pk_bf16_f32 v29, v26, v27
    v_lshlrev_b32 v24, 16, v28
    v_and_b32 v25, 0xffff0000, v28
    v_lshlrev_b32 v26, 16, v29
    v_and_b32 v27, 0xffff0000, v29
    s_mov_b32 s66, 0x3d372713
    s_mov_b32 s67, 0xc0135761
    v_mul_f32 v28, v24, v24
    v_mul_f32 v28, v28, v24
    v_fma_f32 v28, s66, v28, v24
    v_mul_f32 v28, s67, v28
    v_exp_f32 v28, v28
    s_nop 0
    v_add_f32 v28, 1.0, v28
    v_rcp_f32 v28, v28
    s_nop 0
    v_mul_f32 v24, v24, v28
    v_mul_f32 v28, v25, v25
    v_mul_f32 v28, v28, v25
    v_fma_f32 v28, s66, v28, v25
    v_mul_f32 v28, s67, v28
    v_exp_f32 v28, v28
    s_nop 0
    v_add_f32 v28, 1.0, v28
    v_rcp_f32 v28, v28
    s_nop 0
    v_mul_f32 v25, v25, v28
    v_mul_f32 v28, v26, v26
    v_mul_f32 v28, v28, v26
    v_fma_f32 v28, s66, v28, v26
    v_mul_f32 v28, s67, v28
    v_exp_f32 v28, v28
    s_nop 0
    v_add_f32 v28, 1.0, v28
    v_rcp_f32 v28, v28
    s_nop 0
    v_mul_f32 v26, v26, v28
    v_mul_f32 v28, v27, v27
    v_mul_f32 v28, v28, v27
    v_fma_f32 v28, s66, v28, v27
    v_mul_f32 v28, s67, v28
    v_exp_f32 v28, v28
    s_nop 0
    v_add_f32 v28, 1.0, v28
    v_rcp_f32 v28, v28
    s_nop 0
    v_mul_f32 v27, v27, v28
    v_cvt_pk_bf16_f32 v28, v24, v25
    v_cvt_pk_bf16_f32 v29, v26, v27
    s_mov_b32 s66, 229376
    buffer_store_dwordx2 v[28:29], v17, s[28:31], s66 offen offset:208
    s_nop 1
    buffer_load_dwordx2 v[22:23], v18, s[60:63], 0 offen offset:224
    v_accvgpr_read_b32 v24, a120
    v_accvgpr_read_b32 v25, a121
    v_accvgpr_read_b32 v26, a122
    v_accvgpr_read_b32 v27, a123
    s_waitcnt vmcnt(0)
    v_cvt_pk_bf16_f32 v28, v24, v25
    v_cvt_pk_bf16_f32 v29, v26, v27
    v_lshlrev_b32 v24, 16, v28
    v_and_b32 v25, 0xffff0000, v28
    v_lshlrev_b32 v26, 16, v29
    v_and_b32 v27, 0xffff0000, v29
    v_lshlrev_b32 v28, 16, v22
    v_and_b32 v29, 0xffff0000, v22
    v_lshlrev_b32 v30, 16, v23
    v_and_b32 v31, 0xffff0000, v23
    v_add_f32 v24, v24, v28
    v_add_f32 v25, v25, v29
    v_add_f32 v26, v26, v30
    v_add_f32 v27, v27, v31
    v_cvt_pk_bf16_f32 v28, v24, v25
    v_cvt_pk_bf16_f32 v29, v26, v27
    v_lshlrev_b32 v24, 16, v28
    v_and_b32 v25, 0xffff0000, v28
    v_lshlrev_b32 v26, 16, v29
    v_and_b32 v27, 0xffff0000, v29
    s_mov_b32 s66, 0x3d372713
    s_mov_b32 s67, 0xc0135761
    v_mul_f32 v28, v24, v24
    v_mul_f32 v28, v28, v24
    v_fma_f32 v28, s66, v28, v24
    v_mul_f32 v28, s67, v28
    v_exp_f32 v28, v28
    s_nop 0
    v_add_f32 v28, 1.0, v28
    v_rcp_f32 v28, v28
    s_nop 0
    v_mul_f32 v24, v24, v28
    v_mul_f32 v28, v25, v25
    v_mul_f32 v28, v28, v25
    v_fma_f32 v28, s66, v28, v25
    v_mul_f32 v28, s67, v28
    v_exp_f32 v28, v28
    s_nop 0
    v_add_f32 v28, 1.0, v28
    v_rcp_f32 v28, v28
    s_nop 0
    v_mul_f32 v25, v25, v28
    v_mul_f32 v28, v26, v26
    v_mul_f32 v28, v28, v26
    v_fma_f32 v28, s66, v28, v26
    v_mul_f32 v28, s67, v28
    v_exp_f32 v28, v28
    s_nop 0
    v_add_f32 v28, 1.0, v28
    v_rcp_f32 v28, v28
    s_nop 0
    v_mul_f32 v26, v26, v28
    v_mul_f32 v28, v27, v27
    v_mul_f32 v28, v28, v27
    v_fma_f32 v28, s66, v28, v27
    v_mul_f32 v28, s67, v28
    v_exp_f32 v28, v28
    s_nop 0
    v_add_f32 v28, 1.0, v28
    v_rcp_f32 v28, v28
    s_nop 0
    v_mul_f32 v27, v27, v28
    v_cvt_pk_bf16_f32 v28, v24, v25
    v_cvt_pk_bf16_f32 v29, v26, v27
    s_mov_b32 s66, 229376
    buffer_store_dwordx2 v[28:29], v17, s[28:31], s66 offen offset:224
    s_nop 1
    buffer_load_dwordx2 v[22:23], v18, s[60:63], 0 offen offset:240
    v_accvgpr_read_b32 v24, a124
    v_accvgpr_read_b32 v25, a125
    v_accvgpr_read_b32 v26, a126
    v_accvgpr_read_b32 v27, a127
    s_waitcnt vmcnt(0)
    v_cvt_pk_bf16_f32 v28, v24, v25
    v_cvt_pk_bf16_f32 v29, v26, v27
    v_lshlrev_b32 v24, 16, v28
    v_and_b32 v25, 0xffff0000, v28
    v_lshlrev_b32 v26, 16, v29
    v_and_b32 v27, 0xffff0000, v29
    v_lshlrev_b32 v28, 16, v22
    v_and_b32 v29, 0xffff0000, v22
    v_lshlrev_b32 v30, 16, v23
    v_and_b32 v31, 0xffff0000, v23
    v_add_f32 v24, v24, v28
    v_add_f32 v25, v25, v29
    v_add_f32 v26, v26, v30
    v_add_f32 v27, v27, v31
    v_cvt_pk_bf16_f32 v28, v24, v25
    v_cvt_pk_bf16_f32 v29, v26, v27
    v_lshlrev_b32 v24, 16, v28
    v_and_b32 v25, 0xffff0000, v28
    v_lshlrev_b32 v26, 16, v29
    v_and_b32 v27, 0xffff0000, v29
    s_mov_b32 s66, 0x3d372713
    s_mov_b32 s67, 0xc0135761
    v_mul_f32 v28, v24, v24
    v_mul_f32 v28, v28, v24
    v_fma_f32 v28, s66, v28, v24
    v_mul_f32 v28, s67, v28
    v_exp_f32 v28, v28
    s_nop 0
    v_add_f32 v28, 1.0, v28
    v_rcp_f32 v28, v28
    s_nop 0
    v_mul_f32 v24, v24, v28
    v_mul_f32 v28, v25, v25
    v_mul_f32 v28, v28, v25
    v_fma_f32 v28, s66, v28, v25
    v_mul_f32 v28, s67, v28
    v_exp_f32 v28, v28
    s_nop 0
    v_add_f32 v28, 1.0, v28
    v_rcp_f32 v28, v28
    s_nop 0
    v_mul_f32 v25, v25, v28
    v_mul_f32 v28, v26, v26
    v_mul_f32 v28, v28, v26
    v_fma_f32 v28, s66, v28, v26
    v_mul_f32 v28, s67, v28
    v_exp_f32 v28, v28
    s_nop 0
    v_add_f32 v28, 1.0, v28
    v_rcp_f32 v28, v28
    s_nop 0
    v_mul_f32 v26, v26, v28
    v_mul_f32 v28, v27, v27
    v_mul_f32 v28, v28, v27
    v_fma_f32 v28, s66, v28, v27
    v_mul_f32 v28, s67, v28
    v_exp_f32 v28, v28
    s_nop 0
    v_add_f32 v28, 1.0, v28
    v_rcp_f32 v28, v28
    s_nop 0
    v_mul_f32 v27, v27, v28
    v_cvt_pk_bf16_f32 v28, v24, v25
    v_cvt_pk_bf16_f32 v29, v26, v27
    s_mov_b32 s66, 229376
    buffer_store_dwordx2 v[28:29], v17, s[28:31], s66 offen offset:240
    s_nop 1
g1_kernel_done1:
    s_endpgm
.globl g2a_kernel
.p2align 8
.type g2a_kernel,@function
g2a_kernel:
    s_cmp_ge_u32 s2, 256
    s_cbranch_scc1 g2a_kernel_done1
    s_load_dwordx2 s[4:5], s[0:1], 112
    s_load_dwordx2 s[40:41], s[0:1], 80
    s_load_dwordx2 s[50:51], s[0:1], 88
    s_mov_b32 s34, 268435457
    s_mul_hi_u32 s35, s2, s34
    s_mul_i32 s36, s35, 16
    s_sub_u32 s34, s2, s36
    v_and_b32 v1, 63, v0
    v_lshrrev_b32 v17, 6, v0
    s_nop 0
    v_readfirstlane_b32 s37, v17
    s_waitcnt lgkmcnt(0)
    s_mul_i32 s38, s35, 917504
    s_add_u32 s38, s38, 75497472
    s_add_u32 s8, s4, s38
    s_addc_u32 s9, s5, 0
    s_and_b32 s9, s9, 0xffff
    s_mov_b32 s10, 917504
    s_mov_b32 s11, 0x00020000
    s_mul_i32 s38, s34, 64
    s_add_u32 s38, s38, 0
    s_mov_b32 s54, s40
    s_mov_b32 s55, s41
    s_lshl_b32 s38, s38, 1
    s_add_u32 s12, s54, s38
    s_addc_u32 s13, s55, 0
    s_and_b32 s13, s13, 0xffff
    s_sub_u32 s14, 7340032, s38
    s_mov_b32 s15, 0x00020000
    s_add_u32 s28, s4, 92274688
    s_addc_u32 s29, s5, 0
    s_and_b32 s29, s29, 0xffff
    s_mov_b32 s30, 4194304
    s_mov_b32 s31, 0x00020000
    s_add_u32 s56, s4, 71303168
    s_addc_u32 s57, s5, 0
    s_and_b32 s57, s57, 0xffff
    s_mov_b32 s58, 4194304
    s_mov_b32 s59, 0x00020000
    s_mov_b32 s60, s50
    s_and_b32 s61, s51, 0xffff
    s_mov_b32 s62, 2048
    s_mov_b32 s63, 0x00020000
    v_lshrrev_b32 v17, 3, v1
    v_and_b32 v18, 7, v1
    v_lshrrev_b32 v19, 4, v1
    v_xor_b32 v20, v18, v19
    v_xor_b32 v21, 4, v20
    s_mov_b32 s38, 7168
    v_mul_lo_u32 v22, s38, v17
    v_lshl_add_u32 v2, v20, 4, v22
    v_lshl_add_u32 v3, v21, 4, v22
    v_and_b32 v20, 1, v19
    v_lshlrev_b32 v20, 2, v20
    v_xor_b32 v20, v18, v20
    s_mov_b32 s38, 2048
    v_mul_lo_u32 v22, s38, v17
    v_lshl_add_u32 v4, v20, 4, v22
    s_and_b32 s38, s37, 3
    s_lshr_b32 s39, s37, 2
    v_and_b32 v17, 31, v1
    v_lshrrev_b32 v18, 5, v1
    v_lshrrev_b32 v19, 1, v17
    v_and_b32 v19, 7, v19
    s_mul_i32 s54, s38, 4096
    v_add_u32 v20, 0, v18
    v_xor_b32 v20, v20, v19
    v_lshlrev_b32 v20, 4, v20
    v_lshl_add_u32 v20, v17, 7, v20
    v_add_u32 v5, s54, v20
    v_add_u32 v20, 2, v18
    v_xor_b32 v20, v20, v19
    v_lshlrev_b32 v20, 4, v20
    v_lshl_add_u32 v20, v17, 7, v20
    v_add_u32 v6, s54, v20
    v_add_u32 v20, 4, v18
    v_xor_b32 v20, v20, v19
    v_lshlrev_b32 v20, 4, v20
    v_lshl_add_u32 v20, v17, 7, v20
    v_add_u32 v7, s54, v20
    v_add_u32 v20, 6, v18
    v_xor_b32 v20, v20, v19
    v_lshlrev_b32 v20, 4, v20
    v_lshl_add_u32 v20, v17, 7, v20
    v_add_u32 v8, s54, v20
    v_and_b32 v17, 15, v1
    v_lshrrev_b32 v19, 2, v17
    v_and_b32 v20, 3, v17
    v_bfe_u32 v21, v1, 4, 1
    v_lshlrev_b32 v22, 1, v21
    v_lshrrev_b32 v23, 1, v20
    v_add_u32 v22, v22, v23
    v_bfe_u32 v23, v19, 1, 1
    v_lshlrev_b32 v23, 2, v23
    v_xor_b32 v22, v22, v23
    v_lshlrev_b32 v22, 4, v22
    v_and_b32 v23, 1, v20
    v_lshl_add_u32 v22, v23, 3, v22
    v_lshl_add_u32 v23, v18, 3, v19
    v_lshl_add_u32 v22, v23, 7, v22
    v_add_u32 v9, 16384, v22
    v_xor_b32 v10, 64, v9
    s_mul_i32 s55, s39, 2
    v_accvgpr_write_b32 a0, 0
    v_accvgpr_write_b32 a1, 0
    v_accvgpr_write_b32 a2, 0
    v_accvgpr_write_b32 a3, 0
    v_accvgpr_write_b32 a4, 0
    v_accvgpr_write_b32 a5, 0
    v_accvgpr_write_b32 a6, 0
    v_accvgpr_write_b32 a7, 0
    v_accvgpr_write_b32 a8, 0
    v_accvgpr_write_b32 a9, 0
    v_accvgpr_write_b32 a10, 0
    v_accvgpr_write_b32 a11, 0
    v_accvgpr_write_b32 a12, 0
    v_accvgpr_write_b32 a13, 0
    v_accvgpr_write_b32 a14, 0
    v_accvgpr_write_b32 a15, 0
    v_accvgpr_write_b32 a16, 0
    v_accvgpr_write_b32 a17, 0
    v_accvgpr_write_b32 a18, 0
    v_accvgpr_write_b32 a19, 0
    v_accvgpr_write_b32 a20, 0
    v_accvgpr_write_b32 a21, 0
    v_accvgpr_write_b32 a22, 0
    v_accvgpr_write_b32 a23, 0
    v_accvgpr_write_b32 a24, 0
    v_accvgpr_write_b32 a25, 0
    v_accvgpr_write_b32 a26, 0
    v_accvgpr_write_b32 a27, 0
    v_accvgpr_write_b32 a28, 0
    v_accvgpr_write_b32 a29, 0
    v_accvgpr_write_b32 a30, 0
    v_accvgpr_write_b32 a31, 0
    s_mul_i32 s67, s37, 4
    s_mul_i32 s68, s37, 2
    s_mov_b32 s64, 0
    s_mov_b32 s65, 0
    s_mov_b32 s66, 0
    s_add_u32 s69, s67, 0
    s_mul_i32 s70, s69, 57344
    s_add_u32 s70, s70, s64
    s_lshl_b32 s69, s69, 10
    s_add_u32 m0, s69, s66
    buffer_load_dwordx4 v2, s[8:11], s70 offen lds
    s_add_u32 s69, s67, 1
    s_mul_i32 s70, s69, 57344
    s_add_u32 s70, s70, s64
    s_lshl_b32 s69, s69, 10
    s_add_u32 m0, s69, s66
    buffer_load_dwordx4 v3, s[8:11], s70 offen lds
    s_add_u32 s69, s67, 2
    s_mul_i32 s70, s69, 57344
    s_add_u32 s70, s70, s64
    s_lshl_b32 s69, s69, 10
    s_add_u32 m0, s69, s66
    buffer_load_dwordx4 v2, s[8:11], s70 offen lds
    s_add_u32 s69, s67, 3
    s_mul_i32 s70, s69, 57344
    s_add_u32 s70, s70, s64
    s_lshl_b32 s69, s69, 10
    s_add_u32 m0, s69, s66
    buffer_load_dwordx4 v3, s[8:11], s70 offen lds
    s_add_u32 s69, s68, 0
    s_and_b32 s71, s69, 7
    s_mul_i32 s70, s71, 16384
    s_add_u32 s70, s70, s65
    s_lshl_b32 s72, s69, 10
    s_add_u32 s72, s72, s66
    s_add_u32 m0, s72, 16384
    buffer_load_dwordx4 v4, s[12:15], s70 offen lds
    s_add_u32 s69, s68, 1
    s_and_b32 s71, s69, 7
    s_mul_i32 s70, s71, 16384
    s_add_u32 s70, s70, s65
    s_lshl_b32 s72, s69, 10
    s_add_u32 s72, s72, s66
    s_add_u32 m0, s72, 16384
    buffer_load_dwordx4 v4, s[12:15], s70 offen lds
    s_mov_b32 s64, 128
    s_mov_b32 s65, 131072
    s_mov_b32 s66, 24576
    s_add_u32 s69, s67, 0
    s_mul_i32 s70, s69, 57344
    s_add_u32 s70, s70, s64
    s_lshl_b32 s69, s69, 10
    s_add_u32 m0, s69, s66
    buffer_load_dwordx4 v2, s[8:11], s70 offen lds
    s_add_u32 s69, s67, 1
    s_mul_i32 s70, s69, 57344
    s_add_u32 s70, s70, s64
    s_lshl_b32 s69, s69, 10
    s_add_u32 m0, s69, s66
    buffer_load_dwordx4 v3, s[8:11], s70 offen lds
    s_add_u32 s69, s67, 2
    s_mul_i32 s70, s69, 57344
    s_add_u32 s70, s70, s64
    s_lshl_b32 s69, s69, 10
    s_add_u32 m0, s69, s66
    buffer_load_dwordx4 v2, s[8:11], s70 offen lds
    s_add_u32 s69, s67, 3
    s_mul_i32 s70, s69, 57344
    s_add_u32 s70, s70, s64
    s_lshl_b32 s69, s69, 10
    s_add_u32 m0, s69, s66
    buffer_load_dwordx4 v3, s[8:11], s70 offen lds
    s_add_u32 s69, s68, 0
    s_and_b32 s71, s69, 7
    s_mul_i32 s70, s71, 16384
    s_add_u32 s70, s70, s65
    s_lshl_b32 s72, s69, 10
    s_add_u32 s72, s72, s66
    s_add_u32 m0, s72, 16384
    buffer_load_dwordx4 v4, s[12:15], s70 offen lds
    s_add_u32 s69, s68, 1
    s_and_b32 s71, s69, 7
    s_mul_i32 s70, s71, 16384
    s_add_u32 s70, s70, s65
    s_lshl_b32 s72, s69, 10
    s_add_u32 s72, s72, s66
    s_add_u32 m0, s72, 16384
    buffer_load_dwordx4 v4, s[12:15], s70 offen lds
    s_mov_b32 s73, 0
    s_mov_b32 s74, 0
    s_mov_b32 s66, 49152
g2a_kernel_loop2:
    s_waitcnt vmcnt(6)
    s_barrier
    s_add_u32 s64, s64, 128
    s_add_u32 s65, s65, 131072
    s_add_u32 s69, s67, 0
    s_mul_i32 s70, s69, 57344
    s_add_u32 s70, s70, s64
    s_lshl_b32 s69, s69, 10
    s_add_u32 m0, s69, s66
    buffer_load_dwordx4 v2, s[8:11], s70 offen lds
    s_add_u32 s69, s67, 1
    s_mul_i32 s70, s69, 57344
    s_add_u32 s70, s70, s64
    s_lshl_b32 s69, s69, 10
    s_add_u32 m0, s69, s66
    buffer_load_dwordx4 v3, s[8:11], s70 offen lds
    s_add_u32 s69, s67, 2
    s_mul_i32 s70, s69, 57344
    s_add_u32 s70, s70, s64
    s_lshl_b32 s69, s69, 10
    s_add_u32 m0, s69, s66
    buffer_load_dwordx4 v2, s[8:11], s70 offen lds
    s_add_u32 s69, s67, 3
    s_mul_i32 s70, s69, 57344
    s_add_u32 s70, s70, s64
    s_lshl_b32 s69, s69, 10
    s_add_u32 m0, s69, s66
    buffer_load_dwordx4 v3, s[8:11], s70 offen lds
    s_add_u32 s69, s68, 0
    s_and_b32 s71, s69, 7
    s_mul_i32 s70, s71, 16384
    s_add_u32 s70, s70, s65
    s_lshl_b32 s72, s69, 10
    s_add_u32 s72, s72, s66
    s_add_u32 m0, s72, 16384
    buffer_load_dwordx4 v4, s[12:15], s70 offen lds
    s_add_u32 s69, s68, 1
    s_and_b32 s71, s69, 7
    s_mul_i32 s70, s71, 16384
    s_add_u32 s70, s70, s65
    s_lshl_b32 s72, s69, 10
    s_add_u32 s72, s72, s66
    s_add_u32 m0, s72, 16384
    buffer_load_dwordx4 v4, s[12:15], s70 offen lds
    s_add_u32 s66, s66, 24576
    s_cmp_ge_u32 s66, 73728
    s_cselect_b32 s75, 73728, 0
    s_sub_u32 s66, s66, s75
    v_add_u32 v11, s74, v5
    v_add_u32 v12, s74, v6
    v_add_u32 v13, s74, v7
    v_add_u32 v14, s74, v8
    v_add_u32 v15, s74, v9
    v_add_u32 v16, s74, v10
    s_add_u32 s76, s55, 0
    s_and_b32 s77, s76, 1
    s_lshr_b32 s76, s76, 1
    s_mul_i32 s76, s76, 8192
    s_cmp_eq_u32 s77, 0
    s_cselect_b64 s[78:79], -1, 0
    v_cndmask_b32 v17, v16, v15, s[78:79]
    v_add_u32 v17, s76, v17
    s_add_u32 s76, s55, 1
    s_and_b32 s77, s76, 1
    s_lshr_b32 s76, s76, 1
    s_mul_i32 s76, s76, 8192
    s_cmp_eq_u32 s77, 0
    s_cselect_b64 s[78:79], -1, 0
    v_cndmask_b32 v18, v16, v15, s[78:79]
    v_add_u32 v18, s76, v18
    ds_read_b128 v[24:27], v11 offset:0
    ds_read_b64_tr_b16 v[32:33], v17 offset:0
    ds_read_b64_tr_b16 v[34:35], v17 offset:512
    ds_read_b64_tr_b16 v[36:37], v18 offset:0
    ds_read_b64_tr_b16 v[38:39], v18 offset:512
    ds_read_b128 v[28:31], v12 offset:0
    ds_read_b64_tr_b16 v[40:41], v17 offset:2048
    ds_read_b64_tr_b16 v[42:43], v17 offset:2560
    ds_read_b64_tr_b16 v[44:45], v18 offset:2048
    ds_read_b64_tr_b16 v[46:47], v18 offset:2560
    s_waitcnt lgkmcnt(5)
    v_mfma_f32_32x32x16_bf16 a[0:15], v[32:35], v[24:27], a[0:15]
    v_mfma_f32_32x32x16_bf16 a[16:31], v[36:39], v[24:27], a[16:31]
    ds_read_b128 v[24:27], v13 offset:0
    ds_read_b64_tr_b16 v[32:33], v17 offset:4096
    ds_read_b64_tr_b16 v[34:35], v17 offset:4608
    ds_read_b64_tr_b16 v[36:37], v18 offset:4096
    ds_read_b64_tr_b16 v[38:39], v18 offset:4608
    s_waitcnt lgkmcnt(5)
    v_mfma_f32_32x32x16_bf16 a[0:15], v[40:43], v[28:31], a[0:15]
    v_mfma_f32_32x32x16_bf16 a[16:31], v[44:47], v[28:31], a[16:31]
    ds_read_b128 v[28:31], v14 offset:0
    ds_read_b64_tr_b16 v[40:41], v17 offset:6144
    ds_read_b64_tr_b16 v[42:43], v17 offset:6656
    ds_read_b64_tr_b16 v[44:45], v18 offset:6144
    ds_read_b64_tr_b16 v[46:47], v18 offset:6656
    s_waitcnt lgkmcnt(5)
    v_mfma_f32_32x32x16_bf16 a[0:15], v[32:35], v[24:27], a[0:15]
    v_mfma_f32_32x32x16_bf16 a[16:31], v[36:39], v[24:27], a[16:31]
    s_waitcnt lgkmcnt(0)
    v_mfma_f32_32x32x16_bf16 a[0:15], v[40:43], v[28:31], a[0:15]
    v_mfma_f32_32x32x16_bf16 a[16:31], v[44:47], v[28:31], a[16:31]
    s_add_u32 s74, s74, 24576
    s_cmp_ge_u32 s74, 73728
    s_cselect_b32 s75, 73728, 0
    s_sub_u32 s74, s74, s75
    s_add_u32 s73, s73, 1
    s_cmp_lt_u32 s73, 56
    s_cbranch_scc1 g2a_kernel_loop2
    s_nop 15
    s_nop 3
    v_and_b32 v17, 31, v1
    v_lshrrev_b32 v18, 5, v1
    s_mul_i32 s64, s35, 128
    s_mul_i32 s65, s38, 32
    s_add_u32 s64, s64, s65
    v_add_u32 v17, s64, v17
    s_mov_b32 s65, 2048
    v_mul_lo_u32 v17, s65, v17
    s_mul_i32 s64, s34, 64
    s_lshl_b32 s65, s55, 5
    s_add_u32 s64, s64, s65
    v_lshlrev_b32 v18, 2, v18
    v_add_u32 v18, s64, v18
    v_lshlrev_b32 v18, 1, v18
    v_add_u32 v17, v17, v18
    s_mov_b32 s66, 0
    buffer_load_dwordx2 v[20:21], v17, s[56:59], s66 offen offset:0
    buffer_load_dwordx2 v[22:23], v18, s[60:63], 0 offen offset:0
    v_accvgpr_read_b32 v24, a0
    v_accvgpr_read_b32 v25, a1
    v_accvgpr_read_b32 v26, a2
    v_accvgpr_read_b32 v27, a3
    s_waitcnt vmcnt(0)
    v_cvt_pk_bf16_f32 v28, v24, v25
    v_cvt_pk_bf16_f32 v29, v26, v27
    v_lshlrev_b32 v24, 16, v28
    v_and_b32 v25, 0xffff0000, v28
    v_lshlrev_b32 v26, 16, v29
    v_and_b32 v27, 0xffff0000, v29
    v_lshlrev_b32 v28, 16, v22
    v_and_b32 v29, 0xffff0000, v22
    v_lshlrev_b32 v30, 16, v23
    v_and_b32 v31, 0xffff0000, v23
    v_add_f32 v24, v24, v28
    v_add_f32 v25, v25, v29
    v_add_f32 v26, v26, v30
    v_add_f32 v27, v27, v31
    v_cvt_pk_bf16_f32 v28, v24, v25
    v_cvt_pk_bf16_f32 v29, v26, v27
    v_lshlrev_b32 v24, 16, v28
    v_and_b32 v25, 0xffff0000, v28
    v_lshlrev_b32 v26, 16, v29
    v_and_b32 v27, 0xffff0000, v29
    v_lshlrev_b32 v28, 16, v20
    v_and_b32 v29, 0xffff0000, v20
    v_lshlrev_b32 v30, 16, v21
    v_and_b32 v31, 0xffff0000, v21
    v_add_f32 v24, v24, v28
    v_add_f32 v25, v25, v29
    v_add_f32 v26, v26, v30
    v_add_f32 v27, v27, v31
    v_cvt_pk_bf16_f32 v28, v24, v25
    v_cvt_pk_bf16_f32 v29, v26, v27
    s_mov_b32 s66, 0
    buffer_store_dwordx2 v[28:29], v17, s[28:31], s66 offen offset:0
    s_nop 1
    s_mov_b32 s66, 0
    buffer_load_dwordx2 v[20:21], v17, s[56:59], s66 offen offset:16
    buffer_load_dwordx2 v[22:23], v18, s[60:63], 0 offen offset:16
    v_accvgpr_read_b32 v24, a4
    v_accvgpr_read_b32 v25, a5
    v_accvgpr_read_b32 v26, a6
    v_accvgpr_read_b32 v27, a7
    s_waitcnt vmcnt(0)
    v_cvt_pk_bf16_f32 v28, v24, v25
    v_cvt_pk_bf16_f32 v29, v26, v27
    v_lshlrev_b32 v24, 16, v28
    v_and_b32 v25, 0xffff0000, v28
    v_lshlrev_b32 v26, 16, v29
    v_and_b32 v27, 0xffff0000, v29
    v_lshlrev_b32 v28, 16, v22
    v_and_b32 v29, 0xffff0000, v22
    v_lshlrev_b32 v30, 16, v23
    v_and_b32 v31, 0xffff0000, v23
    v_add_f32 v24, v24, v28
    v_add_f32 v25, v25, v29
    v_add_f32 v26, v26, v30
    v_add_f32 v27, v27, v31
    v_cvt_pk_bf16_f32 v28, v24, v25
    v_cvt_pk_bf16_f32 v29, v26, v27
    v_lshlrev_b32 v24, 16, v28
    v_and_b32 v25, 0xffff0000, v28
    v_lshlrev_b32 v26, 16, v29
    v_and_b32 v27, 0xffff0000, v29
    v_lshlrev_b32 v28, 16, v20
    v_and_b32 v29, 0xffff0000, v20
    v_lshlrev_b32 v30, 16, v21
    v_and_b32 v31, 0xffff0000, v21
    v_add_f32 v24, v24, v28
    v_add_f32 v25, v25, v29
    v_add_f32 v26, v26, v30
    v_add_f32 v27, v27, v31
    v_cvt_pk_bf16_f32 v28, v24, v25
    v_cvt_pk_bf16_f32 v29, v26, v27
    s_mov_b32 s66, 0
    buffer_store_dwordx2 v[28:29], v17, s[28:31], s66 offen offset:16
    s_nop 1
    s_mov_b32 s66, 0
    buffer_load_dwordx2 v[20:21], v17, s[56:59], s66 offen offset:32
    buffer_load_dwordx2 v[22:23], v18, s[60:63], 0 offen offset:32
    v_accvgpr_read_b32 v24, a8
    v_accvgpr_read_b32 v25, a9
    v_accvgpr_read_b32 v26, a10
    v_accvgpr_read_b32 v27, a11
    s_waitcnt vmcnt(0)
    v_cvt_pk_bf16_f32 v28, v24, v25
    v_cvt_pk_bf16_f32 v29, v26, v27
    v_lshlrev_b32 v24, 16, v28
    v_and_b32 v25, 0xffff0000, v28
    v_lshlrev_b32 v26, 16, v29
    v_and_b32 v27, 0xffff0000, v29
    v_lshlrev_b32 v28, 16, v22
    v_and_b32 v29, 0xffff0000, v22
    v_lshlrev_b32 v30, 16, v23
    v_and_b32 v31, 0xffff0000, v23
    v_add_f32 v24, v24, v28
    v_add_f32 v25, v25, v29
    v_add_f32 v26, v26, v30
    v_add_f32 v27, v27, v31
    v_cvt_pk_bf16_f32 v28, v24, v25
    v_cvt_pk_bf16_f32 v29, v26, v27
    v_lshlrev_b32 v24, 16, v28
    v_and_b32 v25, 0xffff0000, v28
    v_lshlrev_b32 v26, 16, v29
    v_and_b32 v27, 0xffff0000, v29
    v_lshlrev_b32 v28, 16, v20
    v_and_b32 v29, 0xffff0000, v20
    v_lshlrev_b32 v30, 16, v21
    v_and_b32 v31, 0xffff0000, v21
    v_add_f32 v24, v24, v28
    v_add_f32 v25, v25, v29
    v_add_f32 v26, v26, v30
    v_add_f32 v27, v27, v31
    v_cvt_pk_bf16_f32 v28, v24, v25
    v_cvt_pk_bf16_f32 v29, v26, v27
    s_mov_b32 s66, 0
    buffer_store_dwordx2 v[28:29], v17, s[28:31], s66 offen offset:32
    s_nop 1
    s_mov_b32 s66, 0
    buffer_load_dwordx2 v[20:21], v17, s[56:59], s66 offen offset:48
    buffer_load_dwordx2 v[22:23], v18, s[60:63], 0 offen offset:48
    v_accvgpr_read_b32 v24, a12
    v_accvgpr_read_b32 v25, a13
    v_accvgpr_read_b32 v26, a14
    v_accvgpr_read_b32 v27, a15
    s_waitcnt vmcnt(0)
    v_cvt_pk_bf16_f32 v28, v24, v25
    v_cvt_pk_bf16_f32 v29, v26, v27
    v_lshlrev_b32 v24, 16, v28
    v_and_b32 v25, 0xffff0000, v28
    v_lshlrev_b32 v26, 16, v29
    v_and_b32 v27, 0xffff0000, v29
    v_lshlrev_b32 v28, 16, v22
    v_and_b32 v29, 0xffff0000, v22
    v_lshlrev_b32 v30, 16, v23
    v_and_b32 v31, 0xffff0000, v23
    v_add_f32 v24, v24, v28
    v_add_f32 v25, v25, v29
    v_add_f32 v26, v26, v30
    v_add_f32 v27, v27, v31
    v_cvt_pk_bf16_f32 v28, v24, v25
    v_cvt_pk_bf16_f32 v29, v26, v27
    v_lshlrev_b32 v24, 16, v28
    v_and_b32 v25, 0xffff0000, v28
    v_lshlrev_b32 v26, 16, v29
    v_and_b32 v27, 0xffff0000, v29
    v_lshlrev_b32 v28, 16, v20
    v_and_b32 v29, 0xffff0000, v20
    v_lshlrev_b32 v30, 16, v21
    v_and_b32 v31, 0xffff0000, v21
    v_add_f32 v24, v24, v28
    v_add_f32 v25, v25, v29
    v_add_f32 v26, v26, v30
    v_add_f32 v27, v27, v31
    v_cvt_pk_bf16_f32 v28, v24, v25
    v_cvt_pk_bf16_f32 v29, v26, v27
    s_mov_b32 s66, 0
    buffer_store_dwordx2 v[28:29], v17, s[28:31], s66 offen offset:48
    s_nop 1
    s_mov_b32 s66, 0
    buffer_load_dwordx2 v[20:21], v17, s[56:59], s66 offen offset:64
    buffer_load_dwordx2 v[22:23], v18, s[60:63], 0 offen offset:64
    v_accvgpr_read_b32 v24, a16
    v_accvgpr_read_b32 v25, a17
    v_accvgpr_read_b32 v26, a18
    v_accvgpr_read_b32 v27, a19
    s_waitcnt vmcnt(0)
    v_cvt_pk_bf16_f32 v28, v24, v25
    v_cvt_pk_bf16_f32 v29, v26, v27
    v_lshlrev_b32 v24, 16, v28
    v_and_b32 v25, 0xffff0000, v28
    v_lshlrev_b32 v26, 16, v29
    v_and_b32 v27, 0xffff0000, v29
    v_lshlrev_b32 v28, 16, v22
    v_and_b32 v29, 0xffff0000, v22
    v_lshlrev_b32 v30, 16, v23
    v_and_b32 v31, 0xffff0000, v23
    v_add_f32 v24, v24, v28
    v_add_f32 v25, v25, v29
    v_add_f32 v26, v26, v30
    v_add_f32 v27, v27, v31
    v_cvt_pk_bf16_f32 v28, v24, v25
    v_cvt_pk_bf16_f32 v29, v26, v27
    v_lshlrev_b32 v24, 16, v28
    v_and_b32 v25, 0xffff0000, v28
    v_lshlrev_b32 v26, 16, v29
    v_and_b32 v27, 0xffff0000, v29
    v_lshlrev_b32 v28, 16, v20
    v_and_b32 v29, 0xffff0000, v20
    v_lshlrev_b32 v30, 16, v21
    v_and_b32 v31, 0xffff0000, v21
    v_add_f32 v24, v24, v28
    v_add_f32 v25, v25, v29
    v_add_f32 v26, v26, v30
    v_add_f32 v27, v27, v31
    v_cvt_pk_bf16_f32 v28, v24, v25
    v_cvt_pk_bf16_f32 v29, v26, v27
    s_mov_b32 s66, 0
    buffer_store_dwordx2 v[28:29], v17, s[28:31], s66 offen offset:64
    s_nop 1
    s_mov_b32 s66, 0
    buffer_load_dwordx2 v[20:21], v17, s[56:59], s66 offen offset:80
    buffer_load_dwordx2 v[22:23], v18, s[60:63], 0 offen offset:80
    v_accvgpr_read_b32 v24, a20
    v_accvgpr_read_b32 v25, a21
    v_accvgpr_read_b32 v26, a22
    v_accvgpr_read_b32 v27, a23
    s_waitcnt vmcnt(0)
    v_cvt_pk_bf16_f32 v28, v24, v25
    v_cvt_pk_bf16_f32 v29, v26, v27
    v_lshlrev_b32 v24, 16, v28
    v_and_b32 v25, 0xffff0000, v28
    v_lshlrev_b32 v26, 16, v29
    v_and_b32 v27, 0xffff0000, v29
    v_lshlrev_b32 v28, 16, v22
    v_and_b32 v29, 0xffff0000, v22
    v_lshlrev_b32 v30, 16, v23
    v_and_b32 v31, 0xffff0000, v23
    v_add_f32 v24, v24, v28
    v_add_f32 v25, v25, v29
    v_add_f32 v26, v26, v30
    v_add_f32 v27, v27, v31
    v_cvt_pk_bf16_f32 v28, v24, v25
    v_cvt_pk_bf16_f32 v29, v26, v27
    v_lshlrev_b32 v24, 16, v28
    v_and_b32 v25, 0xffff0000, v28
    v_lshlrev_b32 v26, 16, v29
    v_and_b32 v27, 0xffff0000, v29
    v_lshlrev_b32 v28, 16, v20
    v_and_b32 v29, 0xffff0000, v20
    v_lshlrev_b32 v30, 16, v21
    v_and_b32 v31, 0xffff0000, v21
    v_add_f32 v24, v24, v28
    v_add_f32 v25, v25, v29
    v_add_f32 v26, v26, v30
    v_add_f32 v27, v27, v31
    v_cvt_pk_bf16_f32 v28, v24, v25
    v_cvt_pk_bf16_f32 v29, v26, v27
    s_mov_b32 s66, 0
    buffer_store_dwordx2 v[28:29], v17, s[28:31], s66 offen offset:80
    s_nop 1
    s_mov_b32 s66, 0
    buffer_load_dwordx2 v[20:21], v17, s[56:59], s66 offen offset:96
    buffer_load_dwordx2 v[22:23], v18, s[60:63], 0 offen offset:96
    v_accvgpr_read_b32 v24, a24
    v_accvgpr_read_b32 v25, a25
    v_accvgpr_read_b32 v26, a26
    v_accvgpr_read_b32 v27, a27
    s_waitcnt vmcnt(0)
    v_cvt_pk_bf16_f32 v28, v24, v25
    v_cvt_pk_bf16_f32 v29, v26, v27
    v_lshlrev_b32 v24, 16, v28
    v_and_b32 v25, 0xffff0000, v28
    v_lshlrev_b32 v26, 16, v29
    v_and_b32 v27, 0xffff0000, v29
    v_lshlrev_b32 v28, 16, v22
    v_and_b32 v29, 0xffff0000, v22
    v_lshlrev_b32 v30, 16, v23
    v_and_b32 v31, 0xffff0000, v23
    v_add_f32 v24, v24, v28
    v_add_f32 v25, v25, v29
    v_add_f32 v26, v26, v30
    v_add_f32 v27, v27, v31
    v_cvt_pk_bf16_f32 v28, v24, v25
    v_cvt_pk_bf16_f32 v29, v26, v27
    v_lshlrev_b32 v24, 16, v28
    v_and_b32 v25, 0xffff0000, v28
    v_lshlrev_b32 v26, 16, v29
    v_and_b32 v27, 0xffff0000, v29
    v_lshlrev_b32 v28, 16, v20
    v_and_b32 v29, 0xffff0000, v20
    v_lshlrev_b32 v30, 16, v21
    v_and_b32 v31, 0xffff0000, v21
    v_add_f32 v24, v24, v28
    v_add_f32 v25, v25, v29
    v_add_f32 v26, v26, v30
    v_add_f32 v27, v27, v31
    v_cvt_pk_bf16_f32 v28, v24, v25
    v_cvt_pk_bf16_f32 v29, v26, v27
    s_mov_b32 s66, 0
    buffer_store_dwordx2 v[28:29], v17, s[28:31], s66 offen offset:96
    s_nop 1
    s_mov_b32 s66, 0
    buffer_load_dwordx2 v[20:21], v17, s[56:59], s66 offen offset:112
    buffer_load_dwordx2 v[22:23], v18, s[60:63], 0 offen offset:112
    v_accvgpr_read_b32 v24, a28
    v_accvgpr_read_b32 v25, a29
    v_accvgpr_read_b32 v26, a30
    v_accvgpr_read_b32 v27, a31
    s_waitcnt vmcnt(0)
    v_cvt_pk_bf16_f32 v28, v24, v25
    v_cvt_pk_bf16_f32 v29, v26, v27
    v_lshlrev_b32 v24, 16, v28
    v_and_b32 v25, 0xffff0000, v28
    v_lshlrev_b32 v26, 16, v29
    v_and_b32 v27, 0xffff0000, v29
    v_lshlrev_b32 v28, 16, v22
    v_and_b32 v29, 0xffff0000, v22
    v_lshlrev_b32 v30, 16, v23
    v_and_b32 v31, 0xffff0000, v23
    v_add_f32 v24, v24, v28
    v_add_f32 v25, v25, v29
    v_add_f32 v26, v26, v30
    v_add_f32 v27, v27, v31
    v_cvt_pk_bf16_f32 v28, v24, v25
    v_cvt_pk_bf16_f32 v29, v26, v27
    v_lshlrev_b32 v24, 16, v28
    v_and_b32 v25, 0xffff0000, v28
    v_lshlrev_b32 v26, 16, v29
    v_and_b32 v27, 0xffff0000, v29
    v_lshlrev_b32 v28, 16, v20
    v_and_b32 v29, 0xffff0000, v20
    v_lshlrev_b32 v30, 16, v21
    v_and_b32 v31, 0xffff0000, v21
    v_add_f32 v24, v24, v28
    v_add_f32 v25, v25, v29
    v_add_f32 v26, v26, v30
    v_add_f32 v27, v27, v31
    v_cvt_pk_bf16_f32 v28, v24, v25
    v_cvt_pk_bf16_f32 v29, v26, v27
    s_mov_b32 s66, 0
    buffer_store_dwordx2 v[28:29], v17, s[28:31], s66 offen offset:112
    s_nop 1
g2a_kernel_done1:
    s_endpgm
.globl ln1b_kernel
.p2align 8
.type ln1b_kernel,@function
ln1b_kernel:
    s_cmp_ge_u32 s2, 512
    s_cbranch_scc1 ln1b_kernel_done1
    s_load_dwordx2 s[4:5], s[0:1], 112
    s_waitcnt lgkmcnt(0)
    s_add_u32 s8, s4, 92274688
    s_addc_u32 s9, s5, 0
    s_and_b32 s9, s9, 0xffff
    s_mov_b32 s10, 4194304
    s_mov_b32 s11, 0x00020000
    s_add_u32 s12, s4, 0
    s_addc_u32 s13, s5, 0
    s_and_b32 s13, s13, 0xffff
    s_mov_b32 s14, 4194304
    s_mov_b32 s15, 0x00020000
    v_and_b32 v1, 63, v0
    v_lshrrev_b32 v2, 6, v0
    s_lshl_b32 s3, s2, 2
    v_add_u32 v2, s3, v2
    v_lshlrev_b32 v3, 11, v2
    v_lshl_add_u32 v3, v1, 4, v3
    buffer_load_dwordx4 v[4:7], v3, s[8:11], 0 offen
    buffer_load_dwordx4 v[8:11], v3, s[8:11], 0 offen offset:1024
    v_xor_b32 v50, 1, v1
    v_lshlrev_b32 v50, 2, v50
    v_xor_b32 v51, 2, v1
    v_lshlrev_b32 v51, 2, v51
    v_xor_b32 v52, 4, v1
    v_lshlrev_b32 v52, 2, v52
    v_xor_b32 v53, 8, v1
    v_lshlrev_b32 v53, 2, v53
    v_xor_b32 v54, 16, v1
    v_lshlrev_b32 v54, 2, v54
    v_xor_b32 v55, 32, v1
    v_lshlrev_b32 v55, 2, v55
    s_waitcnt vmcnt(0)
    v_lshlrev_b32 v16, 16, v4
    v_and_b32 v17, 0xffff0000, v4
    v_lshlrev_b32 v18, 16, v5
    v_and_b32 v19, 0xffff0000, v5
    v_lshlrev_b32 v20, 16, v6
    v_and_b32 v21, 0xffff0000, v6
    v_lshlrev_b32 v22, 16, v7
    v_and_b32 v23, 0xffff0000, v7
    v_lshlrev_b32 v24, 16, v8
    v_and_b32 v25, 0xffff0000, v8
    v_lshlrev_b32 v26, 16, v9
    v_and_b32 v27, 0xffff0000, v9
    v_lshlrev_b32 v28, 16, v10
    v_and_b32 v29, 0xffff0000, v10
    v_lshlrev_b32 v30, 16, v11
    v_and_b32 v31, 0xffff0000, v11
    v_add_f32 v40, v16, v17
    v_add_f32 v40, v40, v18
    v_add_f32 v40, v40, v19
    v_add_f32 v40, v40, v20
    v_add_f32 v40, v40, v21
    v_add_f32 v40, v40, v22
    v_add_f32 v40, v40, v23
    v_add_f32 v40, v40, v24
    v_add_f32 v40, v40, v25
    v_add_f32 v40, v40, v26
    v_add_f32 v40, v40, v27
    v_add_f32 v40, v40, v28
    v_add_f32 v40, v40, v29
    v_add_f32 v40, v40, v30
    v_add_f32 v40, v40, v31
    ds_bpermute_b32 v48, v50, v40
    s_waitcnt lgkmcnt(0)
    v_add_f32 v40, v40, v48
    ds_bpermute_b32 v48, v51, v40
    s_waitcnt lgkmcnt(0)
    v_add_f32 v40, v40, v48
    ds_bpermute_b32 v48, v52, v40
    s_waitcnt lgkmcnt(0)
    v_add_f32 v40, v40, v48
    ds_bpermute_b32 v48, v53, v40
    s_waitcnt lgkmcnt(0)
    v_add_f32 v40, v40, v48
    ds_bpermute_b32 v48, v54, v40
    s_waitcnt lgkmcnt(0)
    v_add_f32 v40, v40, v48
    ds_bpermute_b32 v48, v55, v40
    s_waitcnt lgkmcnt(0)
    v_add_f32 v40, v40, v48
    v_mul_f32 v40, 0x3a800000, v40
    v_sub_f32 v41, v16, v40
    v_mul_f32 v42, v41, v41
    v_sub_f32 v41, v17, v40
    v_fmac_f32 v42, v41, v41
    v_sub_f32 v41, v18, v40
    v_fmac_f32 v42, v41, v41
    v_sub_f32 v41, v19, v40
    v_fmac_f32 v42, v41, v41
    v_sub_f32 v41, v20, v40
    v_fmac_f32 v42, v41, v41
    v_sub_f32 v41, v21, v40
    v_fmac_f32 v42, v41, v41
    v_sub_f32 v41, v22, v40
    v_fmac_f32 v42, v41, v41
    v_sub_f32 v41, v23, v40
    v_fmac_f32 v42, v41, v41
    v_sub_f32 v41, v24, v40
    v_fmac_f32 v42, v41, v41
    v_sub_f32 v41, v25, v40
    v_fmac_f32 v42, v41, v41
    v_sub_f32 v41, v26, v40
    v_fmac_f32 v42, v41, v41
    v_sub_f32 v41, v27, v40
    v_fmac_f32 v42, v41, v41
    v_sub_f32 v41, v28, v40
    v_fmac_f32 v42, v41, v41
    v_sub_f32 v41, v29, v40
    v_fmac_f32 v42, v41, v41
    v_sub_f32 v41, v30, v40
    v_fmac_f32 v42, v41, v41
    v_sub_f32 v41, v31, v40
    v_fmac_f32 v42, v41, v41
    ds_bpermute_b32 v48, v50, v42
    s_waitcnt lgkmcnt(0)
    v_add_f32 v42, v42, v48
    ds_bpermute_b32 v48, v51, v42
    s_waitcnt lgkmcnt(0)
    v_add_f32 v42, v42, v48
    ds_bpermute_b32 v48, v52, v42
    s_waitcnt lgkmcnt(0)
    v_add_f32 v42, v42, v48
    ds_bpermute_b32 v48, v53, v42
    s_waitcnt lgkmcnt(0)
    v_add_f32 v42, v42, v48
    ds_bpermute_b32 v48, v54, v42
    s_waitcnt lgkmcnt(0)
    v_add_f32 v42, v42, v48
    ds_bpermute_b32 v48, v55, v42
    s_waitcnt lgkmcnt(0)
    v_add_f32 v42, v42, v48
    v_mul_f32 v42, 0x3a800000, v42
    v_cvt_pk_bf16_f32 v40, v40, v40
    v_lshlrev_b32 v40, 16, v40
    v_cvt_pk_bf16_f32 v42, v42, v42
    v_lshlrev_b32 v42, 16, v42
    v_add_f32 v42, 0x3727c5ac, v42
    v_cvt_pk_bf16_f32 v42, v42, v42
    v_lshlrev_b32 v42, 16, v42
    v_sqrt_f32 v42, v42
    s_nop 0
    v_cvt_pk_bf16_f32 v42, v42, v42
    v_lshlrev_b32 v42, 16, v42
    v_rcp_f32 v43, v42
    s_nop 0
    v_fma_f32 v44, -v42, v43, 2.0
    v_mul_f32 v43, v43, v44
    v_sub_f32 v16, v16, v40
    v_sub_f32 v17, v17, v40
    v_cvt_pk_bf16_f32 v44, v16, v17
    v_lshlrev_b32 v16, 16, v44
    v_and_b32 v17, 0xffff0000, v44
    v_mul_f32 v16, v16, v43
    v_mul_f32 v17, v17, v43
    v_cvt_pk_bf16_f32 v4, v16, v17
    v_lshlrev_b32 v16, 16, v4
    v_and_b32 v17, 0xffff0000, v4
    v_sub_f32 v18, v18, v40
    v_sub_f32 v19, v19, v40
    v_cvt_pk_bf16_f32 v44, v18, v19
    v_lshlrev_b32 v18, 16, v44
    v_and_b32 v19, 0xffff0000, v44
    v_mul_f32 v18, v18, v43
    v_mul_f32 v19, v19, v43
    v_cvt_pk_bf16_f32 v5, v18, v19
    v_lshlrev_b32 v18, 16, v5
    v_and_b32 v19, 0xffff0000, v5
    v_sub_f32 v20, v20, v40
    v_sub_f32 v21, v21, v40
    v_cvt_pk_bf16_f32 v44, v20, v21
    v_lshlrev_b32 v20, 16, v44
    v_and_b32 v21, 0xffff0000, v44
    v_mul_f32 v20, v20, v43
    v_mul_f32 v21, v21, v43
    v_cvt_pk_bf16_f32 v6, v20, v21
    v_lshlrev_b32 v20, 16, v6
    v_and_b32 v21, 0xffff0000, v6
    v_sub_f32 v22, v22, v40
    v_sub_f32 v23, v23, v40
    v_cvt_pk_bf16_f32 v44, v22, v23
    v_lshlrev_b32 v22, 16, v44
    v_and_b32 v23, 0xffff0000, v44
    v_mul_f32 v22, v22, v43
    v_mul_f32 v23, v23, v43
    v_cvt_pk_bf16_f32 v7, v22, v23
    v_lshlrev_b32 v22, 16, v7
    v_and_b32 v23, 0xffff0000, v7
    v_sub_f32 v24, v24, v40
    v_sub_f32 v25, v25, v40
    v_cvt_pk_bf16_f32 v44, v24, v25
    v_lshlrev_b32 v24, 16, v44
    v_and_b32 v25, 0xffff0000, v44
    v_mul_f32 v24, v24, v43
    v_mul_f32 v25, v25, v43
    v_cvt_pk_bf16_f32 v8, v24, v25
    v_lshlrev_b32 v24, 16, v8
    v_and_b32 v25, 0xffff0000, v8
    v_sub_f32 v26, v26, v40
    v_sub_f32 v27, v27, v40
    v_cvt_pk_bf16_f32 v44, v26, v27
    v_lshlrev_b32 v26, 16, v44
    v_and_b32 v27, 0xffff0000, v44
    v_mul_f32 v26, v26, v43
    v_mul_f32 v27, v27, v43
    v_cvt_pk_bf16_f32 v9, v26, v27
    v_lshlrev_b32 v26, 16, v9
    v_and_b32 v27, 0xffff0000, v9
    v_sub_f32 v28, v28, v40
    v_sub_f32 v29, v29, v40
    v_cvt_pk_bf16_f32 v44, v28, v29
    v_lshlrev_b32 v28, 16, v44
    v_and_b32 v29, 0xffff0000, v44
    v_mul_f32 v28, v28, v43
    v_mul_f32 v29, v29, v43
    v_cvt_pk_bf16_f32 v10, v28, v29
    v_lshlrev_b32 v28, 16, v10
    v_and_b32 v29, 0xffff0000, v10
    v_sub_f32 v30, v30, v40
    v_sub_f32 v31, v31, v40
    v_cvt_pk_bf16_f32 v44, v30, v31
    v_lshlrev_b32 v30, 16, v44
    v_and_b32 v31, 0xffff0000, v44
    v_mul_f32 v30, v30, v43
    v_mul_f32 v31, v31, v43
    v_cvt_pk_bf16_f32 v11, v30, v31
    v_lshlrev_b32 v30, 16, v11
    v_and_b32 v31, 0xffff0000, v11
    buffer_store_dwordx4 v[4:7], v3, s[12:15], 0 offen
    buffer_store_dwordx4 v[8:11], v3, s[12:15], 0 offen offset:1024
ln1b_kernel_done1:
    s_endpgm
.globl gob_kernel
.p2align 8
.type gob_kernel,@function
gob_kernel:
    s_cmp_ge_u32 s2, 256
    s_cbranch_scc1 gob_kernel_done1
    s_load_dwordx2 s[4:5], s[0:1], 112
    s_load_dwordx2 s[40:41], s[0:1], 40
    s_mov_b32 s34, 268435457
    s_mul_hi_u32 s35, s2, s34
    s_mul_i32 s36, s35, 16
    s_sub_u32 s34, s2, s36
    v_and_b32 v1, 63, v0
    v_lshrrev_b32 v17, 6, v0
    s_nop 0
    v_readfirstlane_b32 s37, v17
    s_waitcnt lgkmcnt(0)
    s_mul_i32 s38, s35, 1048576
    s_add_u32 s38, s38, 54525952
    s_add_u32 s8, s4, s38
    s_addc_u32 s9, s5, 0
    s_and_b32 s9, s9, 0xffff
    s_mov_b32 s10, 1048576
    s_mov_b32 s11, 0x00020000
    s_mul_i32 s38, s34, 64
    s_add_u32 s38, s38, 0
    s_mov_b32 s54, s40
    s_mov_b32 s55, s41
    s_lshl_b32 s38, s38, 1
    s_add_u32 s12, s54, s38
    s_addc_u32 s13, s55, 0
    s_and_b32 s13, s13, 0xffff
    s_sub_u32 s14, 8388608, s38
    s_mov_b32 s15, 0x00020000
    s_add_u32 s28, s4, 71303168
    s_addc_u32 s29, s5, 0
    s_and_b32 s29, s29, 0xffff
    s_mov_b32 s30, 4194304
    s_mov_b32 s31, 0x00020000
    s_add_u32 s56, s4, 92274688
    s_addc_u32 s57, s5, 0
    s_and_b32 s57, s57, 0xffff
    s_mov_b32 s58, 4194304
    s_mov_b32 s59, 0x00020000
    v_lshrrev_b32 v17, 3, v1
    v_and_b32 v18, 7, v1
    v_lshrrev_b32 v19, 4, v1
    v_xor_b32 v20, v18, v19
    v_xor_b32 v21, 4, v20
    s_mov_b32 s38, 8192
    v_mul_lo_u32 v22, s38, v17
    v_lshl_add_u32 v2, v20, 4, v22
    v_lshl_add_u32 v3, v21, 4, v22
    v_and_b32 v20, 1, v19
    v_lshlrev_b32 v20, 2, v20
    v_xor_b32 v20, v18, v20
    s_mov_b32 s38, 2048
    v_mul_lo_u32 v22, s38, v17
    v_lshl_add_u32 v4, v20, 4, v22
    s_and_b32 s38, s37, 3
    s_lshr_b32 s39, s37, 2
    v_and_b32 v17, 31, v1
    v_lshrrev_b32 v18, 5, v1
    v_lshrrev_b32 v19, 1, v17
    v_and_b32 v19, 7, v19
    s_mul_i32 s54, s38, 4096
    v_add_u32 v20, 0, v18
    v_xor_b32 v20, v20, v19
    v_lshlrev_b32 v20, 4, v20
    v_lshl_add_u32 v20, v17, 7, v20
    v_add_u32 v5, s54, v20
    v_add_u32 v20, 2, v18
    v_xor_b32 v20, v20, v19
    v_lshlrev_b32 v20, 4, v20
    v_lshl_add_u32 v20, v17, 7, v20
    v_add_u32 v6, s54, v20
    v_add_u32 v20, 4, v18
    v_xor_b32 v20, v20, v19
    v_lshlrev_b32 v20, 4, v20
    v_lshl_add_u32 v20, v17, 7, v20
    v_add_u32 v7, s54, v20
    v_add_u32 v20, 6, v18
    v_xor_b32 v20, v20, v19
    v_lshlrev_b32 v20, 4, v20
    v_lshl_add_u32 v20, v17, 7, v20
    v_add_u32 v8, s54, v20
    v_and_b32 v17, 15, v1
    v_lshrrev_b32 v19, 2, v17
    v_and_b32 v20, 3, v17
    v_bfe_u32 v21, v1, 4, 1
    v_lshlrev_b32 v22, 1, v21
    v_lshrrev_b32 v23, 1, v20
    v_add_u32 v22, v22, v23
    v_bfe_u32 v23, v19, 1, 1
    v_lshlrev_b32 v23, 2, v23
    v_xor_b32 v22, v22, v23
    v_lshlrev_b32 v22, 4, v22
    v_and_b32 v23, 1, v20
    v_lshl_add_u32 v22, v23, 3, v22
    v_lshl_add_u32 v23, v18, 3, v19
    v_lshl_add_u32 v22, v23, 7, v22
    v_add_u32 v9, 16384, v22
    v_xor_b32 v10, 64, v9
    s_mul_i32 s55, s39, 2
    v_accvgpr_write_b32 a0, 0
    v_accvgpr_write_b32 a1, 0
    v_accvgpr_write_b32 a2, 0
    v_accvgpr_write_b32 a3, 0
    v_accvgpr_write_b32 a4, 0
    v_accvgpr_write_b32 a5, 0
    v_accvgpr_write_b32 a6, 0
    v_accvgpr_write_b32 a7, 0
    v_accvgpr_write_b32 a8, 0
    v_accvgpr_write_b32 a9, 0
    v_accvgpr_write_b32 a10, 0
    v_accvgpr_write_b32 a11, 0
    v_accvgpr_write_b32 a12, 0
    v_accvgpr_write_b32 a13, 0
    v_accvgpr_write_b32 a14, 0
    v_accvgpr_write_b32 a15, 0
    v_accvgpr_write_b32 a16, 0
    v_accvgpr_write_b32 a17, 0
    v_accvgpr_write_b32 a18, 0
    v_accvgpr_write_b32 a19, 0
    v_accvgpr_write_b32 a20, 0
    v_accvgpr_write_b32 a21, 0
    v_accvgpr_write_b32 a22, 0
    v_accvgpr_write_b32 a23, 0
    v_accvgpr_write_b32 a24, 0
    v_accvgpr_write_b32 a25, 0
    v_accvgpr_write_b32 a26, 0
    v_accvgpr_write_b32 a27, 0
    v_accvgpr_write_b32 a28, 0
    v_accvgpr_write_b32 a29, 0
    v_accvgpr_write_b32 a30, 0
    v_accvgpr_write_b32 a31, 0
    s_mul_i32 s67, s37, 4
    s_mul_i32 s68, s37, 2
    s_mov_b32 s64, 0
    s_mov_b32 s65, 0
    s_mov_b32 s66, 0
    s_add_u32 s69, s67, 0
    s_mul_i32 s70, s69, 65536
    s_add_u32 s70, s70, s64
    s_lshl_b32 s69, s69, 10
    s_add_u32 m0, s69, s66
    buffer_load_dwordx4 v2, s[8:11], s70 offen lds
    s_add_u32 s69, s67, 1
    s_mul_i32 s70, s69, 65536
    s_add_u32 s70, s70, s64
    s_lshl_b32 s69, s69, 10
    s_add_u32 m0, s69, s66
    buffer_load_dwordx4 v3, s[8:11], s70 offen lds
    s_add_u32 s69, s67, 2
    s_mul_i32 s70, s69, 65536
    s_add_u32 s70, s70, s64
    s_lshl_b32 s69, s69, 10
    s_add_u32 m0, s69, s66
    buffer_load_dwordx4 v2, s[8:11], s70 offen lds
    s_add_u32 s69, s67, 3
    s_mul_i32 s70, s69, 65536
    s_add_u32 s70, s70, s64
    s_lshl_b32 s69, s69, 10
    s_add_u32 m0, s69, s66
    buffer_load_dwordx4 v3, s[8:11], s70 offen lds
    s_add_u32 s69, s68, 0
    s_and_b32 s71, s69, 7
    s_mul_i32 s70, s71, 16384
    s_add_u32 s70, s70, s65
    s_lshl_b32 s72, s69, 10
    s_add_u32 s72, s72, s66
    s_add_u32 m0, s72, 16384
    buffer_load_dwordx4 v4, s[12:15], s70 offen lds
    s_add_u32 s69, s68, 1
    s_and_b32 s71, s69, 7
    s_mul_i32 s70, s71, 16384
    s_add_u32 s70, s70, s65
    s_lshl_b32 s72, s69, 10
    s_add_u32 s72, s72, s66
    s_add_u32 m0, s72, 16384
    buffer_load_dwordx4 v4, s[12:15], s70 offen lds
    s_mov_b32 s64, 128
    s_mov_b32 s65, 131072
    s_mov_b32 s66, 24576
    s_add_u32 s69, s67, 0
    s_mul_i32 s70, s69, 65536
    s_add_u32 s70, s70, s64
    s_lshl_b32 s69, s69, 10
    s_add_u32 m0, s69, s66
    buffer_load_dwordx4 v2, s[8:11], s70 offen lds
    s_add_u32 s69, s67, 1
    s_mul_i32 s70, s69, 65536
    s_add_u32 s70, s70, s64
    s_lshl_b32 s69, s69, 10
    s_add_u32 m0, s69, s66
    buffer_load_dwordx4 v3, s[8:11], s70 offen lds
    s_add_u32 s69, s67, 2
    s_mul_i32 s70, s69, 65536
    s_add_u32 s70, s70, s64
    s_lshl_b32 s69, s69, 10
    s_add_u32 m0, s69, s66
    buffer_load_dwordx4 v2, s[8:11], s70 offen lds
    s_add_u32 s69, s67, 3
    s_mul_i32 s70, s69, 65536
    s_add_u32 s70, s70, s64
    s_lshl_b32 s69, s69, 10
    s_add_u32 m0, s69, s66
    buffer_load_dwordx4 v3, s[8:11], s70 offen lds
    s_add_u32 s69, s68, 0
    s_and_b32 s71, s69, 7
    s_mul_i32 s70, s71, 16384
    s_add_u32 s70, s70, s65
    s_lshl_b32 s72, s69, 10
    s_add_u32 s72, s72, s66
    s_add_u32 m0, s72, 16384
    buffer_load_dwordx4 v4, s[12:15], s70 offen lds
    s_add_u32 s69, s68, 1
    s_and_b32 s71, s69, 7
    s_mul_i32 s70, s71, 16384
    s_add_u32 s70, s70, s65
    s_lshl_b32 s72, s69, 10
    s_add_u32 s72, s72, s66
    s_add_u32 m0, s72, 16384
    buffer_load_dwordx4 v4, s[12:15], s70 offen lds
    s_mov_b32 s73, 0
    s_mov_b32 s74, 0
    s_mov_b32 s66, 49152
gob_kernel_loop2:
    s_waitcnt vmcnt(6)
    s_barrier
    s_add_u32 s64, s64, 128
    s_add_u32 s65, s65, 131072
    s_add_u32 s69, s67, 0
    s_mul_i32 s70, s69, 65536
    s_add_u32 s70, s70, s64
    s_lshl_b32 s69, s69, 10
    s_add_u32 m0, s69, s66
    buffer_load_dwordx4 v2, s[8:11], s70 offen lds
    s_add_u32 s69, s67, 1
    s_mul_i32 s70, s69, 65536
    s_add_u32 s70, s70, s64
    s_lshl_b32 s69, s69, 10
    s_add_u32 m0, s69, s66
    buffer_load_dwordx4 v3, s[8:11], s70 offen lds
    s_add_u32 s69, s67, 2
    s_mul_i32 s70, s69, 65536
    s_add_u32 s70, s70, s64
    s_lshl_b32 s69, s69, 10
    s_add_u32 m0, s69, s66
    buffer_load_dwordx4 v2, s[8:11], s70 offen lds
    s_add_u32 s69, s67, 3
    s_mul_i32 s70, s69, 65536
    s_add_u32 s70, s70, s64
    s_lshl_b32 s69, s69, 10
    s_add_u32 m0, s69, s66
    buffer_load_dwordx4 v3, s[8:11], s70 offen lds
    s_add_u32 s69, s68, 0
    s_and_b32 s71, s69, 7
    s_mul_i32 s70, s71, 16384
    s_add_u32 s70, s70, s65
    s_lshl_b32 s72, s69, 10
    s_add_u32 s72, s72, s66
    s_add_u32 m0, s72, 16384
    buffer_load_dwordx4 v4, s[12:15], s70 offen lds
    s_add_u32 s69, s68, 1
    s_and_b32 s71, s69, 7
    s_mul_i32 s70, s71, 16384
    s_add_u32 s70, s70, s65
    s_lshl_b32 s72, s69, 10
    s_add_u32 s72, s72, s66
    s_add_u32 m0, s72, 16384
    buffer_load_dwordx4 v4, s[12:15], s70 offen lds
    s_add_u32 s66, s66, 24576
    s_cmp_ge_u32 s66, 73728
    s_cselect_b32 s75, 73728, 0
    s_sub_u32 s66, s66, s75
    v_add_u32 v11, s74, v5
    v_add_u32 v12, s74, v6
    v_add_u32 v13, s74, v7
    v_add_u32 v14, s74, v8
    v_add_u32 v15, s74, v9
    v_add_u32 v16, s74, v10
    s_add_u32 s76, s55, 0
    s_and_b32 s77, s76, 1
    s_lshr_b32 s76, s76, 1
    s_mul_i32 s76, s76, 8192
    s_cmp_eq_u32 s77, 0
    s_cselect_b64 s[78:79], -1, 0
    v_cndmask_b32 v17, v16, v15, s[78:79]
    v_add_u32 v17, s76, v17
    s_add_u32 s76, s55, 1
    s_and_b32 s77, s76, 1
    s_lshr_b32 s76, s76, 1
    s_mul_i32 s76, s76, 8192
    s_cmp_eq_u32 s77, 0
    s_cselect_b64 s[78:79], -1, 0
    v_cndmask_b32 v18, v16, v15, s[78:79]
    v_add_u32 v18, s76, v18
    ds_read_b128 v[24:27], v11 offset:0
    ds_read_b64_tr_b16 v[32:33], v17 offset:0
    ds_read_b64_tr_b16 v[34:35], v17 offset:512
    ds_read_b64_tr_b16 v[36:37], v18 offset:0
    ds_read_b64_tr_b16 v[38:39], v18 offset:512
    ds_read_b128 v[28:31], v12 offset:0
    ds_read_b64_tr_b16 v[40:41], v17 offset:2048
    ds_read_b64_tr_b16 v[42:43], v17 offset:2560
    ds_read_b64_tr_b16 v[44:45], v18 offset:2048
    ds_read_b64_tr_b16 v[46:47], v18 offset:2560
    s_waitcnt lgkmcnt(5)
    v_mfma_f32_32x32x16_bf16 a[0:15], v[32:35], v[24:27], a[0:15]
    v_mfma_f32_32x32x16_bf16 a[16:31], v[36:39], v[24:27], a[16:31]
    ds_read_b128 v[24:27], v13 offset:0
    ds_read_b64_tr_b16 v[32:33], v17 offset:4096
    ds_read_b64_tr_b16 v[34:35], v17 offset:4608
    ds_read_b64_tr_b16 v[36:37], v18 offset:4096
    ds_read_b64_tr_b16 v[38:39], v18 offset:4608
    s_waitcnt lgkmcnt(5)
    v_mfma_f32_32x32x16_bf16 a[0:15], v[40:43], v[28:31], a[0:15]
    v_mfma_f32_32x32x16_bf16 a[16:31], v[44:47], v[28:31], a[16:31]
    ds_read_b128 v[28:31], v14 offset:0
    ds_read_b64_tr_b16 v[40:41], v17 offset:6144
    ds_read_b64_tr_b16 v[42:43], v17 offset:6656
    ds_read_b64_tr_b16 v[44:45], v18 offset:6144
    ds_read_b64_tr_b16 v[46:47], v18 offset:6656
    s_waitcnt lgkmcnt(5)
    v_mfma_f32_32x32x16_bf16 a[0:15], v[32:35], v[24:27], a[0:15]
    v_mfma_f32_32x32x16_bf16 a[16:31], v[36:39], v[24:27], a[16:31]
    s_waitcnt lgkmcnt(0)
    v_mfma_f32_32x32x16_bf16 a[0:15], v[40:43], v[28:31], a[0:15]
    v_mfma_f32_32x32x16_bf16 a[16:31], v[44:47], v[28:31], a[16:31]
    s_add_u32 s74, s74, 24576
    s_cmp_ge_u32 s74, 73728
    s_cselect_b32 s75, 73728, 0
    s_sub_u32 s74, s74, s75
    s_add_u32 s73, s73, 1
    s_cmp_lt_u32 s73, 64
    s_cbranch_scc1 gob_kernel_loop2
    s_nop 15
    s_nop 3
    v_and_b32 v17, 31, v1
    v_lshrrev_b32 v18, 5, v1
    s_mul_i32 s64, s35, 128
    s_mul_i32 s65, s38, 32
    s_add_u32 s64, s64, s65
    v_add_u32 v17, s64, v17
    s_mov_b32 s65, 2048
    v_mul_lo_u32 v17, s65, v17
    s_mul_i32 s64, s34, 64
    s_lshl_b32 s65, s55, 5
    s_add_u32 s64, s64, s65
    v_lshlrev_b32 v18, 2, v18
    v_add_u32 v18, s64, v18
    v_lshlrev_b32 v18, 1, v18
    v_add_u32 v17, v17, v18
    s_mov_b32 s66, 0
    buffer_load_dwordx2 v[20:21], v17, s[56:59], s66 offen offset:0
    v_accvgpr_read_b32 v24, a0
    v_accvgpr_read_b32 v25, a1
    v_accvgpr_read_b32 v26, a2
    v_accvgpr_read_b32 v27, a3
    s_waitcnt vmcnt(0)
    v_cvt_pk_bf16_f32 v28, v24, v25
    v_cvt_pk_bf16_f32 v29, v26, v27
    v_lshlrev_b32 v24, 16, v28
    v_and_b32 v25, 0xffff0000, v28
    v_lshlrev_b32 v26, 16, v29
    v_and_b32 v27, 0xffff0000, v29
    v_lshlrev_b32 v28, 16, v20
    v_and_b32 v29, 0xffff0000, v20
    v_lshlrev_b32 v30, 16, v21
    v_and_b32 v31, 0xffff0000, v21
    v_add_f32 v24, v24, v28
    v_add_f32 v25, v25, v29
    v_add_f32 v26, v26, v30
    v_add_f32 v27, v27, v31
    v_cvt_pk_bf16_f32 v28, v24, v25
    v_cvt_pk_bf16_f32 v29, v26, v27
    s_mov_b32 s66, 0
    buffer_store_dwordx2 v[28:29], v17, s[28:31], s66 offen offset:0
    s_nop 1
    s_mov_b32 s66, 0
    buffer_load_dwordx2 v[20:21], v17, s[56:59], s66 offen offset:16
    v_accvgpr_read_b32 v24, a4
    v_accvgpr_read_b32 v25, a5
    v_accvgpr_read_b32 v26, a6
    v_accvgpr_read_b32 v27, a7
    s_waitcnt vmcnt(0)
    v_cvt_pk_bf16_f32 v28, v24, v25
    v_cvt_pk_bf16_f32 v29, v26, v27
    v_lshlrev_b32 v24, 16, v28
    v_and_b32 v25, 0xffff0000, v28
    v_lshlrev_b32 v26, 16, v29
    v_and_b32 v27, 0xffff0000, v29
    v_lshlrev_b32 v28, 16, v20
    v_and_b32 v29, 0xffff0000, v20
    v_lshlrev_b32 v30, 16, v21
    v_and_b32 v31, 0xffff0000, v21
    v_add_f32 v24, v24, v28
    v_add_f32 v25, v25, v29
    v_add_f32 v26, v26, v30
    v_add_f32 v27, v27, v31
    v_cvt_pk_bf16_f32 v28, v24, v25
    v_cvt_pk_bf16_f32 v29, v26, v27
    s_mov_b32 s66, 0
    buffer_store_dwordx2 v[28:29], v17, s[28:31], s66 offen offset:16
    s_nop 1
    s_mov_b32 s66, 0
    buffer_load_dwordx2 v[20:21], v17, s[56:59], s66 offen offset:32
    v_accvgpr_read_b32 v24, a8
    v_accvgpr_read_b32 v25, a9
    v_accvgpr_read_b32 v26, a10
    v_accvgpr_read_b32 v27, a11
    s_waitcnt vmcnt(0)
    v_cvt_pk_bf16_f32 v28, v24, v25
    v_cvt_pk_bf16_f32 v29, v26, v27
    v_lshlrev_b32 v24, 16, v28
    v_and_b32 v25, 0xffff0000, v28
    v_lshlrev_b32 v26, 16, v29
    v_and_b32 v27, 0xffff0000, v29
    v_lshlrev_b32 v28, 16, v20
    v_and_b32 v29, 0xffff0000, v20
    v_lshlrev_b32 v30, 16, v21
    v_and_b32 v31, 0xffff0000, v21
    v_add_f32 v24, v24, v28
    v_add_f32 v25, v25, v29
    v_add_f32 v26, v26, v30
    v_add_f32 v27, v27, v31
    v_cvt_pk_bf16_f32 v28, v24, v25
    v_cvt_pk_bf16_f32 v29, v26, v27
    s_mov_b32 s66, 0
    buffer_store_dwordx2 v[28:29], v17, s[28:31], s66 offen offset:32
    s_nop 1
    s_mov_b32 s66, 0
    buffer_load_dwordx2 v[20:21], v17, s[56:59], s66 offen offset:48
    v_accvgpr_read_b32 v24, a12
    v_accvgpr_read_b32 v25, a13
    v_accvgpr_read_b32 v26, a14
    v_accvgpr_read_b32 v27, a15
    s_waitcnt vmcnt(0)
    v_cvt_pk_bf16_f32 v28, v24, v25
    v_cvt_pk_bf16_f32 v29, v26, v27
    v_lshlrev_b32 v24, 16, v28
    v_and_b32 v25, 0xffff0000, v28
    v_lshlrev_b32 v26, 16, v29
    v_and_b32 v27, 0xffff0000, v29
    v_lshlrev_b32 v28, 16, v20
    v_and_b32 v29, 0xffff0000, v20
    v_lshlrev_b32 v30, 16, v21
    v_and_b32 v31, 0xffff0000, v21
    v_add_f32 v24, v24, v28
    v_add_f32 v25, v25, v29
    v_add_f32 v26, v26, v30
    v_add_f32 v27, v27, v31
    v_cvt_pk_bf16_f32 v28, v24, v25
    v_cvt_pk_bf16_f32 v29, v26, v27
    s_mov_b32 s66, 0
    buffer_store_dwordx2 v[28:29], v17, s[28:31], s66 offen offset:48
    s_nop 1
    s_mov_b32 s66, 0
    buffer_load_dwordx2 v[20:21], v17, s[56:59], s66 offen offset:64
    v_accvgpr_read_b32 v24, a16
    v_accvgpr_read_b32 v25, a17
    v_accvgpr_read_b32 v26, a18
    v_accvgpr_read_b32 v27, a19
    s_waitcnt vmcnt(0)
    v_cvt_pk_bf16_f32 v28, v24, v25
    v_cvt_pk_bf16_f32 v29, v26, v27
    v_lshlrev_b32 v24, 16, v28
    v_and_b32 v25, 0xffff0000, v28
    v_lshlrev_b32 v26, 16, v29
    v_and_b32 v27, 0xffff0000, v29
    v_lshlrev_b32 v28, 16, v20
    v_and_b32 v29, 0xffff0000, v20
    v_lshlrev_b32 v30, 16, v21
    v_and_b32 v31, 0xffff0000, v21
    v_add_f32 v24, v24, v28
    v_add_f32 v25, v25, v29
    v_add_f32 v26, v26, v30
    v_add_f32 v27, v27, v31
    v_cvt_pk_bf16_f32 v28, v24, v25
    v_cvt_pk_bf16_f32 v29, v26, v27
    s_mov_b32 s66, 0
    buffer_store_dwordx2 v[28:29], v17, s[28:31], s66 offen offset:64
    s_nop 1
    s_mov_b32 s66, 0
    buffer_load_dwordx2 v[20:21], v17, s[56:59], s66 offen offset:80
    v_accvgpr_read_b32 v24, a20
    v_accvgpr_read_b32 v25, a21
    v_accvgpr_read_b32 v26, a22
    v_accvgpr_read_b32 v27, a23
    s_waitcnt vmcnt(0)
    v_cvt_pk_bf16_f32 v28, v24, v25
    v_cvt_pk_bf16_f32 v29, v26, v27
    v_lshlrev_b32 v24, 16, v28
    v_and_b32 v25, 0xffff0000, v28
    v_lshlrev_b32 v26, 16, v29
    v_and_b32 v27, 0xffff0000, v29
    v_lshlrev_b32 v28, 16, v20
    v_and_b32 v29, 0xffff0000, v20
    v_lshlrev_b32 v30, 16, v21
    v_and_b32 v31, 0xffff0000, v21
    v_add_f32 v24, v24, v28
    v_add_f32 v25, v25, v29
    v_add_f32 v26, v26, v30
    v_add_f32 v27, v27, v31
    v_cvt_pk_bf16_f32 v28, v24, v25
    v_cvt_pk_bf16_f32 v29, v26, v27
    s_mov_b32 s66, 0
    buffer_store_dwordx2 v[28:29], v17, s[28:31], s66 offen offset:80
    s_nop 1
    s_mov_b32 s66, 0
    buffer_load_dwordx2 v[20:21], v17, s[56:59], s66 offen offset:96
    v_accvgpr_read_b32 v24, a24
    v_accvgpr_read_b32 v25, a25
    v_accvgpr_read_b32 v26, a26
    v_accvgpr_read_b32 v27, a27
    s_waitcnt vmcnt(0)
    v_cvt_pk_bf16_f32 v28, v24, v25
    v_cvt_pk_bf16_f32 v29, v26, v27
    v_lshlrev_b32 v24, 16, v28
    v_and_b32 v25, 0xffff0000, v28
    v_lshlrev_b32 v26, 16, v29
    v_and_b32 v27, 0xffff0000, v29
    v_lshlrev_b32 v28, 16, v20
    v_and_b32 v29, 0xffff0000, v20
    v_lshlrev_b32 v30, 16, v21
    v_and_b32 v31, 0xffff0000, v21
    v_add_f32 v24, v24, v28
    v_add_f32 v25, v25, v29
    v_add_f32 v26, v26, v30
    v_add_f32 v27, v27, v31
    v_cvt_pk_bf16_f32 v28, v24, v25
    v_cvt_pk_bf16_f32 v29, v26, v27
    s_mov_b32 s66, 0
    buffer_store_dwordx2 v[28:29], v17, s[28:31], s66 offen offset:96
    s_nop 1
    s_mov_b32 s66, 0
    buffer_load_dwordx2 v[20:21], v17, s[56:59], s66 offen offset:112
    v_accvgpr_read_b32 v24, a28
    v_accvgpr_read_b32 v25, a29
    v_accvgpr_read_b32 v26, a30
    v_accvgpr_read_b32 v27, a31
    s_waitcnt vmcnt(0)
    v_cvt_pk_bf16_f32 v28, v24, v25
    v_cvt_pk_bf16_f32 v29, v26, v27
    v_lshlrev_b32 v24, 16, v28
    v_and_b32 v25, 0xffff0000, v28
    v_lshlrev_b32 v26, 16, v29
    v_and_b32 v27, 0xffff0000, v29
    v_lshlrev_b32 v28, 16, v20
    v_and_b32 v29, 0xffff0000, v20
    v_lshlrev_b32 v30, 16, v21
    v_and_b32 v31, 0xffff0000, v21
    v_add_f32 v24, v24, v28
    v_add_f32 v25, v25, v29
    v_add_f32 v26, v26, v30
    v_add_f32 v27, v27, v31
    v_cvt_pk_bf16_f32 v28, v24, v25
    v_cvt_pk_bf16_f32 v29, v26, v27
    s_mov_b32 s66, 0
    buffer_store_dwordx2 v[28:29], v17, s[28:31], s66 offen offset:112
    s_nop 1
gob_kernel_done1:
    s_endpgm
.globl g2b_kernel
.p2align 8
.type g2b_kernel,@function
g2b_kernel:
    s_cmp_ge_u32 s2, 256
    s_cbranch_scc1 g2b_kernel_done1
    s_load_dwordx2 s[4:5], s[0:1], 112
    s_load_dwordx2 s[40:41], s[0:1], 80
    s_load_dwordx2 s[48:49], s[0:1], 96
    s_load_dwordx2 s[50:51], s[0:1], 88
    s_mov_b32 s34, 268435457
    s_mul_hi_u32 s35, s2, s34
    s_mul_i32 s36, s35, 16
    s_sub_u32 s34, s2, s36
    v_and_b32 v1, 63, v0
    v_lshrrev_b32 v17, 6, v0
    s_nop 0
    v_readfirstlane_b32 s37, v17
    s_waitcnt lgkmcnt(0)
    s_mul_i32 s38, s35, 917504
    s_add_u32 s38, s38, 75497472
    s_add_u32 s8, s4, s38
    s_addc_u32 s9, s5, 0
    s_and_b32 s9, s9, 0xffff
    s_mov_b32 s10, 917504
    s_mov_b32 s11, 0x00020000
    s_mul_i32 s38, s34, 64
    s_add_u32 s38, s38, 0
    s_mov_b32 s54, s40
    s_mov_b32 s55, s41
    s_lshl_b32 s38, s38, 1
    s_add_u32 s12, s54, s38
    s_addc_u32 s13, s55, 0
    s_and_b32 s13, s13, 0xffff
    s_sub_u32 s14, 7340032, s38
    s_mov_b32 s15, 0x00020000
    s_mov_b32 s28, s48
    s_and_b32 s29, s49, 0xffff
    s_mov_b32 s30, 4194304
    s_mov_b32 s31, 0x00020000
    s_add_u32 s56, s4, 71303168
    s_addc_u32 s57, s5, 0
    s_and_b32 s57, s57, 0xffff
    s_mov_b32 s58, 4194304
    s_mov_b32 s59, 0x00020000
    s_mov_b32 s60, s50
    s_and_b32 s61, s51, 0xffff
    s_mov_b32 s62, 2048
    s_mov_b32 s63, 0x00020000
    v_lshrrev_b32 v17, 3, v1
    v_and_b32 v18, 7, v1
    v_lshrrev_b32 v19, 4, v1
    v_xor_b32 v20, v18, v19
    v_xor_b32 v21, 4, v20
    s_mov_b32 s38, 7168
    v_mul_lo_u32 v22, s38, v17
    v_lshl_add_u32 v2, v20, 4, v22
    v_lshl_add_u32 v3, v21, 4, v22
    v_and_b32 v20, 1, v19
    v_lshlrev_b32 v20, 2, v20
    v_xor_b32 v20, v18, v20
    s_mov_b32 s38, 2048
    v_mul_lo_u32 v22, s38, v17
    v_lshl_add_u32 v4, v20, 4, v22
    s_and_b32 s38, s37, 3
    s_lshr_b32 s39, s37, 2
    v_and_b32 v17, 31, v1
    v_lshrrev_b32 v18, 5, v1
    v_lshrrev_b32 v19, 1, v17
    v_and_b32 v19, 7, v19
    s_mul_i32 s54, s38, 4096
    v_add_u32 v20, 0, v18
    v_xor_b32 v20, v20, v19
    v_lshlrev_b32 v20, 4, v20
    v_lshl_add_u32 v20, v17, 7, v20
    v_add_u32 v5, s54, v20
    v_add_u32 v20, 2, v18
    v_xor_b32 v20, v20, v19
    v_lshlrev_b32 v20, 4, v20
    v_lshl_add_u32 v20, v17, 7, v20
    v_add_u32 v6, s54, v20
    v_add_u32 v20, 4, v18
    v_xor_b32 v20, v20, v19
    v_lshlrev_b32 v20, 4, v20
    v_lshl_add_u32 v20, v17, 7, v20
    v_add_u32 v7, s54, v20
    v_add_u32 v20, 6, v18
    v_xor_b32 v20, v20, v19
    v_lshlrev_b32 v20, 4, v20
    v_lshl_add_u32 v20, v17, 7, v20
    v_add_u32 v8, s54, v20
    v_and_b32 v17, 15, v1
    v_lshrrev_b32 v19, 2, v17
    v_and_b32 v20, 3, v17
    v_bfe_u32 v21, v1, 4, 1
    v_lshlrev_b32 v22, 1, v21
    v_lshrrev_b32 v23, 1, v20
    v_add_u32 v22, v22, v23
    v_bfe_u32 v23, v19, 1, 1
    v_lshlrev_b32 v23, 2, v23
    v_xor_b32 v22, v22, v23
    v_lshlrev_b32 v22, 4, v22
    v_and_b32 v23, 1, v20
    v_lshl_add_u32 v22, v23, 3, v22
    v_lshl_add_u32 v23, v18, 3, v19
    v_lshl_add_u32 v22, v23, 7, v22
    v_add_u32 v9, 16384, v22
    v_xor_b32 v10, 64, v9
    s_mul_i32 s55, s39, 2
    v_accvgpr_write_b32 a0, 0
    v_accvgpr_write_b32 a1, 0
    v_accvgpr_write_b32 a2, 0
    v_accvgpr_write_b32 a3, 0
    v_accvgpr_write_b32 a4, 0
    v_accvgpr_write_b32 a5, 0
    v_accvgpr_write_b32 a6, 0
    v_accvgpr_write_b32 a7, 0
    v_accvgpr_write_b32 a8, 0
    v_accvgpr_write_b32 a9, 0
    v_accvgpr_write_b32 a10, 0
    v_accvgpr_write_b32 a11, 0
    v_accvgpr_write_b32 a12, 0
    v_accvgpr_write_b32 a13, 0
    v_accvgpr_write_b32 a14, 0
    v_accvgpr_write_b32 a15, 0
    v_accvgpr_write_b32 a16, 0
    v_accvgpr_write_b32 a17, 0
    v_accvgpr_write_b32 a18, 0
    v_accvgpr_write_b32 a19, 0
    v_accvgpr_write_b32 a20, 0
    v_accvgpr_write_b32 a21, 0
    v_accvgpr_write_b32 a22, 0
    v_accvgpr_write_b32 a23, 0
    v_accvgpr_write_b32 a24, 0
    v_accvgpr_write_b32 a25, 0
    v_accvgpr_write_b32 a26, 0
    v_accvgpr_write_b32 a27, 0
    v_accvgpr_write_b32 a28, 0
    v_accvgpr_write_b32 a29, 0
    v_accvgpr_write_b32 a30, 0
    v_accvgpr_write_b32 a31, 0
    s_mul_i32 s67, s37, 4
    s_mul_i32 s68, s37, 2
    s_mov_b32 s64, 0
    s_mov_b32 s65, 0
    s_mov_b32 s66, 0
    s_add_u32 s69, s67, 0
    s_mul_i32 s70, s69, 57344
    s_add_u32 s70, s70, s64
    s_lshl_b32 s69, s69, 10
    s_add_u32 m0, s69, s66
    buffer_load_dwordx4 v2, s[8:11], s70 offen lds
    s_add_u32 s69, s67, 1
    s_mul_i32 s70, s69, 57344
    s_add_u32 s70, s70, s64
    s_lshl_b32 s69, s69, 10
    s_add_u32 m0, s69, s66
    buffer_load_dwordx4 v3, s[8:11], s70 offen lds
    s_add_u32 s69, s67, 2
    s_mul_i32 s70, s69, 57344
    s_add_u32 s70, s70, s64
    s_lshl_b32 s69, s69, 10
    s_add_u32 m0, s69, s66
    buffer_load_dwordx4 v2, s[8:11], s70 offen lds
    s_add_u32 s69, s67, 3
    s_mul_i32 s70, s69, 57344
    s_add_u32 s70, s70, s64
    s_lshl_b32 s69, s69, 10
    s_add_u32 m0, s69, s66
    buffer_load_dwordx4 v3, s[8:11], s70 offen lds
    s_add_u32 s69, s68, 0
    s_and_b32 s71, s69, 7
    s_mul_i32 s70, s71, 16384
    s_add_u32 s70, s70, s65
    s_lshl_b32 s72, s69, 10
    s_add_u32 s72, s72, s66
    s_add_u32 m0, s72, 16384
    buffer_load_dwordx4 v4, s[12:15], s70 offen lds
    s_add_u32 s69, s68, 1
    s_and_b32 s71, s69, 7
    s_mul_i32 s70, s71, 16384
    s_add_u32 s70, s70, s65
    s_lshl_b32 s72, s69, 10
    s_add_u32 s72, s72, s66
    s_add_u32 m0, s72, 16384
    buffer_load_dwordx4 v4, s[12:15], s70 offen lds
    s_mov_b32 s64, 128
    s_mov_b32 s65, 131072
    s_mov_b32 s66, 24576
    s_add_u32 s69, s67, 0
    s_mul_i32 s70, s69, 57344
    s_add_u32 s70, s70, s64
    s_lshl_b32 s69, s69, 10
    s_add_u32 m0, s69, s66
    buffer_load_dwordx4 v2, s[8:11], s70 offen lds
    s_add_u32 s69, s67, 1
    s_mul_i32 s70, s69, 57344
    s_add_u32 s70, s70, s64
    s_lshl_b32 s69, s69, 10
    s_add_u32 m0, s69, s66
    buffer_load_dwordx4 v3, s[8:11], s70 offen lds
    s_add_u32 s69, s67, 2
    s_mul_i32 s70, s69, 57344
    s_add_u32 s70, s70, s64
    s_lshl_b32 s69, s69, 10
    s_add_u32 m0, s69, s66
    buffer_load_dwordx4 v2, s[8:11], s70 offen lds
    s_add_u32 s69, s67, 3
    s_mul_i32 s70, s69, 57344
    s_add_u32 s70, s70, s64
    s_lshl_b32 s69, s69, 10
    s_add_u32 m0, s69, s66
    buffer_load_dwordx4 v3, s[8:11], s70 offen lds
    s_add_u32 s69, s68, 0
    s_and_b32 s71, s69, 7
    s_mul_i32 s70, s71, 16384
    s_add_u32 s70, s70, s65
    s_lshl_b32 s72, s69, 10
    s_add_u32 s72, s72, s66
    s_add_u32 m0, s72, 16384
    buffer_load_dwordx4 v4, s[12:15], s70 offen lds
    s_add_u32 s69, s68, 1
    s_and_b32 s71, s69, 7
    s_mul_i32 s70, s71, 16384
    s_add_u32 s70, s70, s65
    s_lshl_b32 s72, s69, 10
    s_add_u32 s72, s72, s66
    s_add_u32 m0, s72, 16384
    buffer_load_dwordx4 v4, s[12:15], s70 offen lds
    s_mov_b32 s73, 0
    s_mov_b32 s74, 0
    s_mov_b32 s66, 49152
g2b_kernel_loop2:
    s_waitcnt vmcnt(6)
    s_barrier
    s_add_u32 s64, s64, 128
    s_add_u32 s65, s65, 131072
    s_add_u32 s69, s67, 0
    s_mul_i32 s70, s69, 57344
    s_add_u32 s70, s70, s64
    s_lshl_b32 s69, s69, 10
    s_add_u32 m0, s69, s66
    buffer_load_dwordx4 v2, s[8:11], s70 offen lds
    s_add_u32 s69, s67, 1
    s_mul_i32 s70, s69, 57344
    s_add_u32 s70, s70, s64
    s_lshl_b32 s69, s69, 10
    s_add_u32 m0, s69, s66
    buffer_load_dwordx4 v3, s[8:11], s70 offen lds
    s_add_u32 s69, s67, 2
    s_mul_i32 s70, s69, 57344
    s_add_u32 s70, s70, s64
    s_lshl_b32 s69, s69, 10
    s_add_u32 m0, s69, s66
    buffer_load_dwordx4 v2, s[8:11], s70 offen lds
    s_add_u32 s69, s67, 3
    s_mul_i32 s70, s69, 57344
    s_add_u32 s70, s70, s64
    s_lshl_b32 s69, s69, 10
    s_add_u32 m0, s69, s66
    buffer_load_dwordx4 v3, s[8:11], s70 offen lds
    s_add_u32 s69, s68, 0
    s_and_b32 s71, s69, 7
    s_mul_i32 s70, s71, 16384
    s_add_u32 s70, s70, s65
    s_lshl_b32 s72, s69, 10
    s_add_u32 s72, s72, s66
    s_add_u32 m0, s72, 16384
    buffer_load_dwordx4 v4, s[12:15], s70 offen lds
    s_add_u32 s69, s68, 1
    s_and_b32 s71, s69, 7
    s_mul_i32 s70, s71, 16384
    s_add_u32 s70, s70, s65
    s_lshl_b32 s72, s69, 10
    s_add_u32 s72, s72, s66
    s_add_u32 m0, s72, 16384
    buffer_load_dwordx4 v4, s[12:15], s70 offen lds
    s_add_u32 s66, s66, 24576
    s_cmp_ge_u32 s66, 73728
    s_cselect_b32 s75, 73728, 0
    s_sub_u32 s66, s66, s75
    v_add_u32 v11, s74, v5
    v_add_u32 v12, s74, v6
    v_add_u32 v13, s74, v7
    v_add_u32 v14, s74, v8
    v_add_u32 v15, s74, v9
    v_add_u32 v16, s74, v10
    s_add_u32 s76, s55, 0
    s_and_b32 s77, s76, 1
    s_lshr_b32 s76, s76, 1
    s_mul_i32 s76, s76, 8192
    s_cmp_eq_u32 s77, 0
    s_cselect_b64 s[78:79], -1, 0
    v_cndmask_b32 v17, v16, v15, s[78:79]
    v_add_u32 v17, s76, v17
    s_add_u32 s76, s55, 1
    s_and_b32 s77, s76, 1
    s_lshr_b32 s76, s76, 1
    s_mul_i32 s76, s76, 8192
    s_cmp_eq_u32 s77, 0
    s_cselect_b64 s[78:79], -1, 0
    v_cndmask_b32 v18, v16, v15, s[78:79]
    v_add_u32 v18, s76, v18
    ds_read_b128 v[24:27], v11 offset:0
    ds_read_b64_tr_b16 v[32:33], v17 offset:0
    ds_read_b64_tr_b16 v[34:35], v17 offset:512
    ds_read_b64_tr_b16 v[36:37], v18 offset:0
    ds_read_b64_tr_b16 v[38:39], v18 offset:512
    ds_read_b128 v[28:31], v12 offset:0
    ds_read_b64_tr_b16 v[40:41], v17 offset:2048
    ds_read_b64_tr_b16 v[42:43], v17 offset:2560
    ds_read_b64_tr_b16 v[44:45], v18 offset:2048
    ds_read_b64_tr_b16 v[46:47], v18 offset:2560
    s_waitcnt lgkmcnt(5)
    v_mfma_f32_32x32x16_bf16 a[0:15], v[32:35], v[24:27], a[0:15]
    v_mfma_f32_32x32x16_bf16 a[16:31], v[36:39], v[24:27], a[16:31]
    ds_read_b128 v[24:27], v13 offset:0
    ds_read_b64_tr_b16 v[32:33], v17 offset:4096
    ds_read_b64_tr_b16 v[34:35], v17 offset:4608
    ds_read_b64_tr_b16 v[36:37], v18 offset:4096
    ds_read_b64_tr_b16 v[38:39], v18 offset:4608
    s_waitcnt lgkmcnt(5)
    v_mfma_f32_32x32x16_bf16 a[0:15], v[40:43], v[28:31], a[0:15]
    v_mfma_f32_32x32x16_bf16 a[16:31], v[44:47], v[28:31], a[16:31]
    ds_read_b128 v[28:31], v14 offset:0
    ds_read_b64_tr_b16 v[40:41], v17 offset:6144
    ds_read_b64_tr_b16 v[42:43], v17 offset:6656
    ds_read_b64_tr_b16 v[44:45], v18 offset:6144
    ds_read_b64_tr_b16 v[46:47], v18 offset:6656
    s_waitcnt lgkmcnt(5)
    v_mfma_f32_32x32x16_bf16 a[0:15], v[32:35], v[24:27], a[0:15]
    v_mfma_f32_32x32x16_bf16 a[16:31], v[36:39], v[24:27], a[16:31]
    s_waitcnt lgkmcnt(0)
    v_mfma_f32_32x32x16_bf16 a[0:15], v[40:43], v[28:31], a[0:15]
    v_mfma_f32_32x32x16_bf16 a[16:31], v[44:47], v[28:31], a[16:31]
    s_add_u32 s74, s74, 24576
    s_cmp_ge_u32 s74, 73728
    s_cselect_b32 s75, 73728, 0
    s_sub_u32 s74, s74, s75
    s_add_u32 s73, s73, 1
    s_cmp_lt_u32 s73, 56
    s_cbranch_scc1 g2b_kernel_loop2
    s_nop 15
    s_nop 3
    v_and_b32 v17, 31, v1
    v_lshrrev_b32 v18, 5, v1
    s_mul_i32 s64, s35, 128
    s_mul_i32 s65, s38, 32
    s_add_u32 s64, s64, s65
    v_add_u32 v17, s64, v17
    s_mov_b32 s65, 2048
    v_mul_lo_u32 v17, s65, v17
    s_mul_i32 s64, s34, 64
    s_lshl_b32 s65, s55, 5
    s_add_u32 s64, s64, s65
    v_lshlrev_b32 v18, 2, v18
    v_add_u32 v18, s64, v18
    v_lshlrev_b32 v18, 1, v18
    v_add_u32 v17, v17, v18
    s_mov_b32 s66, 0
    buffer_load_dwordx2 v[20:21], v17, s[56:59], s66 offen offset:0
    buffer_load_dwordx2 v[22:23], v18, s[60:63], 0 offen offset:0
    v_accvgpr_read_b32 v24, a0
    v_accvgpr_read_b32 v25, a1
    v_accvgpr_read_b32 v26, a2
    v_accvgpr_read_b32 v27, a3
    s_waitcnt vmcnt(0)
    v_cvt_pk_bf16_f32 v28, v24, v25
    v_cvt_pk_bf16_f32 v29, v26, v27
    v_lshlrev_b32 v24, 16, v28
    v_and_b32 v25, 0xffff0000, v28
    v_lshlrev_b32 v26, 16, v29
    v_and_b32 v27, 0xffff0000, v29
    v_lshlrev_b32 v28, 16, v22
    v_and_b32 v29, 0xffff0000, v22
    v_lshlrev_b32 v30, 16, v23
    v_and_b32 v31, 0xffff0000, v23
    v_add_f32 v24, v24, v28
    v_add_f32 v25, v25, v29
    v_add_f32 v26, v26, v30
    v_add_f32 v27, v27, v31
    v_cvt_pk_bf16_f32 v28, v24, v25
    v_cvt_pk_bf16_f32 v29, v26, v27
    v_lshlrev_b32 v24, 16, v28
    v_and_b32 v25, 0xffff0000, v28
    v_lshlrev_b32 v26, 16, v29
    v_and_b32 v27, 0xffff0000, v29
    v_lshlrev_b32 v28, 16, v20
    v_and_b32 v29, 0xffff0000, v20
    v_lshlrev_b32 v30, 16, v21
    v_and_b32 v31, 0xffff0000, v21
    v_add_f32 v24, v24, v28
    v_add_f32 v25, v25, v29
    v_add_f32 v26, v26, v30
    v_add_f32 v27, v27, v31
    v_cvt_pk_bf16_f32 v28, v24, v25
    v_cvt_pk_bf16_f32 v29, v26, v27
    s_mov_b32 s66, 0
    buffer_store_dwordx2 v[28:29], v17, s[28:31], s66 offen offset:0
    s_nop 1
    s_mov_b32 s66, 0
    buffer_load_dwordx2 v[20:21], v17, s[56:59], s66 offen offset:16
    buffer_load_dwordx2 v[22:23], v18, s[60:63], 0 offen offset:16
    v_accvgpr_read_b32 v24, a4
    v_accvgpr_read_b32 v25, a5
    v_accvgpr_read_b32 v26, a6
    v_accvgpr_read_b32 v27, a7
    s_waitcnt vmcnt(0)
    v_cvt_pk_bf16_f32 v28, v24, v25
    v_cvt_pk_bf16_f32 v29, v26, v27
    v_lshlrev_b32 v24, 16, v28
    v_and_b32 v25, 0xffff0000, v28
    v_lshlrev_b32 v26, 16, v29
    v_and_b32 v27, 0xffff0000, v29
    v_lshlrev_b32 v28, 16, v22
    v_and_b32 v29, 0xffff0000, v22
    v_lshlrev_b32 v30, 16, v23
    v_and_b32 v31, 0xffff0000, v23
    v_add_f32 v24, v24, v28
    v_add_f32 v25, v25, v29
    v_add_f32 v26, v26, v30
    v_add_f32 v27, v27, v31
    v_cvt_pk_bf16_f32 v28, v24, v25
    v_cvt_pk_bf16_f32 v29, v26, v27
    v_lshlrev_b32 v24, 16, v28
    v_and_b32 v25, 0xffff0000, v28
    v_lshlrev_b32 v26, 16, v29
    v_and_b32 v27, 0xffff0000, v29
    v_lshlrev_b32 v28, 16, v20
    v_and_b32 v29, 0xffff0000, v20
    v_lshlrev_b32 v30, 16, v21
    v_and_b32 v31, 0xffff0000, v21
    v_add_f32 v24, v24, v28
    v_add_f32 v25, v25, v29
    v_add_f32 v26, v26, v30
    v_add_f32 v27, v27, v31
    v_cvt_pk_bf16_f32 v28, v24, v25
    v_cvt_pk_bf16_f32 v29, v26, v27
    s_mov_b32 s66, 0
    buffer_store_dwordx2 v[28:29], v17, s[28:31], s66 offen offset:16
    s_nop 1
    s_mov_b32 s66, 0
    buffer_load_dwordx2 v[20:21], v17, s[56:59], s66 offen offset:32
    buffer_load_dwordx2 v[22:23], v18, s[60:63], 0 offen offset:32
    v_accvgpr_read_b32 v24, a8
    v_accvgpr_read_b32 v25, a9
    v_accvgpr_read_b32 v26, a10
    v_accvgpr_read_b32 v27, a11
    s_waitcnt vmcnt(0)
    v_cvt_pk_bf16_f32 v28, v24, v25
    v_cvt_pk_bf16_f32 v29, v26, v27
    v_lshlrev_b32 v24, 16, v28
    v_and_b32 v25, 0xffff0000, v28
    v_lshlrev_b32 v26, 16, v29
    v_and_b32 v27, 0xffff0000, v29
    v_lshlrev_b32 v28, 16, v22
    v_and_b32 v29, 0xffff0000, v22
    v_lshlrev_b32 v30, 16, v23
    v_and_b32 v31, 0xffff0000, v23
    v_add_f32 v24, v24, v28
    v_add_f32 v25, v25, v29
    v_add_f32 v26, v26, v30
    v_add_f32 v27, v27, v31
    v_cvt_pk_bf16_f32 v28, v24, v25
    v_cvt_pk_bf16_f32 v29, v26, v27
    v_lshlrev_b32 v24, 16, v28
    v_and_b32 v25, 0xffff0000, v28
    v_lshlrev_b32 v26, 16, v29
    v_and_b32 v27, 0xffff0000, v29
    v_lshlrev_b32 v28, 16, v20
    v_and_b32 v29, 0xffff0000, v20
    v_lshlrev_b32 v30, 16, v21
    v_and_b32 v31, 0xffff0000, v21
    v_add_f32 v24, v24, v28
    v_add_f32 v25, v25, v29
    v_add_f32 v26, v26, v30
    v_add_f32 v27, v27, v31
    v_cvt_pk_bf16_f32 v28, v24, v25
    v_cvt_pk_bf16_f32 v29, v26, v27
    s_mov_b32 s66, 0
    buffer_store_dwordx2 v[28:29], v17, s[28:31], s66 offen offset:32
    s_nop 1
    s_mov_b32 s66, 0
    buffer_load_dwordx2 v[20:21], v17, s[56:59], s66 offen offset:48
    buffer_load_dwordx2 v[22:23], v18, s[60:63], 0 offen offset:48
    v_accvgpr_read_b32 v24, a12
    v_accvgpr_read_b32 v25, a13
    v_accvgpr_read_b32 v26, a14
    v_accvgpr_read_b32 v27, a15
    s_waitcnt vmcnt(0)
    v_cvt_pk_bf16_f32 v28, v24, v25
    v_cvt_pk_bf16_f32 v29, v26, v27
    v_lshlrev_b32 v24, 16, v28
    v_and_b32 v25, 0xffff0000, v28
    v_lshlrev_b32 v26, 16, v29
    v_and_b32 v27, 0xffff0000, v29
    v_lshlrev_b32 v28, 16, v22
    v_and_b32 v29, 0xffff0000, v22
    v_lshlrev_b32 v30, 16, v23
    v_and_b32 v31, 0xffff0000, v23
    v_add_f32 v24, v24, v28
    v_add_f32 v25, v25, v29
    v_add_f32 v26, v26, v30
    v_add_f32 v27, v27, v31
    v_cvt_pk_bf16_f32 v28, v24, v25
    v_cvt_pk_bf16_f32 v29, v26, v27
    v_lshlrev_b32 v24, 16, v28
    v_and_b32 v25, 0xffff0000, v28
    v_lshlrev_b32 v26, 16, v29
    v_and_b32 v27, 0xffff0000, v29
    v_lshlrev_b32 v28, 16, v20
    v_and_b32 v29, 0xffff0000, v20
    v_lshlrev_b32 v30, 16, v21
    v_and_b32 v31, 0xffff0000, v21
    v_add_f32 v24, v24, v28
    v_add_f32 v25, v25, v29
    v_add_f32 v26, v26, v30
    v_add_f32 v27, v27, v31
    v_cvt_pk_bf16_f32 v28, v24, v25
    v_cvt_pk_bf16_f32 v29, v26, v27
    s_mov_b32 s66, 0
    buffer_store_dwordx2 v[28:29], v17, s[28:31], s66 offen offset:48
    s_nop 1
    s_mov_b32 s66, 0
    buffer_load_dwordx2 v[20:21], v17, s[56:59], s66 offen offset:64
    buffer_load_dwordx2 v[22:23], v18, s[60:63], 0 offen offset:64
    v_accvgpr_read_b32 v24, a16
    v_accvgpr_read_b32 v25, a17
    v_accvgpr_read_b32 v26, a18
    v_accvgpr_read_b32 v27, a19
    s_waitcnt vmcnt(0)
    v_cvt_pk_bf16_f32 v28, v24, v25
    v_cvt_pk_bf16_f32 v29, v26, v27
    v_lshlrev_b32 v24, 16, v28
    v_and_b32 v25, 0xffff0000, v28
    v_lshlrev_b32 v26, 16, v29
    v_and_b32 v27, 0xffff0000, v29
    v_lshlrev_b32 v28, 16, v22
    v_and_b32 v29, 0xffff0000, v22
    v_lshlrev_b32 v30, 16, v23
    v_and_b32 v31, 0xffff0000, v23
    v_add_f32 v24, v24, v28
    v_add_f32 v25, v25, v29
    v_add_f32 v26, v26, v30
    v_add_f32 v27, v27, v31
    v_cvt_pk_bf16_f32 v28, v24, v25
    v_cvt_pk_bf16_f32 v29, v26, v27
    v_lshlrev_b32 v24, 16, v28
    v_and_b32 v25, 0xffff0000, v28
    v_lshlrev_b32 v26, 16, v29
    v_and_b32 v27, 0xffff0000, v29
    v_lshlrev_b32 v28, 16, v20
    v_and_b32 v29, 0xffff0000, v20
    v_lshlrev_b32 v30, 16, v21
    v_and_b32 v31, 0xffff0000, v21
    v_add_f32 v24, v24, v28
    v_add_f32 v25, v25, v29
    v_add_f32 v26, v26, v30
    v_add_f32 v27, v27, v31
    v_cvt_pk_bf16_f32 v28, v24, v25
    v_cvt_pk_bf16_f32 v29, v26, v27
    s_mov_b32 s66, 0
    buffer_store_dwordx2 v[28:29], v17, s[28:31], s66 offen offset:64
    s_nop 1
    s_mov_b32 s66, 0
    buffer_load_dwordx2 v[20:21], v17, s[56:59], s66 offen offset:80
    buffer_load_dwordx2 v[22:23], v18, s[60:63], 0 offen offset:80
    v_accvgpr_read_b32 v24, a20
    v_accvgpr_read_b32 v25, a21
    v_accvgpr_read_b32 v26, a22
    v_accvgpr_read_b32 v27, a23
    s_waitcnt vmcnt(0)
    v_cvt_pk_bf16_f32 v28, v24, v25
    v_cvt_pk_bf16_f32 v29, v26, v27
    v_lshlrev_b32 v24, 16, v28
    v_and_b32 v25, 0xffff0000, v28
    v_lshlrev_b32 v26, 16, v29
    v_and_b32 v27, 0xffff0000, v29
    v_lshlrev_b32 v28, 16, v22
    v_and_b32 v29, 0xffff0000, v22
    v_lshlrev_b32 v30, 16, v23
    v_and_b32 v31, 0xffff0000, v23
    v_add_f32 v24, v24, v28
    v_add_f32 v25, v25, v29
    v_add_f32 v26, v26, v30
    v_add_f32 v27, v27, v31
    v_cvt_pk_bf16_f32 v28, v24, v25
    v_cvt_pk_bf16_f32 v29, v26, v27
    v_lshlrev_b32 v24, 16, v28
    v_and_b32 v25, 0xffff0000, v28
    v_lshlrev_b32 v26, 16, v29
    v_and_b32 v27, 0xffff0000, v29
    v_lshlrev_b32 v28, 16, v20
    v_and_b32 v29, 0xffff0000, v20
    v_lshlrev_b32 v30, 16, v21
    v_and_b32 v31, 0xffff0000, v21
    v_add_f32 v24, v24, v28
    v_add_f32 v25, v25, v29
    v_add_f32 v26, v26, v30
    v_add_f32 v27, v27, v31
    v_cvt_pk_bf16_f32 v28, v24, v25
    v_cvt_pk_bf16_f32 v29, v26, v27
    s_mov_b32 s66, 0
    buffer_store_dwordx2 v[28:29], v17, s[28:31], s66 offen offset:80
    s_nop 1
    s_mov_b32 s66, 0
    buffer_load_dwordx2 v[20:21], v17, s[56:59], s66 offen offset:96
    buffer_load_dwordx2 v[22:23], v18, s[60:63], 0 offen offset:96
    v_accvgpr_read_b32 v24, a24
    v_accvgpr_read_b32 v25, a25
    v_accvgpr_read_b32 v26, a26
    v_accvgpr_read_b32 v27, a27
    s_waitcnt vmcnt(0)
    v_cvt_pk_bf16_f32 v28, v24, v25
    v_cvt_pk_bf16_f32 v29, v26, v27
    v_lshlrev_b32 v24, 16, v28
    v_and_b32 v25, 0xffff0000, v28
    v_lshlrev_b32 v26, 16, v29
    v_and_b32 v27, 0xffff0000, v29
    v_lshlrev_b32 v28, 16, v22
    v_and_b32 v29, 0xffff0000, v22
    v_lshlrev_b32 v30, 16, v23
    v_and_b32 v31, 0xffff0000, v23
    v_add_f32 v24, v24, v28
    v_add_f32 v25, v25, v29
    v_add_f32 v26, v26, v30
    v_add_f32 v27, v27, v31
    v_cvt_pk_bf16_f32 v28, v24, v25
    v_cvt_pk_bf16_f32 v29, v26, v27
    v_lshlrev_b32 v24, 16, v28
    v_and_b32 v25, 0xffff0000, v28
    v_lshlrev_b32 v26, 16, v29
    v_and_b32 v27, 0xffff0000, v29
    v_lshlrev_b32 v28, 16, v20
    v_and_b32 v29, 0xffff0000, v20
    v_lshlrev_b32 v30, 16, v21
    v_and_b32 v31, 0xffff0000, v21
    v_add_f32 v24, v24, v28
    v_add_f32 v25, v25, v29
    v_add_f32 v26, v26, v30
    v_add_f32 v27, v27, v31
    v_cvt_pk_bf16_f32 v28, v24, v25
    v_cvt_pk_bf16_f32 v29, v26, v27
    s_mov_b32 s66, 0
    buffer_store_dwordx2 v[28:29], v17, s[28:31], s66 offen offset:96
    s_nop 1
    s_mov_b32 s66, 0
    buffer_load_dwordx2 v[20:21], v17, s[56:59], s66 offen offset:112
    buffer_load_dwordx2 v[22:23], v18, s[60:63], 0 offen offset:112
    v_accvgpr_read_b32 v24, a28
    v_accvgpr_read_b32 v25, a29
    v_accvgpr_read_b32 v26, a30
    v_accvgpr_read_b32 v27, a31
    s_waitcnt vmcnt(0)
    v_cvt_pk_bf16_f32 v28, v24, v25
    v_cvt_pk_bf16_f32 v29, v26, v27
    v_lshlrev_b32 v24, 16, v28
    v_and_b32 v25, 0xffff0000, v28
    v_lshlrev_b32 v26, 16, v29
    v_and_b32 v27, 0xffff0000, v29
    v_lshlrev_b32 v28, 16, v22
    v_and_b32 v29, 0xffff0000, v22
    v_lshlrev_b32 v30, 16, v23
    v_and_b32 v31, 0xffff0000, v23
    v_add_f32 v24, v24, v28
    v_add_f32 v25, v25, v29
    v_add_f32 v26, v26, v30
    v_add_f32 v27, v27, v31
    v_cvt_pk_bf16_f32 v28, v24, v25
    v_cvt_pk_bf16_f32 v29, v26, v27
    v_lshlrev_b32 v24, 16, v28
    v_and_b32 v25, 0xffff0000, v28
    v_lshlrev_b32 v26, 16, v29
    v_and_b32 v27, 0xffff0000, v29
    v_lshlrev_b32 v28, 16, v20
    v_and_b32 v29, 0xffff0000, v20
    v_lshlrev_b32 v30, 16, v21
    v_and_b32 v31, 0xffff0000, v21
    v_add_f32 v24, v24, v28
    v_add_f32 v25, v25, v29
    v_add_f32 v26, v26, v30
    v_add_f32 v27, v27, v31
    v_cvt_pk_bf16_f32 v28, v24, v25
    v_cvt_pk_bf16_f32 v29, v26, v27
    s_mov_b32 s66, 0
    buffer_store_dwordx2 v[28:29], v17, s[28:31], s66 offen offset:112
    s_nop 1
g2b_kernel_done1:
    s_endpgm
.section .rodata,"a"
.p2align 6
.amdhsa_kernel ln1a_kernel
  .amdhsa_next_free_vgpr 64
  .amdhsa_next_free_sgpr 96
  .amdhsa_accum_offset 64
  .amdhsa_group_segment_fixed_size 0
  .amdhsa_kernarg_size 120
  .amdhsa_user_sgpr_count 2
  .amdhsa_user_sgpr_kernarg_segment_ptr 1
  .amdhsa_system_sgpr_workgroup_id_x 1
.end_amdhsa_kernel
.p2align 6
.amdhsa_kernel gqkv_kernel
  .amdhsa_next_free_vgpr 120
  .amdhsa_next_free_sgpr 96
  .amdhsa_accum_offset 56
  .amdhsa_group_segment_fixed_size 0
  .amdhsa_kernarg_size 120
  .amdhsa_user_sgpr_count 2
  .amdhsa_user_sgpr_kernarg_segment_ptr 1
  .amdhsa_system_sgpr_workgroup_id_x 1
.end_amdhsa_kernel
.p2align 6
.amdhsa_kernel zero_kernel
  .amdhsa_next_free_vgpr 16
  .amdhsa_next_free_sgpr 96
  .amdhsa_accum_offset 16
  .amdhsa_group_segment_fixed_size 0
  .amdhsa_kernarg_size 120
  .amdhsa_user_sgpr_count 2
  .amdhsa_user_sgpr_kernarg_segment_ptr 1
  .amdhsa_system_sgpr_workgroup_id_x 1
.end_amdhsa_kernel
.p2align 6
.amdhsa_kernel rec_kernel
  .amdhsa_next_free_vgpr 328
  .amdhsa_next_free_sgpr 102
  .amdhsa_accum_offset 200
  .amdhsa_group_segment_fixed_size 0
  .amdhsa_kernarg_size 120
  .amdhsa_user_sgpr_count 2
  .amdhsa_user_sgpr_kernarg_segment_ptr 1
  .amdhsa_system_sgpr_workgroup_id_x 1
.end_amdhsa_kernel
.p2align 6
.amdhsa_kernel att_kernel
  .amdhsa_next_free_vgpr 160
  .amdhsa_next_free_sgpr 96
  .amdhsa_accum_offset 160
  .amdhsa_group_segment_fixed_size 0
  .amdhsa_kernarg_size 120
  .amdhsa_user_sgpr_count 2
  .amdhsa_user_sgpr_kernarg_segment_ptr 1
  .amdhsa_system_sgpr_workgroup_id_x 1
.end_amdhsa_kernel
.p2align 6
.amdhsa_kernel goa_kernel
  .amdhsa_next_free_vgpr 80
  .amdhsa_next_free_sgpr 96
  .amdhsa_accum_offset 48
  .amdhsa_group_segment_fixed_size 0
  .amdhsa_kernarg_size 120
  .amdhsa_user_sgpr_count 2
  .amdhsa_user_sgpr_kernarg_segment_ptr 1
  .amdhsa_system_sgpr_workgroup_id_x 1
.end_amdhsa_kernel
.p2align 6
.amdhsa_kernel ln2_kernel
  .amdhsa_next_free_vgpr 64
  .amdhsa_next_free_sgpr 96
  .amdhsa_accum_offset 64
  .amdhsa_group_segment_fixed_size 0
  .amdhsa_kernarg_size 120
  .amdhsa_user_sgpr_count 2
  .amdhsa_user_sgpr_kernarg_segment_ptr 1
  .amdhsa_system_sgpr_workgroup_id_x 1
.end_amdhsa_kernel
.p2align 6
.amdhsa_kernel g1_kernel
  .amdhsa_next_free_vgpr 200
  .amdhsa_next_free_sgpr 96
  .amdhsa_accum_offset 72
  .amdhsa_group_segment_fixed_size 0
  .amdhsa_kernarg_size 120
  .amdhsa_user_sgpr_count 2
  .amdhsa_user_sgpr_kernarg_segment_ptr 1
  .amdhsa_system_sgpr_workgroup_id_x 1
.end_amdhsa_kernel
.p2align 6
.amdhsa_kernel g2a_kernel
  .amdhsa_next_free_vgpr 80
  .amdhsa_next_free_sgpr 96
  .amdhsa_accum_offset 48
  .amdhsa_group_segment_fixed_size 0
  .amdhsa_kernarg_size 120
  .amdhsa_user_sgpr_count 2
  .amdhsa_user_sgpr_kernarg_segment_ptr 1
  .amdhsa_system_sgpr_workgroup_id_x 1
.end_amdhsa_kernel
.p2align 6
.amdhsa_kernel ln1b_kernel
  .amdhsa_next_free_vgpr 64
  .amdhsa_next_free_sgpr 96
  .amdhsa_accum_offset 64
  .amdhsa_group_segment_fixed_size 0
  .amdhsa_kernarg_size 120
  .amdhsa_user_sgpr_count 2
  .amdhsa_user_sgpr_kernarg_segment_ptr 1
  .amdhsa_system_sgpr_workgroup_id_x 1
.end_amdhsa_kernel
.p2align 6
.amdhsa_kernel gob_kernel
  .amdhsa_next_free_vgpr 80
  .amdhsa_next_free_sgpr 96
  .amdhsa_accum_offset 48
  .amdhsa_group_segment_fixed_size 0
  .amdhsa_kernarg_size 120
  .amdhsa_user_sgpr_count 2
  .amdhsa_user_sgpr_kernarg_segment_ptr 1
  .amdhsa_system_sgpr_workgroup_id_x 1
.end_amdhsa_kernel
.p2align 6
.amdhsa_kernel g2b_kernel
  .amdhsa_next_free_vgpr 80
  .amdhsa_next_free_sgpr 96
  .amdhsa_accum_offset 48
  .amdhsa_group_segment_fixed_size 0
  .amdhsa_kernarg_size 120
  .amdhsa_user_sgpr_count 2
  .amdhsa_user_sgpr_kernarg_segment_ptr 1
  .amdhsa_system_sgpr_workgroup_id_x 1
.end_amdhsa_kernel
```
